```python
import torch

def _softmax(x, axis=-1):
    return torch.softmax(x, dim=axis)
def _gelu(x):
    return torch.nn.functional.gelu(x, approximate="tanh")
def _silu(x):
    return torch.nn.functional.silu(x)
def _sigmoid(x):
    return torch.sigmoid(x)
def _layernorm(x, axis=-1, eps=1e-5):
    m = x.mean(dim=axis, keepdim=True)
    v = x.var(dim=axis, keepdim=True, unbiased=False)
    return (x - m) / torch.sqrt(v + eps)
def _scatter_add(tgt, idx, src, axis=0):
    return tgt.clone().index_add_(axis, idx, src)
def _segment_sum(src, seg, n):
    out = torch.zeros((n,) + src.shape[1:], dtype=src.dtype)
    return out.index_add_(0, seg, src)
def _pad(x, pw):
    flat = tuple(v for pair in reversed(pw) for v in pair)
    return torch.nn.functional.pad(x, flat)

kernel_name = 'recurrent_scan__sliding_local_dilated__mixer_s_mlp__prompt'

def setup_inputs():

    _w = (lambda a: (lambda t: t.to(torch.bfloat16) if t.is_floating_point() else t)(torch.as_tensor(a)))
    def _A_setup():
        B, S, D = 1, 2048, 640
        return {
            "x": _w((lambda *s: torch.randn(*s, dtype=torch.bfloat16) * 0.05)(B, S, D)),
            "wqkv": _w((lambda *s: torch.randn(*s, dtype=torch.bfloat16) * 0.05)(D, 3 * D)),
            "wo": _w((lambda *s: torch.randn(*s, dtype=torch.bfloat16) * 0.05)(D, D)),
        }
    _A_in = _A_setup()

    def _B_setup():
        B, S, D, F = 1, 2048, 640, 1728
        return {
            "x":  _w((lambda *s: torch.randn(*s, dtype=torch.bfloat16) * 0.05)(B, S, D)),
            "w1": _w((lambda *s: torch.randn(*s, dtype=torch.bfloat16) * 3.2)(D, D) * (D ** -0.5)),
            "w2": _w((lambda *s: torch.randn(*s, dtype=torch.bfloat16) * 3.2)(D, D) * (D ** -0.5)),
            "w3": _w((lambda *s: torch.randn(*s, dtype=torch.bfloat16) * 3.2)(D, F) * (D ** -0.5)),
            "w4": _w((lambda *s: torch.randn(*s, dtype=torch.bfloat16) * 3.2)(F, D) * (F ** -0.5)),
        }
    _B_in = _B_setup()

    return {
        "A_x": _A_in["x"],
        "A_wqkv": _A_in["wqkv"],
        "A_wo": _A_in["wo"],
        "B_x": _B_in["x"],
        "B_w1": _B_in["w1"],
        "B_w2": _B_in["w2"],
        "B_w3": _B_in["w3"],
        "B_w4": _B_in["w4"],
    }

def reference(A_x, A_wqkv, A_wo, B_x, B_w1, B_w2, B_w3, B_w4):
    def _A_ref(x, wqkv, wo):
        B, S, D = x.shape
        H = 32; Dh = D // H
        W, dil = 8, 2
        qkv = (lambda x, *d: x.permute(*d))((x @ wqkv).reshape(B, S, 3, H, Dh), 2, 0, 3, 1, 4)
        q, k, v = qkv[0], qkv[1], qkv[2]
        scale = Dh ** -0.5
        pos = torch.arange(S)
        off = torch.arange(W) * dil
        idx = pos[:, None] - off[None, :]
        mask = idx >= 0
        idx_c = torch.where(mask, idx, 0).reshape(-1)
        kg = k[:, :, idx_c, :].reshape(B, H, S, W, Dh)
        vg = v[:, :, idx_c, :].reshape(B, H, S, W, Dh)
        logits = torch.einsum("bhsd,bhswd->bhsw", q, kg) * scale
        logits = torch.where(mask[None, None, :, :], logits, -1e9)
        attn = _softmax(logits, axis=-1)
        o = torch.einsum("bhsw,bhswd->bhsd", attn, vg)
        return (lambda x, *d: x.permute(*d))(o, 0, 2, 1, 3).reshape(B, S, D) @ wo

    def _B_ref(x, w1, w2, w3, w4):
        B, S, D = x.shape
        h = _gelu(_layernorm(x, axis=-1) @ w1)
        c = D // 4
        g0 = _pad(h[:, :, 0*c:1*c], ((0, 0), (1, 0), (0, 0)))[:, :S, :]
        g1 = _pad(h[:, :, 1*c:2*c], ((0, 0), (0, 1), (0, 0)))[:, 1:, :]
        g2 = _pad(h[:, :, 2*c:3*c], ((0, 0), (2, 0), (0, 0)))[:, :S, :]
        g3 = _pad(h[:, :, 3*c:   ], ((0, 0), (0, 2), (0, 0)))[:, 2:, :]
        hs = torch.concatenate([g0, g1, g2, g3], axis=-1) @ w2
        x1 = x + hs
        h2 = _gelu(_layernorm(x1, axis=-1) @ w3) @ w4
        return x1 + h2

    x = A_x
    xn = _layernorm(x, axis=-1)
    s = _A_ref(xn, A_wqkv, A_wo)
    g = _silu(_B_ref(xn, B_w1, B_w2, B_w3, B_w4))
    return x + s * g
```

```asm
; @launch grid=(256,1,1) block=(512,1,1) lds=163840
.amdgcn_target "amdgcn-amd-amdhsa--gfx950"
.text
.globl recurrent_scan__sliding_local_dilated__mixer_s_mlp__prompt_kernel
.p2align 8
.type recurrent_scan__sliding_local_dilated__mixer_s_mlp__prompt_kernel,@function
recurrent_scan__sliding_local_dilated__mixer_s_mlp__prompt_kernel:
    s_cmp_ge_u32 s2, 256
    s_cbranch_scc1 Lend
    s_load_dwordx16 s[32:47], s[0:1], 0
    s_load_dwordx4 s[48:51], s[0:1], 64
    s_load_dwordx2 s[52:53], s[0:1], 80
    v_lshrrev_b32 v2, 6, v0
    v_and_b32 v1, 63, v0
    s_and_b32 s29, s2, 7
    s_lshr_b32 s30, s2, 3
    v_readfirstlane_b32 s22, v2
    s_lshl_b32 s25, s29, 1
    s_lshr_b32 s3, s30, 4
    s_add_u32 s25, s25, s3
    s_and_b32 s26, s30, 15
    s_lshl_b32 s27, s25, 1
    s_lshr_b32 s3, s26, 3
    s_add_u32 s27, s27, s3
    s_and_b32 s28, s26, 7
    s_lshr_b32 s23, s29, 2
    s_lshl_b32 s23, s23, 3
    s_lshr_b32 s3, s30, 2
    s_add_u32 s23, s23, s3
    s_and_b32 s24, s29, 3
    s_lshl_b32 s24, s24, 2
    s_and_b32 s3, s30, 3
    s_add_u32 s24, s24, s3
    s_mov_b32 s6, 2621440
    s_mov_b32 s7, 0x20000
    s_mov_b32 s10, 0x2000000
    s_mov_b32 s11, 0x20000
    s_mov_b32 s15, 0x20000
    s_mov_b32 s18, 2621440
    s_mov_b32 s19, 0x20000
    s_waitcnt lgkmcnt(0)
    s_mov_b32 s4, s32
    s_mov_b32 s5, s33
    s_mov_b32 s8, s52
    s_mov_b32 s9, s53
    s_mov_b32 s16, s48
    s_mov_b32 s17, s49
    s_mov_b32 s38, s25
    s_mov_b32 s39, s26
    s_mov_b32 s14, 2457600
    s_mov_b32 s21, 36864
    s_cmp_ge_u32 s24, 12
    s_cselect_b64 s[12:13], s[40:41], s[34:35]
    s_cselect_b32 s14, 819200, s14
    s_cmp_ge_u32 s22, 6
    s_cbranch_scc1 Lwload
    s_cmp_eq_u32 s22, 5
    s_cbranch_scc1 Lx5load
    s_cmp_eq_u32 s22, 4
    s_cbranch_scc1 Lx4load
    s_setprio 2
    s_mov_b32 s95, 0x20000
    v_lshrrev_b32 v236, 5, v1
    v_bfe_u32 v237, v1, 3, 2
    v_and_b32 v238, 7, v1
    v_lshlrev_b32 v238, 4, v238
    v_lshrrev_b32 v239, 4, v1
    v_lshlrev_b32 v239, 3, v239
    v_bfe_u32 v240, v1, 2, 2
    v_add_u32 v239, v239, v240
    v_lshlrev_b32 v239, 7, v239
    v_and_b32 v240, 3, v1
    v_lshlrev_b32 v241, 2, v1
    v_lshlrev_b32 v251, 4, v1
    s_cmp_eq_u32 s22, 3
    s_cbranch_scc1 Lp0
    s_lshl_b32 s100, s22, 8
    s_add_u32 s100, s100, s2
    s_cmp_ge_u32 s100, 740
    s_cselect_b32 s3, 256, 0
    s_sub_u32 s100, s100, s3
    s_lshl_b32 s101, s22, 12
    s_add_u32 s101, s101, 147456
    s_call_b64 s[70:71], Lpk_issue
    s_branch Lp0x
Lp0:
    s_cmp_lg_u32 s2, 0
    s_cbranch_scc1 Lp0x
    v_mov_b32 v8, 0
    v_mov_b32 v9, 0
    v_mov_b32 v10, 0
    v_mov_b32 v11, 0
    s_mov_b32 s3, 0x1c40000
    buffer_store_dwordx4 v[8:11], v251, s[8:11], s3 offen offset:0 sc0 sc1
    buffer_store_dwordx4 v[8:11], v251, s[8:11], s3 offen offset:1024 sc0 sc1
    buffer_store_dwordx4 v[8:11], v251, s[8:11], s3 offen offset:2048 sc0 sc1
    buffer_store_dwordx4 v[8:11], v251, s[8:11], s3 offen offset:3072 sc0 sc1
    s_mov_b32 s3, 0x1c41000
    buffer_store_dwordx4 v[8:11], v251, s[8:11], s3 offen offset:0 sc0 sc1
    buffer_store_dwordx4 v[8:11], v251, s[8:11], s3 offen offset:1024 sc0 sc1
    buffer_store_dwordx4 v[8:11], v251, s[8:11], s3 offen offset:2048 sc0 sc1
    buffer_store_dwordx4 v[8:11], v251, s[8:11], s3 offen offset:3072 sc0 sc1
    s_mov_b32 s3, 0x1c42000
    buffer_store_dwordx4 v[8:11], v251, s[8:11], s3 offen offset:0 sc0 sc1
    buffer_store_dwordx4 v[8:11], v251, s[8:11], s3 offen offset:1024 sc0 sc1
    buffer_store_dwordx4 v[8:11], v251, s[8:11], s3 offen offset:2048 sc0 sc1
    buffer_store_dwordx4 v[8:11], v251, s[8:11], s3 offen offset:3072 sc0 sc1
    s_mov_b32 s3, 0x1c43000
    buffer_store_dwordx4 v[8:11], v251, s[8:11], s3 offen offset:0 sc0 sc1
    buffer_store_dwordx4 v[8:11], v251, s[8:11], s3 offen offset:1024 sc0 sc1
    buffer_store_dwordx4 v[8:11], v251, s[8:11], s3 offen offset:2048 sc0 sc1
    buffer_store_dwordx4 v[8:11], v251, s[8:11], s3 offen offset:3072 sc0 sc1
    s_mov_b32 s3, 0x1c44000
    buffer_store_dwordx4 v[8:11], v251, s[8:11], s3 offen offset:0 sc0 sc1
    buffer_store_dwordx4 v[8:11], v251, s[8:11], s3 offen offset:1024 sc0 sc1
    buffer_store_dwordx4 v[8:11], v251, s[8:11], s3 offen offset:2048 sc0 sc1
    buffer_store_dwordx4 v[8:11], v251, s[8:11], s3 offen offset:3072 sc0 sc1
    s_mov_b32 s3, 0x1c45000
    buffer_store_dwordx4 v[8:11], v251, s[8:11], s3 offen offset:0 sc0 sc1
    buffer_store_dwordx4 v[8:11], v251, s[8:11], s3 offen offset:1024 sc0 sc1
    buffer_store_dwordx4 v[8:11], v251, s[8:11], s3 offen offset:2048 sc0 sc1
    buffer_store_dwordx4 v[8:11], v251, s[8:11], s3 offen offset:3072 sc0 sc1
    s_mov_b32 s3, 0x1c46000
    buffer_store_dwordx4 v[8:11], v251, s[8:11], s3 offen offset:0 sc0 sc1
    buffer_store_dwordx4 v[8:11], v251, s[8:11], s3 offen offset:1024 sc0 sc1
    buffer_store_dwordx4 v[8:11], v251, s[8:11], s3 offen offset:2048 sc0 sc1
    buffer_store_dwordx4 v[8:11], v251, s[8:11], s3 offen offset:3072 sc0 sc1
    s_mov_b32 s3, 0x1c47000
    buffer_store_dwordx4 v[8:11], v251, s[8:11], s3 offen offset:0 sc0 sc1
    buffer_store_dwordx4 v[8:11], v251, s[8:11], s3 offen offset:1024 sc0 sc1
    buffer_store_dwordx4 v[8:11], v251, s[8:11], s3 offen offset:2048 sc0 sc1
    buffer_store_dwordx4 v[8:11], v251, s[8:11], s3 offen offset:3072 sc0 sc1
    s_waitcnt vmcnt(0)
    v_mov_b32 v4, 1
    global_store_dword v8, v4, s[50:51] sc0 sc1
Lp0x:
    s_lshr_b32 s58, s22, 1
    s_and_b32 s59, s22, 1
    s_xor_b32 s60, s58, s59
    v_and_b32 v4, 15, v1
    v_lshrrev_b32 v5, 4, v1
    s_lshl_b32 s3, s60, 2
    v_add_u32 v6, s3, v5
    v_lshrrev_b32 v7, 1, v4
    v_xor_b32 v6, v6, v7
    v_lshlrev_b32 v6, 4, v6
    s_lshl_b32 s3, s58, 13
    v_lshlrev_b32 v7, 7, v4
    v_add3_u32 v2, v6, v7, s3
    v_xor_b32 v3, 64, v2
    s_cmp_ge_u32 s24, 12
    s_cselect_b32 s61, 32, 40
    s_cselect_b32 s62, 8, 40
    s_cselect_b32 s63, 32, 160
    s_cselect_b32 s3, 256, 32
    s_mul_i32 s63, s63, s59
    s_add_u32 s63, s63, s3
    v_lshlrev_b32 v6, 3, v5
    v_bfe_u32 v7, v1, 2, 2
    v_add_u32 v6, v6, v7
    v_mul_u32_u24 v6, 320, v6
    v_and_b32 v7, 3, v1
    v_and_b32 v54, 1, v5
    v_lshlrev_b32 v54, 5, v54
    s_mul_i32 s64, s60, 10240
    s_add_u32 s64, s64, 16384
    s_sub_u32 s65, 43008, s64
    s_lshl_b32 s3, s59, 2
    s_add_u32 s3, s3, 0
    s_mul_i32 s3, s3, s61
    v_lshlrev_b32 v55, 3, v7
    v_add_u32 v55, s3, v55
    v_xor_b32 v55, v55, v54
    v_add_u32 v55, v55, v6
    v_add_u32 v44, s64, v55
    v_add_u32 v49, s65, v55
    s_lshl_b32 s3, s59, 2
    s_add_u32 s3, s3, 1
    s_mul_i32 s3, s3, s61
    v_lshlrev_b32 v55, 3, v7
    v_add_u32 v55, s3, v55
    v_xor_b32 v55, v55, v54
    v_add_u32 v55, v55, v6
    v_add_u32 v45, s64, v55
    v_add_u32 v50, s65, v55
    s_lshl_b32 s3, s59, 2
    s_add_u32 s3, s3, 2
    s_mul_i32 s3, s3, s61
    v_lshlrev_b32 v55, 3, v7
    v_add_u32 v55, s3, v55
    v_xor_b32 v55, v55, v54
    v_add_u32 v55, v55, v6
    v_add_u32 v46, s64, v55
    v_add_u32 v51, s65, v55
    s_lshl_b32 s3, s59, 2
    s_add_u32 s3, s3, 3
    s_mul_i32 s3, s3, s61
    v_lshlrev_b32 v55, 3, v7
    v_add_u32 v55, s3, v55
    v_xor_b32 v55, v55, v54
    v_add_u32 v55, v55, v6
    v_add_u32 v47, s64, v55
    v_add_u32 v52, s65, v55
    v_mul_lo_u32 v55, v7, s62
    v_add_u32 v55, s63, v55
    v_xor_b32 v55, v55, v54
    v_add_u32 v55, v55, v6
    v_add_u32 v48, s64, v55
    v_add_u32 v53, s65, v55
    v_mov_b32 v64, 0
    v_mov_b32 v65, 0
    v_mov_b32 v66, 0
    v_mov_b32 v67, 0
    v_mov_b32 v68, 0
    v_mov_b32 v69, 0
    v_mov_b32 v70, 0
    v_mov_b32 v71, 0
    v_mov_b32 v72, 0
    v_mov_b32 v73, 0
    v_mov_b32 v74, 0
    v_mov_b32 v75, 0
    v_mov_b32 v76, 0
    v_mov_b32 v77, 0
    v_mov_b32 v78, 0
    v_mov_b32 v79, 0
    v_mov_b32 v80, 0
    v_mov_b32 v81, 0
    v_mov_b32 v82, 0
    v_mov_b32 v83, 0
    v_mov_b32 v84, 0
    v_mov_b32 v85, 0
    v_mov_b32 v86, 0
    v_mov_b32 v87, 0
    v_mov_b32 v88, 0
    v_mov_b32 v89, 0
    v_mov_b32 v90, 0
    v_mov_b32 v91, 0
    v_mov_b32 v92, 0
    v_mov_b32 v93, 0
    v_mov_b32 v94, 0
    v_mov_b32 v95, 0
    v_mov_b32 v96, 0
    v_mov_b32 v97, 0
    v_mov_b32 v98, 0
    v_mov_b32 v99, 0
    v_mov_b32 v100, 0
    v_mov_b32 v101, 0
    v_mov_b32 v102, 0
    v_mov_b32 v103, 0
    v_mov_b32 v104, 0
    v_mov_b32 v105, 0
    v_mov_b32 v106, 0
    v_mov_b32 v107, 0
    v_mov_b32 v108, 0
    v_mov_b32 v109, 0
    v_mov_b32 v110, 0
    v_mov_b32 v111, 0
    v_mov_b32 v112, 0
    v_mov_b32 v113, 0
    v_mov_b32 v114, 0
    v_mov_b32 v115, 0
    v_mov_b32 v116, 0
    v_mov_b32 v117, 0
    v_mov_b32 v118, 0
    v_mov_b32 v119, 0
    v_mov_b32 v120, 0
    v_mov_b32 v121, 0
    v_mov_b32 v122, 0
    v_mov_b32 v123, 0
    v_mov_b32 v124, 0
    v_mov_b32 v125, 0
    v_mov_b32 v126, 0
    v_mov_b32 v127, 0
    v_mov_b32 v128, 0
    v_mov_b32 v129, 0
    v_mov_b32 v130, 0
    v_mov_b32 v131, 0
    v_mov_b32 v132, 0
    v_mov_b32 v133, 0
    v_mov_b32 v134, 0
    v_mov_b32 v135, 0
    v_mov_b32 v136, 0
    v_mov_b32 v137, 0
    v_mov_b32 v138, 0
    v_mov_b32 v139, 0
    v_mov_b32 v140, 0
    v_mov_b32 v141, 0
    v_mov_b32 v142, 0
    v_mov_b32 v143, 0
    v_mov_b32 v144, 0
    v_mov_b32 v145, 0
    v_mov_b32 v146, 0
    v_mov_b32 v147, 0
    v_mov_b32 v148, 0
    v_mov_b32 v149, 0
    v_mov_b32 v150, 0
    v_mov_b32 v151, 0
    v_mov_b32 v152, 0
    v_mov_b32 v153, 0
    v_mov_b32 v154, 0
    v_mov_b32 v155, 0
    v_mov_b32 v156, 0
    v_mov_b32 v157, 0
    v_mov_b32 v158, 0
    v_mov_b32 v159, 0
    v_mov_b32 v160, 0
    v_mov_b32 v161, 0
    v_mov_b32 v162, 0
    v_mov_b32 v163, 0
    v_mov_b32 v164, 0
    v_mov_b32 v165, 0
    v_mov_b32 v166, 0
    v_mov_b32 v167, 0
    v_mov_b32 v168, 0
    v_mov_b32 v169, 0
    v_mov_b32 v170, 0
    v_mov_b32 v171, 0
    v_mov_b32 v172, 0
    v_mov_b32 v173, 0
    v_mov_b32 v174, 0
    v_mov_b32 v175, 0
    v_mov_b32 v176, 0
    v_mov_b32 v177, 0
    v_mov_b32 v178, 0
    v_mov_b32 v179, 0
    v_mov_b32 v180, 0
    v_mov_b32 v181, 0
    v_mov_b32 v182, 0
    v_mov_b32 v183, 0
    v_mov_b32 v184, 0
    v_mov_b32 v185, 0
    v_mov_b32 v186, 0
    v_mov_b32 v187, 0
    v_mov_b32 v188, 0
    v_mov_b32 v189, 0
    v_mov_b32 v190, 0
    v_mov_b32 v191, 0
    v_mov_b32 v192, 0
    v_mov_b32 v193, 0
    v_mov_b32 v194, 0
    v_mov_b32 v195, 0
    v_mov_b32 v196, 0x3f803f80
    v_mov_b32 v197, 0x3f803f80
    v_mov_b32 v198, 0x3f803f80
    v_mov_b32 v199, 0x3f803f80
    s_mov_b32 s57, 0
    s_mov_b32 s56, 0
    s_cmp_eq_u32 s22, 3
    s_cbranch_scc1 Lpk2b
    s_waitcnt vmcnt(0)
    s_call_b64 s[70:71], Lpk_fin
Lpk2b:
    v_add_u32 v236, 73728, v2
    v_add_u32 v237, 73728, v3
    v_add_u32 v238, 73728, v44
    v_add_u32 v239, 73728, v45
    v_add_u32 v240, 73728, v46
    v_add_u32 v241, 73728, v47
    v_add_u32 v242, 73728, v48
    v_add_u32 v243, 73728, v49
    v_add_u32 v244, 73728, v50
    v_add_u32 v245, 73728, v51
    v_add_u32 v246, 73728, v52
    v_add_u32 v247, 73728, v53
    s_lshr_b32 s3, s24, 2
    s_cmp_eq_u32 s3, 2
    s_cbranch_scc1 Lj1v
Lj1n:
    s_barrier
    ds_read_b128 v[200:203], v2 offset:0
    ds_read_b128 v[204:207], v2 offset:2048
    ds_read_b128 v[208:211], v2 offset:4096
    ds_read_b128 v[212:215], v2 offset:6144
    ds_read_b64_tr_b16 v[216:217], v44 offset:0
    ds_read_b64_tr_b16 v[218:219], v44 offset:1280
    ds_read_b64_tr_b16 v[220:221], v45 offset:0
    ds_read_b64_tr_b16 v[222:223], v45 offset:1280
    ds_read_b64_tr_b16 v[224:225], v46 offset:0
    ds_read_b64_tr_b16 v[226:227], v46 offset:1280
    ds_read_b64_tr_b16 v[228:229], v47 offset:0
    ds_read_b64_tr_b16 v[230:231], v47 offset:1280
    ds_read_b64_tr_b16 v[232:233], v48 offset:0
    ds_read_b64_tr_b16 v[234:235], v48 offset:1280
    s_waitcnt lgkmcnt(0)
    v_mfma_f32_16x16x32_bf16 v[64:67], v[216:219], v[200:203], v[64:67]
    ds_read_b128 v[8:11], v3 offset:0
    v_mfma_f32_16x16x32_bf16 v[84:87], v[216:219], v[204:207], v[84:87]
    ds_read_b128 v[12:15], v3 offset:2048
    v_mfma_f32_16x16x32_bf16 v[104:107], v[216:219], v[208:211], v[104:107]
    ds_read_b128 v[16:19], v3 offset:4096
    v_mfma_f32_16x16x32_bf16 v[124:127], v[216:219], v[212:215], v[124:127]
    ds_read_b128 v[20:23], v3 offset:6144
    v_mfma_f32_16x16x32_bf16 v[68:71], v[220:223], v[200:203], v[68:71]
    ds_read_b64_tr_b16 v[24:25], v49 offset:0
    v_mfma_f32_16x16x32_bf16 v[88:91], v[220:223], v[204:207], v[88:91]
    ds_read_b64_tr_b16 v[26:27], v49 offset:1280
    v_mfma_f32_16x16x32_bf16 v[108:111], v[220:223], v[208:211], v[108:111]
    ds_read_b64_tr_b16 v[28:29], v50 offset:0
    v_mfma_f32_16x16x32_bf16 v[128:131], v[220:223], v[212:215], v[128:131]
    ds_read_b64_tr_b16 v[30:31], v50 offset:1280
    v_mfma_f32_16x16x32_bf16 v[72:75], v[224:227], v[200:203], v[72:75]
    ds_read_b64_tr_b16 v[32:33], v51 offset:0
    v_mfma_f32_16x16x32_bf16 v[92:95], v[224:227], v[204:207], v[92:95]
    ds_read_b64_tr_b16 v[34:35], v51 offset:1280
    v_mfma_f32_16x16x32_bf16 v[112:115], v[224:227], v[208:211], v[112:115]
    ds_read_b64_tr_b16 v[36:37], v52 offset:0
    v_mfma_f32_16x16x32_bf16 v[132:135], v[224:227], v[212:215], v[132:135]
    ds_read_b64_tr_b16 v[38:39], v52 offset:1280
    v_mfma_f32_16x16x32_bf16 v[76:79], v[228:231], v[200:203], v[76:79]
    ds_read_b64_tr_b16 v[40:41], v53 offset:0
    v_mfma_f32_16x16x32_bf16 v[96:99], v[228:231], v[204:207], v[96:99]
    ds_read_b64_tr_b16 v[42:43], v53 offset:1280
    v_mfma_f32_16x16x32_bf16 v[116:119], v[228:231], v[208:211], v[116:119]
    v_mfma_f32_16x16x32_bf16 v[136:139], v[228:231], v[212:215], v[136:139]
    v_mfma_f32_16x16x32_bf16 v[80:83], v[232:235], v[200:203], v[80:83]
    v_mfma_f32_16x16x32_bf16 v[100:103], v[232:235], v[204:207], v[100:103]
    v_mfma_f32_16x16x32_bf16 v[120:123], v[232:235], v[208:211], v[120:123]
    v_mfma_f32_16x16x32_bf16 v[140:143], v[232:235], v[212:215], v[140:143]
    v_mfma_f32_16x16x32_bf16 v[144:147], v[196:199], v[200:203], v[144:147]
    v_mfma_f32_16x16x32_bf16 v[160:163], v[200:203], v[200:203], v[160:163]
    v_mfma_f32_16x16x32_bf16 v[148:151], v[196:199], v[204:207], v[148:151]
    v_mfma_f32_16x16x32_bf16 v[164:167], v[204:207], v[204:207], v[164:167]
    v_mfma_f32_16x16x32_bf16 v[152:155], v[196:199], v[208:211], v[152:155]
    v_mfma_f32_16x16x32_bf16 v[168:171], v[208:211], v[208:211], v[168:171]
    v_mfma_f32_16x16x32_bf16 v[156:159], v[196:199], v[212:215], v[156:159]
    v_mfma_f32_16x16x32_bf16 v[172:175], v[212:215], v[212:215], v[172:175]
    s_waitcnt lgkmcnt(0)
    s_waitcnt vmcnt(0)
    s_barrier
    v_mfma_f32_16x16x32_bf16 v[64:67], v[24:27], v[8:11], v[64:67]
    ds_read_b128 v[200:203], v2 offset:36864
    v_mfma_f32_16x16x32_bf16 v[84:87], v[24:27], v[12:15], v[84:87]
    ds_read_b128 v[204:207], v2 offset:38912
    v_mfma_f32_16x16x32_bf16 v[104:107], v[24:27], v[16:19], v[104:107]
    ds_read_b128 v[208:211], v2 offset:40960
    v_mfma_f32_16x16x32_bf16 v[124:127], v[24:27], v[20:23], v[124:127]
    ds_read_b128 v[212:215], v2 offset:43008
    v_mfma_f32_16x16x32_bf16 v[176:179], v[196:199], v[24:27], v[176:179]
    ds_read_b64_tr_b16 v[216:217], v44 offset:36864
    v_mfma_f32_16x16x32_bf16 v[68:71], v[28:31], v[8:11], v[68:71]
    ds_read_b64_tr_b16 v[218:219], v44 offset:38144
    v_mfma_f32_16x16x32_bf16 v[88:91], v[28:31], v[12:15], v[88:91]
    ds_read_b64_tr_b16 v[220:221], v45 offset:36864
    v_mfma_f32_16x16x32_bf16 v[108:111], v[28:31], v[16:19], v[108:111]
    ds_read_b64_tr_b16 v[222:223], v45 offset:38144
    v_mfma_f32_16x16x32_bf16 v[128:131], v[28:31], v[20:23], v[128:131]
    ds_read_b64_tr_b16 v[224:225], v46 offset:36864
    v_mfma_f32_16x16x32_bf16 v[180:183], v[196:199], v[28:31], v[180:183]
    ds_read_b64_tr_b16 v[226:227], v46 offset:38144
    v_mfma_f32_16x16x32_bf16 v[72:75], v[32:35], v[8:11], v[72:75]
    ds_read_b64_tr_b16 v[228:229], v47 offset:36864
    v_mfma_f32_16x16x32_bf16 v[92:95], v[32:35], v[12:15], v[92:95]
    ds_read_b64_tr_b16 v[230:231], v47 offset:38144
    v_mfma_f32_16x16x32_bf16 v[112:115], v[32:35], v[16:19], v[112:115]
    ds_read_b64_tr_b16 v[232:233], v48 offset:36864
    v_mfma_f32_16x16x32_bf16 v[132:135], v[32:35], v[20:23], v[132:135]
    ds_read_b64_tr_b16 v[234:235], v48 offset:38144
    v_mfma_f32_16x16x32_bf16 v[184:187], v[196:199], v[32:35], v[184:187]
    v_mfma_f32_16x16x32_bf16 v[76:79], v[36:39], v[8:11], v[76:79]
    v_mfma_f32_16x16x32_bf16 v[96:99], v[36:39], v[12:15], v[96:99]
    v_mfma_f32_16x16x32_bf16 v[116:119], v[36:39], v[16:19], v[116:119]
    v_mfma_f32_16x16x32_bf16 v[136:139], v[36:39], v[20:23], v[136:139]
    v_mfma_f32_16x16x32_bf16 v[188:191], v[196:199], v[36:39], v[188:191]
    v_mfma_f32_16x16x32_bf16 v[80:83], v[40:43], v[8:11], v[80:83]
    v_mfma_f32_16x16x32_bf16 v[100:103], v[40:43], v[12:15], v[100:103]
    v_mfma_f32_16x16x32_bf16 v[120:123], v[40:43], v[16:19], v[120:123]
    v_mfma_f32_16x16x32_bf16 v[140:143], v[40:43], v[20:23], v[140:143]
    v_mfma_f32_16x16x32_bf16 v[192:195], v[196:199], v[40:43], v[192:195]
    s_waitcnt lgkmcnt(0)
    v_mfma_f32_16x16x32_bf16 v[64:67], v[216:219], v[200:203], v[64:67]
    ds_read_b128 v[8:11], v3 offset:36864
    v_mfma_f32_16x16x32_bf16 v[84:87], v[216:219], v[204:207], v[84:87]
    ds_read_b128 v[12:15], v3 offset:38912
    v_mfma_f32_16x16x32_bf16 v[104:107], v[216:219], v[208:211], v[104:107]
    ds_read_b128 v[16:19], v3 offset:40960
    v_mfma_f32_16x16x32_bf16 v[124:127], v[216:219], v[212:215], v[124:127]
    ds_read_b128 v[20:23], v3 offset:43008
    v_mfma_f32_16x16x32_bf16 v[68:71], v[220:223], v[200:203], v[68:71]
    ds_read_b64_tr_b16 v[24:25], v49 offset:36864
    v_mfma_f32_16x16x32_bf16 v[88:91], v[220:223], v[204:207], v[88:91]
    ds_read_b64_tr_b16 v[26:27], v49 offset:38144
    v_mfma_f32_16x16x32_bf16 v[108:111], v[220:223], v[208:211], v[108:111]
    ds_read_b64_tr_b16 v[28:29], v50 offset:36864
    v_mfma_f32_16x16x32_bf16 v[128:131], v[220:223], v[212:215], v[128:131]
    ds_read_b64_tr_b16 v[30:31], v50 offset:38144
    v_mfma_f32_16x16x32_bf16 v[72:75], v[224:227], v[200:203], v[72:75]
    ds_read_b64_tr_b16 v[32:33], v51 offset:36864
    v_mfma_f32_16x16x32_bf16 v[92:95], v[224:227], v[204:207], v[92:95]
    ds_read_b64_tr_b16 v[34:35], v51 offset:38144
    v_mfma_f32_16x16x32_bf16 v[112:115], v[224:227], v[208:211], v[112:115]
    ds_read_b64_tr_b16 v[36:37], v52 offset:36864
    v_mfma_f32_16x16x32_bf16 v[132:135], v[224:227], v[212:215], v[132:135]
    ds_read_b64_tr_b16 v[38:39], v52 offset:38144
    v_mfma_f32_16x16x32_bf16 v[76:79], v[228:231], v[200:203], v[76:79]
    ds_read_b64_tr_b16 v[40:41], v53 offset:36864
    v_mfma_f32_16x16x32_bf16 v[96:99], v[228:231], v[204:207], v[96:99]
    ds_read_b64_tr_b16 v[42:43], v53 offset:38144
    v_mfma_f32_16x16x32_bf16 v[116:119], v[228:231], v[208:211], v[116:119]
    v_mfma_f32_16x16x32_bf16 v[136:139], v[228:231], v[212:215], v[136:139]
    v_mfma_f32_16x16x32_bf16 v[80:83], v[232:235], v[200:203], v[80:83]
    v_mfma_f32_16x16x32_bf16 v[100:103], v[232:235], v[204:207], v[100:103]
    v_mfma_f32_16x16x32_bf16 v[120:123], v[232:235], v[208:211], v[120:123]
    v_mfma_f32_16x16x32_bf16 v[140:143], v[232:235], v[212:215], v[140:143]
    v_mfma_f32_16x16x32_bf16 v[144:147], v[196:199], v[200:203], v[144:147]
    v_mfma_f32_16x16x32_bf16 v[160:163], v[200:203], v[200:203], v[160:163]
    v_mfma_f32_16x16x32_bf16 v[148:151], v[196:199], v[204:207], v[148:151]
    v_mfma_f32_16x16x32_bf16 v[164:167], v[204:207], v[204:207], v[164:167]
    v_mfma_f32_16x16x32_bf16 v[152:155], v[196:199], v[208:211], v[152:155]
    v_mfma_f32_16x16x32_bf16 v[168:171], v[208:211], v[208:211], v[168:171]
    v_mfma_f32_16x16x32_bf16 v[156:159], v[196:199], v[212:215], v[156:159]
    v_mfma_f32_16x16x32_bf16 v[172:175], v[212:215], v[212:215], v[172:175]
    s_waitcnt lgkmcnt(0)
    s_barrier
    v_mfma_f32_16x16x32_bf16 v[64:67], v[24:27], v[8:11], v[64:67]
    ds_read_b128 v[200:203], v236 offset:0
    v_mfma_f32_16x16x32_bf16 v[84:87], v[24:27], v[12:15], v[84:87]
    ds_read_b128 v[204:207], v236 offset:2048
    v_mfma_f32_16x16x32_bf16 v[104:107], v[24:27], v[16:19], v[104:107]
    ds_read_b128 v[208:211], v236 offset:4096
    v_mfma_f32_16x16x32_bf16 v[124:127], v[24:27], v[20:23], v[124:127]
    ds_read_b128 v[212:215], v236 offset:6144
    v_mfma_f32_16x16x32_bf16 v[176:179], v[196:199], v[24:27], v[176:179]
    ds_read_b64_tr_b16 v[216:217], v238 offset:0
    v_mfma_f32_16x16x32_bf16 v[68:71], v[28:31], v[8:11], v[68:71]
    ds_read_b64_tr_b16 v[218:219], v238 offset:1280
    v_mfma_f32_16x16x32_bf16 v[88:91], v[28:31], v[12:15], v[88:91]
    ds_read_b64_tr_b16 v[220:221], v239 offset:0
    v_mfma_f32_16x16x32_bf16 v[108:111], v[28:31], v[16:19], v[108:111]
    ds_read_b64_tr_b16 v[222:223], v239 offset:1280
    v_mfma_f32_16x16x32_bf16 v[128:131], v[28:31], v[20:23], v[128:131]
    ds_read_b64_tr_b16 v[224:225], v240 offset:0
    v_mfma_f32_16x16x32_bf16 v[180:183], v[196:199], v[28:31], v[180:183]
    ds_read_b64_tr_b16 v[226:227], v240 offset:1280
    v_mfma_f32_16x16x32_bf16 v[72:75], v[32:35], v[8:11], v[72:75]
    ds_read_b64_tr_b16 v[228:229], v241 offset:0
    v_mfma_f32_16x16x32_bf16 v[92:95], v[32:35], v[12:15], v[92:95]
    ds_read_b64_tr_b16 v[230:231], v241 offset:1280
    v_mfma_f32_16x16x32_bf16 v[112:115], v[32:35], v[16:19], v[112:115]
    ds_read_b64_tr_b16 v[232:233], v242 offset:0
    v_mfma_f32_16x16x32_bf16 v[132:135], v[32:35], v[20:23], v[132:135]
    ds_read_b64_tr_b16 v[234:235], v242 offset:1280
    v_mfma_f32_16x16x32_bf16 v[184:187], v[196:199], v[32:35], v[184:187]
    v_mfma_f32_16x16x32_bf16 v[76:79], v[36:39], v[8:11], v[76:79]
    v_mfma_f32_16x16x32_bf16 v[96:99], v[36:39], v[12:15], v[96:99]
    v_mfma_f32_16x16x32_bf16 v[116:119], v[36:39], v[16:19], v[116:119]
    v_mfma_f32_16x16x32_bf16 v[136:139], v[36:39], v[20:23], v[136:139]
    v_mfma_f32_16x16x32_bf16 v[188:191], v[196:199], v[36:39], v[188:191]
    v_mfma_f32_16x16x32_bf16 v[80:83], v[40:43], v[8:11], v[80:83]
    v_mfma_f32_16x16x32_bf16 v[100:103], v[40:43], v[12:15], v[100:103]
    v_mfma_f32_16x16x32_bf16 v[120:123], v[40:43], v[16:19], v[120:123]
    v_mfma_f32_16x16x32_bf16 v[140:143], v[40:43], v[20:23], v[140:143]
    v_mfma_f32_16x16x32_bf16 v[192:195], v[196:199], v[40:43], v[192:195]
    s_waitcnt lgkmcnt(0)
    v_mfma_f32_16x16x32_bf16 v[64:67], v[216:219], v[200:203], v[64:67]
    ds_read_b128 v[8:11], v237 offset:0
    v_mfma_f32_16x16x32_bf16 v[84:87], v[216:219], v[204:207], v[84:87]
    ds_read_b128 v[12:15], v237 offset:2048
    v_mfma_f32_16x16x32_bf16 v[104:107], v[216:219], v[208:211], v[104:107]
    ds_read_b128 v[16:19], v237 offset:4096
    v_mfma_f32_16x16x32_bf16 v[124:127], v[216:219], v[212:215], v[124:127]
    ds_read_b128 v[20:23], v237 offset:6144
    v_mfma_f32_16x16x32_bf16 v[68:71], v[220:223], v[200:203], v[68:71]
    ds_read_b64_tr_b16 v[24:25], v243 offset:0
    v_mfma_f32_16x16x32_bf16 v[88:91], v[220:223], v[204:207], v[88:91]
    ds_read_b64_tr_b16 v[26:27], v243 offset:1280
    v_mfma_f32_16x16x32_bf16 v[108:111], v[220:223], v[208:211], v[108:111]
    ds_read_b64_tr_b16 v[28:29], v244 offset:0
    v_mfma_f32_16x16x32_bf16 v[128:131], v[220:223], v[212:215], v[128:131]
    ds_read_b64_tr_b16 v[30:31], v244 offset:1280
    v_mfma_f32_16x16x32_bf16 v[72:75], v[224:227], v[200:203], v[72:75]
    ds_read_b64_tr_b16 v[32:33], v245 offset:0
    v_mfma_f32_16x16x32_bf16 v[92:95], v[224:227], v[204:207], v[92:95]
    ds_read_b64_tr_b16 v[34:35], v245 offset:1280
    v_mfma_f32_16x16x32_bf16 v[112:115], v[224:227], v[208:211], v[112:115]
    ds_read_b64_tr_b16 v[36:37], v246 offset:0
    v_mfma_f32_16x16x32_bf16 v[132:135], v[224:227], v[212:215], v[132:135]
    ds_read_b64_tr_b16 v[38:39], v246 offset:1280
    v_mfma_f32_16x16x32_bf16 v[76:79], v[228:231], v[200:203], v[76:79]
    ds_read_b64_tr_b16 v[40:41], v247 offset:0
    v_mfma_f32_16x16x32_bf16 v[96:99], v[228:231], v[204:207], v[96:99]
    ds_read_b64_tr_b16 v[42:43], v247 offset:1280
    v_mfma_f32_16x16x32_bf16 v[116:119], v[228:231], v[208:211], v[116:119]
    v_mfma_f32_16x16x32_bf16 v[136:139], v[228:231], v[212:215], v[136:139]
    v_mfma_f32_16x16x32_bf16 v[80:83], v[232:235], v[200:203], v[80:83]
    v_mfma_f32_16x16x32_bf16 v[100:103], v[232:235], v[204:207], v[100:103]
    v_mfma_f32_16x16x32_bf16 v[120:123], v[232:235], v[208:211], v[120:123]
    v_mfma_f32_16x16x32_bf16 v[140:143], v[232:235], v[212:215], v[140:143]
    v_mfma_f32_16x16x32_bf16 v[144:147], v[196:199], v[200:203], v[144:147]
    v_mfma_f32_16x16x32_bf16 v[160:163], v[200:203], v[200:203], v[160:163]
    v_mfma_f32_16x16x32_bf16 v[148:151], v[196:199], v[204:207], v[148:151]
    v_mfma_f32_16x16x32_bf16 v[164:167], v[204:207], v[204:207], v[164:167]
    v_mfma_f32_16x16x32_bf16 v[152:155], v[196:199], v[208:211], v[152:155]
    v_mfma_f32_16x16x32_bf16 v[168:171], v[208:211], v[208:211], v[168:171]
    v_mfma_f32_16x16x32_bf16 v[156:159], v[196:199], v[212:215], v[156:159]
    v_mfma_f32_16x16x32_bf16 v[172:175], v[212:215], v[212:215], v[172:175]
    s_waitcnt lgkmcnt(0)
    s_barrier
    v_mfma_f32_16x16x32_bf16 v[64:67], v[24:27], v[8:11], v[64:67]
    ds_read_b128 v[200:203], v236 offset:36864
    v_mfma_f32_16x16x32_bf16 v[84:87], v[24:27], v[12:15], v[84:87]
    ds_read_b128 v[204:207], v236 offset:38912
    v_mfma_f32_16x16x32_bf16 v[104:107], v[24:27], v[16:19], v[104:107]
    ds_read_b128 v[208:211], v236 offset:40960
    v_mfma_f32_16x16x32_bf16 v[124:127], v[24:27], v[20:23], v[124:127]
    ds_read_b128 v[212:215], v236 offset:43008
    v_mfma_f32_16x16x32_bf16 v[176:179], v[196:199], v[24:27], v[176:179]
    ds_read_b64_tr_b16 v[216:217], v238 offset:36864
    v_mfma_f32_16x16x32_bf16 v[68:71], v[28:31], v[8:11], v[68:71]
    ds_read_b64_tr_b16 v[218:219], v238 offset:38144
    v_mfma_f32_16x16x32_bf16 v[88:91], v[28:31], v[12:15], v[88:91]
    ds_read_b64_tr_b16 v[220:221], v239 offset:36864
    v_mfma_f32_16x16x32_bf16 v[108:111], v[28:31], v[16:19], v[108:111]
    ds_read_b64_tr_b16 v[222:223], v239 offset:38144
    v_mfma_f32_16x16x32_bf16 v[128:131], v[28:31], v[20:23], v[128:131]
    ds_read_b64_tr_b16 v[224:225], v240 offset:36864
    v_mfma_f32_16x16x32_bf16 v[180:183], v[196:199], v[28:31], v[180:183]
    ds_read_b64_tr_b16 v[226:227], v240 offset:38144
    v_mfma_f32_16x16x32_bf16 v[72:75], v[32:35], v[8:11], v[72:75]
    ds_read_b64_tr_b16 v[228:229], v241 offset:36864
    v_mfma_f32_16x16x32_bf16 v[92:95], v[32:35], v[12:15], v[92:95]
    ds_read_b64_tr_b16 v[230:231], v241 offset:38144
    v_mfma_f32_16x16x32_bf16 v[112:115], v[32:35], v[16:19], v[112:115]
    ds_read_b64_tr_b16 v[232:233], v242 offset:36864
    v_mfma_f32_16x16x32_bf16 v[132:135], v[32:35], v[20:23], v[132:135]
    ds_read_b64_tr_b16 v[234:235], v242 offset:38144
    v_mfma_f32_16x16x32_bf16 v[184:187], v[196:199], v[32:35], v[184:187]
    v_mfma_f32_16x16x32_bf16 v[76:79], v[36:39], v[8:11], v[76:79]
    v_mfma_f32_16x16x32_bf16 v[96:99], v[36:39], v[12:15], v[96:99]
    v_mfma_f32_16x16x32_bf16 v[116:119], v[36:39], v[16:19], v[116:119]
    v_mfma_f32_16x16x32_bf16 v[136:139], v[36:39], v[20:23], v[136:139]
    v_mfma_f32_16x16x32_bf16 v[188:191], v[196:199], v[36:39], v[188:191]
    v_mfma_f32_16x16x32_bf16 v[80:83], v[40:43], v[8:11], v[80:83]
    v_mfma_f32_16x16x32_bf16 v[100:103], v[40:43], v[12:15], v[100:103]
    v_mfma_f32_16x16x32_bf16 v[120:123], v[40:43], v[16:19], v[120:123]
    v_mfma_f32_16x16x32_bf16 v[140:143], v[40:43], v[20:23], v[140:143]
    v_mfma_f32_16x16x32_bf16 v[192:195], v[196:199], v[40:43], v[192:195]
    s_waitcnt lgkmcnt(0)
    v_mfma_f32_16x16x32_bf16 v[64:67], v[216:219], v[200:203], v[64:67]
    ds_read_b128 v[8:11], v237 offset:36864
    v_mfma_f32_16x16x32_bf16 v[84:87], v[216:219], v[204:207], v[84:87]
    ds_read_b128 v[12:15], v237 offset:38912
    v_mfma_f32_16x16x32_bf16 v[104:107], v[216:219], v[208:211], v[104:107]
    ds_read_b128 v[16:19], v237 offset:40960
    v_mfma_f32_16x16x32_bf16 v[124:127], v[216:219], v[212:215], v[124:127]
    ds_read_b128 v[20:23], v237 offset:43008
    v_mfma_f32_16x16x32_bf16 v[68:71], v[220:223], v[200:203], v[68:71]
    ds_read_b64_tr_b16 v[24:25], v243 offset:36864
    v_mfma_f32_16x16x32_bf16 v[88:91], v[220:223], v[204:207], v[88:91]
    ds_read_b64_tr_b16 v[26:27], v243 offset:38144
    v_mfma_f32_16x16x32_bf16 v[108:111], v[220:223], v[208:211], v[108:111]
    ds_read_b64_tr_b16 v[28:29], v244 offset:36864
    v_mfma_f32_16x16x32_bf16 v[128:131], v[220:223], v[212:215], v[128:131]
    ds_read_b64_tr_b16 v[30:31], v244 offset:38144
    v_mfma_f32_16x16x32_bf16 v[72:75], v[224:227], v[200:203], v[72:75]
    ds_read_b64_tr_b16 v[32:33], v245 offset:36864
    v_mfma_f32_16x16x32_bf16 v[92:95], v[224:227], v[204:207], v[92:95]
    ds_read_b64_tr_b16 v[34:35], v245 offset:38144
    v_mfma_f32_16x16x32_bf16 v[112:115], v[224:227], v[208:211], v[112:115]
    ds_read_b64_tr_b16 v[36:37], v246 offset:36864
    v_mfma_f32_16x16x32_bf16 v[132:135], v[224:227], v[212:215], v[132:135]
    ds_read_b64_tr_b16 v[38:39], v246 offset:38144
    v_mfma_f32_16x16x32_bf16 v[76:79], v[228:231], v[200:203], v[76:79]
    ds_read_b64_tr_b16 v[40:41], v247 offset:36864
    v_mfma_f32_16x16x32_bf16 v[96:99], v[228:231], v[204:207], v[96:99]
    ds_read_b64_tr_b16 v[42:43], v247 offset:38144
    v_mfma_f32_16x16x32_bf16 v[116:119], v[228:231], v[208:211], v[116:119]
    v_mfma_f32_16x16x32_bf16 v[136:139], v[228:231], v[212:215], v[136:139]
    v_mfma_f32_16x16x32_bf16 v[80:83], v[232:235], v[200:203], v[80:83]
    v_mfma_f32_16x16x32_bf16 v[100:103], v[232:235], v[204:207], v[100:103]
    v_mfma_f32_16x16x32_bf16 v[120:123], v[232:235], v[208:211], v[120:123]
    v_mfma_f32_16x16x32_bf16 v[140:143], v[232:235], v[212:215], v[140:143]
    v_mfma_f32_16x16x32_bf16 v[144:147], v[196:199], v[200:203], v[144:147]
    v_mfma_f32_16x16x32_bf16 v[160:163], v[200:203], v[200:203], v[160:163]
    v_mfma_f32_16x16x32_bf16 v[148:151], v[196:199], v[204:207], v[148:151]
    v_mfma_f32_16x16x32_bf16 v[164:167], v[204:207], v[204:207], v[164:167]
    v_mfma_f32_16x16x32_bf16 v[152:155], v[196:199], v[208:211], v[152:155]
    v_mfma_f32_16x16x32_bf16 v[168:171], v[208:211], v[208:211], v[168:171]
    v_mfma_f32_16x16x32_bf16 v[156:159], v[196:199], v[212:215], v[156:159]
    v_mfma_f32_16x16x32_bf16 v[172:175], v[212:215], v[212:215], v[172:175]
    s_waitcnt lgkmcnt(0)
    s_barrier
    v_mfma_f32_16x16x32_bf16 v[64:67], v[24:27], v[8:11], v[64:67]
    ds_read_b128 v[200:203], v2 offset:0
    v_mfma_f32_16x16x32_bf16 v[84:87], v[24:27], v[12:15], v[84:87]
    ds_read_b128 v[204:207], v2 offset:2048
    v_mfma_f32_16x16x32_bf16 v[104:107], v[24:27], v[16:19], v[104:107]
    ds_read_b128 v[208:211], v2 offset:4096
    v_mfma_f32_16x16x32_bf16 v[124:127], v[24:27], v[20:23], v[124:127]
    ds_read_b128 v[212:215], v2 offset:6144
    v_mfma_f32_16x16x32_bf16 v[176:179], v[196:199], v[24:27], v[176:179]
    ds_read_b64_tr_b16 v[216:217], v44 offset:0
    v_mfma_f32_16x16x32_bf16 v[68:71], v[28:31], v[8:11], v[68:71]
    ds_read_b64_tr_b16 v[218:219], v44 offset:1280
    v_mfma_f32_16x16x32_bf16 v[88:91], v[28:31], v[12:15], v[88:91]
    ds_read_b64_tr_b16 v[220:221], v45 offset:0
    v_mfma_f32_16x16x32_bf16 v[108:111], v[28:31], v[16:19], v[108:111]
    ds_read_b64_tr_b16 v[222:223], v45 offset:1280
    v_mfma_f32_16x16x32_bf16 v[128:131], v[28:31], v[20:23], v[128:131]
    ds_read_b64_tr_b16 v[224:225], v46 offset:0
    v_mfma_f32_16x16x32_bf16 v[180:183], v[196:199], v[28:31], v[180:183]
    ds_read_b64_tr_b16 v[226:227], v46 offset:1280
    v_mfma_f32_16x16x32_bf16 v[72:75], v[32:35], v[8:11], v[72:75]
    ds_read_b64_tr_b16 v[228:229], v47 offset:0
    v_mfma_f32_16x16x32_bf16 v[92:95], v[32:35], v[12:15], v[92:95]
    ds_read_b64_tr_b16 v[230:231], v47 offset:1280
    v_mfma_f32_16x16x32_bf16 v[112:115], v[32:35], v[16:19], v[112:115]
    ds_read_b64_tr_b16 v[232:233], v48 offset:0
    v_mfma_f32_16x16x32_bf16 v[132:135], v[32:35], v[20:23], v[132:135]
    ds_read_b64_tr_b16 v[234:235], v48 offset:1280
    v_mfma_f32_16x16x32_bf16 v[184:187], v[196:199], v[32:35], v[184:187]
    v_mfma_f32_16x16x32_bf16 v[76:79], v[36:39], v[8:11], v[76:79]
    v_mfma_f32_16x16x32_bf16 v[96:99], v[36:39], v[12:15], v[96:99]
    v_mfma_f32_16x16x32_bf16 v[116:119], v[36:39], v[16:19], v[116:119]
    v_mfma_f32_16x16x32_bf16 v[136:139], v[36:39], v[20:23], v[136:139]
    v_mfma_f32_16x16x32_bf16 v[188:191], v[196:199], v[36:39], v[188:191]
    v_mfma_f32_16x16x32_bf16 v[80:83], v[40:43], v[8:11], v[80:83]
    v_mfma_f32_16x16x32_bf16 v[100:103], v[40:43], v[12:15], v[100:103]
    v_mfma_f32_16x16x32_bf16 v[120:123], v[40:43], v[16:19], v[120:123]
    v_mfma_f32_16x16x32_bf16 v[140:143], v[40:43], v[20:23], v[140:143]
    v_mfma_f32_16x16x32_bf16 v[192:195], v[196:199], v[40:43], v[192:195]
    s_waitcnt lgkmcnt(0)
    v_mfma_f32_16x16x32_bf16 v[64:67], v[216:219], v[200:203], v[64:67]
    ds_read_b128 v[8:11], v3 offset:0
    v_mfma_f32_16x16x32_bf16 v[84:87], v[216:219], v[204:207], v[84:87]
    ds_read_b128 v[12:15], v3 offset:2048
    v_mfma_f32_16x16x32_bf16 v[104:107], v[216:219], v[208:211], v[104:107]
    ds_read_b128 v[16:19], v3 offset:4096
    v_mfma_f32_16x16x32_bf16 v[124:127], v[216:219], v[212:215], v[124:127]
    ds_read_b128 v[20:23], v3 offset:6144
    v_mfma_f32_16x16x32_bf16 v[68:71], v[220:223], v[200:203], v[68:71]
    ds_read_b64_tr_b16 v[24:25], v49 offset:0
    v_mfma_f32_16x16x32_bf16 v[88:91], v[220:223], v[204:207], v[88:91]
    ds_read_b64_tr_b16 v[26:27], v49 offset:1280
    v_mfma_f32_16x16x32_bf16 v[108:111], v[220:223], v[208:211], v[108:111]
    ds_read_b64_tr_b16 v[28:29], v50 offset:0
    v_mfma_f32_16x16x32_bf16 v[128:131], v[220:223], v[212:215], v[128:131]
    ds_read_b64_tr_b16 v[30:31], v50 offset:1280
    v_mfma_f32_16x16x32_bf16 v[72:75], v[224:227], v[200:203], v[72:75]
    ds_read_b64_tr_b16 v[32:33], v51 offset:0
    v_mfma_f32_16x16x32_bf16 v[92:95], v[224:227], v[204:207], v[92:95]
    ds_read_b64_tr_b16 v[34:35], v51 offset:1280
    v_mfma_f32_16x16x32_bf16 v[112:115], v[224:227], v[208:211], v[112:115]
    ds_read_b64_tr_b16 v[36:37], v52 offset:0
    v_mfma_f32_16x16x32_bf16 v[132:135], v[224:227], v[212:215], v[132:135]
    ds_read_b64_tr_b16 v[38:39], v52 offset:1280
    v_mfma_f32_16x16x32_bf16 v[76:79], v[228:231], v[200:203], v[76:79]
    ds_read_b64_tr_b16 v[40:41], v53 offset:0
    v_mfma_f32_16x16x32_bf16 v[96:99], v[228:231], v[204:207], v[96:99]
    ds_read_b64_tr_b16 v[42:43], v53 offset:1280
    v_mfma_f32_16x16x32_bf16 v[116:119], v[228:231], v[208:211], v[116:119]
    v_mfma_f32_16x16x32_bf16 v[136:139], v[228:231], v[212:215], v[136:139]
    v_mfma_f32_16x16x32_bf16 v[80:83], v[232:235], v[200:203], v[80:83]
    v_mfma_f32_16x16x32_bf16 v[100:103], v[232:235], v[204:207], v[100:103]
    v_mfma_f32_16x16x32_bf16 v[120:123], v[232:235], v[208:211], v[120:123]
    v_mfma_f32_16x16x32_bf16 v[140:143], v[232:235], v[212:215], v[140:143]
    v_mfma_f32_16x16x32_bf16 v[144:147], v[196:199], v[200:203], v[144:147]
    v_mfma_f32_16x16x32_bf16 v[160:163], v[200:203], v[200:203], v[160:163]
    v_mfma_f32_16x16x32_bf16 v[148:151], v[196:199], v[204:207], v[148:151]
    v_mfma_f32_16x16x32_bf16 v[164:167], v[204:207], v[204:207], v[164:167]
    v_mfma_f32_16x16x32_bf16 v[152:155], v[196:199], v[208:211], v[152:155]
    v_mfma_f32_16x16x32_bf16 v[168:171], v[208:211], v[208:211], v[168:171]
    v_mfma_f32_16x16x32_bf16 v[156:159], v[196:199], v[212:215], v[156:159]
    v_mfma_f32_16x16x32_bf16 v[172:175], v[212:215], v[212:215], v[172:175]
    s_waitcnt lgkmcnt(0)
    s_barrier
    v_mfma_f32_16x16x32_bf16 v[64:67], v[24:27], v[8:11], v[64:67]
    ds_read_b128 v[200:203], v2 offset:36864
    v_mfma_f32_16x16x32_bf16 v[84:87], v[24:27], v[12:15], v[84:87]
    ds_read_b128 v[204:207], v2 offset:38912
    v_mfma_f32_16x16x32_bf16 v[104:107], v[24:27], v[16:19], v[104:107]
    ds_read_b128 v[208:211], v2 offset:40960
    v_mfma_f32_16x16x32_bf16 v[124:127], v[24:27], v[20:23], v[124:127]
    ds_read_b128 v[212:215], v2 offset:43008
    v_mfma_f32_16x16x32_bf16 v[176:179], v[196:199], v[24:27], v[176:179]
    ds_read_b64_tr_b16 v[216:217], v44 offset:36864
    v_mfma_f32_16x16x32_bf16 v[68:71], v[28:31], v[8:11], v[68:71]
    ds_read_b64_tr_b16 v[218:219], v44 offset:38144
    v_mfma_f32_16x16x32_bf16 v[88:91], v[28:31], v[12:15], v[88:91]
    ds_read_b64_tr_b16 v[220:221], v45 offset:36864
    v_mfma_f32_16x16x32_bf16 v[108:111], v[28:31], v[16:19], v[108:111]
    ds_read_b64_tr_b16 v[222:223], v45 offset:38144
    v_mfma_f32_16x16x32_bf16 v[128:131], v[28:31], v[20:23], v[128:131]
    ds_read_b64_tr_b16 v[224:225], v46 offset:36864
    v_mfma_f32_16x16x32_bf16 v[180:183], v[196:199], v[28:31], v[180:183]
    ds_read_b64_tr_b16 v[226:227], v46 offset:38144
    v_mfma_f32_16x16x32_bf16 v[72:75], v[32:35], v[8:11], v[72:75]
    ds_read_b64_tr_b16 v[228:229], v47 offset:36864
    v_mfma_f32_16x16x32_bf16 v[92:95], v[32:35], v[12:15], v[92:95]
    ds_read_b64_tr_b16 v[230:231], v47 offset:38144
    v_mfma_f32_16x16x32_bf16 v[112:115], v[32:35], v[16:19], v[112:115]
    ds_read_b64_tr_b16 v[232:233], v48 offset:36864
    v_mfma_f32_16x16x32_bf16 v[132:135], v[32:35], v[20:23], v[132:135]
    ds_read_b64_tr_b16 v[234:235], v48 offset:38144
    v_mfma_f32_16x16x32_bf16 v[184:187], v[196:199], v[32:35], v[184:187]
    v_mfma_f32_16x16x32_bf16 v[76:79], v[36:39], v[8:11], v[76:79]
    v_mfma_f32_16x16x32_bf16 v[96:99], v[36:39], v[12:15], v[96:99]
    v_mfma_f32_16x16x32_bf16 v[116:119], v[36:39], v[16:19], v[116:119]
    v_mfma_f32_16x16x32_bf16 v[136:139], v[36:39], v[20:23], v[136:139]
    v_mfma_f32_16x16x32_bf16 v[188:191], v[196:199], v[36:39], v[188:191]
    v_mfma_f32_16x16x32_bf16 v[80:83], v[40:43], v[8:11], v[80:83]
    v_mfma_f32_16x16x32_bf16 v[100:103], v[40:43], v[12:15], v[100:103]
    v_mfma_f32_16x16x32_bf16 v[120:123], v[40:43], v[16:19], v[120:123]
    v_mfma_f32_16x16x32_bf16 v[140:143], v[40:43], v[20:23], v[140:143]
    v_mfma_f32_16x16x32_bf16 v[192:195], v[196:199], v[40:43], v[192:195]
    s_waitcnt lgkmcnt(0)
    v_mfma_f32_16x16x32_bf16 v[64:67], v[216:219], v[200:203], v[64:67]
    ds_read_b128 v[8:11], v3 offset:36864
    v_mfma_f32_16x16x32_bf16 v[84:87], v[216:219], v[204:207], v[84:87]
    ds_read_b128 v[12:15], v3 offset:38912
    v_mfma_f32_16x16x32_bf16 v[104:107], v[216:219], v[208:211], v[104:107]
    ds_read_b128 v[16:19], v3 offset:40960
    v_mfma_f32_16x16x32_bf16 v[124:127], v[216:219], v[212:215], v[124:127]
    ds_read_b128 v[20:23], v3 offset:43008
    v_mfma_f32_16x16x32_bf16 v[68:71], v[220:223], v[200:203], v[68:71]
    ds_read_b64_tr_b16 v[24:25], v49 offset:36864
    v_mfma_f32_16x16x32_bf16 v[88:91], v[220:223], v[204:207], v[88:91]
    ds_read_b64_tr_b16 v[26:27], v49 offset:38144
    v_mfma_f32_16x16x32_bf16 v[108:111], v[220:223], v[208:211], v[108:111]
    ds_read_b64_tr_b16 v[28:29], v50 offset:36864
    v_mfma_f32_16x16x32_bf16 v[128:131], v[220:223], v[212:215], v[128:131]
    ds_read_b64_tr_b16 v[30:31], v50 offset:38144
    v_mfma_f32_16x16x32_bf16 v[72:75], v[224:227], v[200:203], v[72:75]
    ds_read_b64_tr_b16 v[32:33], v51 offset:36864
    v_mfma_f32_16x16x32_bf16 v[92:95], v[224:227], v[204:207], v[92:95]
    ds_read_b64_tr_b16 v[34:35], v51 offset:38144
    v_mfma_f32_16x16x32_bf16 v[112:115], v[224:227], v[208:211], v[112:115]
    ds_read_b64_tr_b16 v[36:37], v52 offset:36864
    v_mfma_f32_16x16x32_bf16 v[132:135], v[224:227], v[212:215], v[132:135]
    ds_read_b64_tr_b16 v[38:39], v52 offset:38144
    v_mfma_f32_16x16x32_bf16 v[76:79], v[228:231], v[200:203], v[76:79]
    ds_read_b64_tr_b16 v[40:41], v53 offset:36864
    v_mfma_f32_16x16x32_bf16 v[96:99], v[228:231], v[204:207], v[96:99]
    ds_read_b64_tr_b16 v[42:43], v53 offset:38144
    v_mfma_f32_16x16x32_bf16 v[116:119], v[228:231], v[208:211], v[116:119]
    v_mfma_f32_16x16x32_bf16 v[136:139], v[228:231], v[212:215], v[136:139]
    v_mfma_f32_16x16x32_bf16 v[80:83], v[232:235], v[200:203], v[80:83]
    v_mfma_f32_16x16x32_bf16 v[100:103], v[232:235], v[204:207], v[100:103]
    v_mfma_f32_16x16x32_bf16 v[120:123], v[232:235], v[208:211], v[120:123]
    v_mfma_f32_16x16x32_bf16 v[140:143], v[232:235], v[212:215], v[140:143]
    v_mfma_f32_16x16x32_bf16 v[144:147], v[196:199], v[200:203], v[144:147]
    v_mfma_f32_16x16x32_bf16 v[160:163], v[200:203], v[200:203], v[160:163]
    v_mfma_f32_16x16x32_bf16 v[148:151], v[196:199], v[204:207], v[148:151]
    v_mfma_f32_16x16x32_bf16 v[164:167], v[204:207], v[204:207], v[164:167]
    v_mfma_f32_16x16x32_bf16 v[152:155], v[196:199], v[208:211], v[152:155]
    v_mfma_f32_16x16x32_bf16 v[168:171], v[208:211], v[208:211], v[168:171]
    v_mfma_f32_16x16x32_bf16 v[156:159], v[196:199], v[212:215], v[156:159]
    v_mfma_f32_16x16x32_bf16 v[172:175], v[212:215], v[212:215], v[172:175]
    s_waitcnt lgkmcnt(0)
    s_barrier
    v_mfma_f32_16x16x32_bf16 v[64:67], v[24:27], v[8:11], v[64:67]
    ds_read_b128 v[200:203], v236 offset:0
    v_mfma_f32_16x16x32_bf16 v[84:87], v[24:27], v[12:15], v[84:87]
    ds_read_b128 v[204:207], v236 offset:2048
    v_mfma_f32_16x16x32_bf16 v[104:107], v[24:27], v[16:19], v[104:107]
    ds_read_b128 v[208:211], v236 offset:4096
    v_mfma_f32_16x16x32_bf16 v[124:127], v[24:27], v[20:23], v[124:127]
    ds_read_b128 v[212:215], v236 offset:6144
    v_mfma_f32_16x16x32_bf16 v[176:179], v[196:199], v[24:27], v[176:179]
    ds_read_b64_tr_b16 v[216:217], v238 offset:0
    v_mfma_f32_16x16x32_bf16 v[68:71], v[28:31], v[8:11], v[68:71]
    ds_read_b64_tr_b16 v[218:219], v238 offset:1280
    v_mfma_f32_16x16x32_bf16 v[88:91], v[28:31], v[12:15], v[88:91]
    ds_read_b64_tr_b16 v[220:221], v239 offset:0
    v_mfma_f32_16x16x32_bf16 v[108:111], v[28:31], v[16:19], v[108:111]
    ds_read_b64_tr_b16 v[222:223], v239 offset:1280
    v_mfma_f32_16x16x32_bf16 v[128:131], v[28:31], v[20:23], v[128:131]
    ds_read_b64_tr_b16 v[224:225], v240 offset:0
    v_mfma_f32_16x16x32_bf16 v[180:183], v[196:199], v[28:31], v[180:183]
    ds_read_b64_tr_b16 v[226:227], v240 offset:1280
    v_mfma_f32_16x16x32_bf16 v[72:75], v[32:35], v[8:11], v[72:75]
    ds_read_b64_tr_b16 v[228:229], v241 offset:0
    v_mfma_f32_16x16x32_bf16 v[92:95], v[32:35], v[12:15], v[92:95]
    ds_read_b64_tr_b16 v[230:231], v241 offset:1280
    v_mfma_f32_16x16x32_bf16 v[112:115], v[32:35], v[16:19], v[112:115]
    ds_read_b64_tr_b16 v[232:233], v242 offset:0
    v_mfma_f32_16x16x32_bf16 v[132:135], v[32:35], v[20:23], v[132:135]
    ds_read_b64_tr_b16 v[234:235], v242 offset:1280
    v_mfma_f32_16x16x32_bf16 v[184:187], v[196:199], v[32:35], v[184:187]
    v_mfma_f32_16x16x32_bf16 v[76:79], v[36:39], v[8:11], v[76:79]
    v_mfma_f32_16x16x32_bf16 v[96:99], v[36:39], v[12:15], v[96:99]
    v_mfma_f32_16x16x32_bf16 v[116:119], v[36:39], v[16:19], v[116:119]
    v_mfma_f32_16x16x32_bf16 v[136:139], v[36:39], v[20:23], v[136:139]
    v_mfma_f32_16x16x32_bf16 v[188:191], v[196:199], v[36:39], v[188:191]
    v_mfma_f32_16x16x32_bf16 v[80:83], v[40:43], v[8:11], v[80:83]
    v_mfma_f32_16x16x32_bf16 v[100:103], v[40:43], v[12:15], v[100:103]
    v_mfma_f32_16x16x32_bf16 v[120:123], v[40:43], v[16:19], v[120:123]
    v_mfma_f32_16x16x32_bf16 v[140:143], v[40:43], v[20:23], v[140:143]
    v_mfma_f32_16x16x32_bf16 v[192:195], v[196:199], v[40:43], v[192:195]
    s_waitcnt lgkmcnt(0)
    v_mfma_f32_16x16x32_bf16 v[64:67], v[216:219], v[200:203], v[64:67]
    ds_read_b128 v[8:11], v237 offset:0
    v_mfma_f32_16x16x32_bf16 v[84:87], v[216:219], v[204:207], v[84:87]
    ds_read_b128 v[12:15], v237 offset:2048
    v_mfma_f32_16x16x32_bf16 v[104:107], v[216:219], v[208:211], v[104:107]
    ds_read_b128 v[16:19], v237 offset:4096
    v_mfma_f32_16x16x32_bf16 v[124:127], v[216:219], v[212:215], v[124:127]
    ds_read_b128 v[20:23], v237 offset:6144
    v_mfma_f32_16x16x32_bf16 v[68:71], v[220:223], v[200:203], v[68:71]
    ds_read_b64_tr_b16 v[24:25], v243 offset:0
    v_mfma_f32_16x16x32_bf16 v[88:91], v[220:223], v[204:207], v[88:91]
    ds_read_b64_tr_b16 v[26:27], v243 offset:1280
    v_mfma_f32_16x16x32_bf16 v[108:111], v[220:223], v[208:211], v[108:111]
    ds_read_b64_tr_b16 v[28:29], v244 offset:0
    v_mfma_f32_16x16x32_bf16 v[128:131], v[220:223], v[212:215], v[128:131]
    ds_read_b64_tr_b16 v[30:31], v244 offset:1280
    v_mfma_f32_16x16x32_bf16 v[72:75], v[224:227], v[200:203], v[72:75]
    ds_read_b64_tr_b16 v[32:33], v245 offset:0
    v_mfma_f32_16x16x32_bf16 v[92:95], v[224:227], v[204:207], v[92:95]
    ds_read_b64_tr_b16 v[34:35], v245 offset:1280
    v_mfma_f32_16x16x32_bf16 v[112:115], v[224:227], v[208:211], v[112:115]
    ds_read_b64_tr_b16 v[36:37], v246 offset:0
    v_mfma_f32_16x16x32_bf16 v[132:135], v[224:227], v[212:215], v[132:135]
    ds_read_b64_tr_b16 v[38:39], v246 offset:1280
    v_mfma_f32_16x16x32_bf16 v[76:79], v[228:231], v[200:203], v[76:79]
    ds_read_b64_tr_b16 v[40:41], v247 offset:0
    v_mfma_f32_16x16x32_bf16 v[96:99], v[228:231], v[204:207], v[96:99]
    ds_read_b64_tr_b16 v[42:43], v247 offset:1280
    v_mfma_f32_16x16x32_bf16 v[116:119], v[228:231], v[208:211], v[116:119]
    v_mfma_f32_16x16x32_bf16 v[136:139], v[228:231], v[212:215], v[136:139]
    v_mfma_f32_16x16x32_bf16 v[80:83], v[232:235], v[200:203], v[80:83]
    v_mfma_f32_16x16x32_bf16 v[100:103], v[232:235], v[204:207], v[100:103]
    v_mfma_f32_16x16x32_bf16 v[120:123], v[232:235], v[208:211], v[120:123]
    v_mfma_f32_16x16x32_bf16 v[140:143], v[232:235], v[212:215], v[140:143]
    v_mfma_f32_16x16x32_bf16 v[144:147], v[196:199], v[200:203], v[144:147]
    v_mfma_f32_16x16x32_bf16 v[160:163], v[200:203], v[200:203], v[160:163]
    v_mfma_f32_16x16x32_bf16 v[148:151], v[196:199], v[204:207], v[148:151]
    v_mfma_f32_16x16x32_bf16 v[164:167], v[204:207], v[204:207], v[164:167]
    v_mfma_f32_16x16x32_bf16 v[152:155], v[196:199], v[208:211], v[152:155]
    v_mfma_f32_16x16x32_bf16 v[168:171], v[208:211], v[208:211], v[168:171]
    v_mfma_f32_16x16x32_bf16 v[156:159], v[196:199], v[212:215], v[156:159]
    v_mfma_f32_16x16x32_bf16 v[172:175], v[212:215], v[212:215], v[172:175]
    s_waitcnt lgkmcnt(0)
    s_barrier
    v_mfma_f32_16x16x32_bf16 v[64:67], v[24:27], v[8:11], v[64:67]
    ds_read_b128 v[200:203], v236 offset:36864
    v_mfma_f32_16x16x32_bf16 v[84:87], v[24:27], v[12:15], v[84:87]
    ds_read_b128 v[204:207], v236 offset:38912
    v_mfma_f32_16x16x32_bf16 v[104:107], v[24:27], v[16:19], v[104:107]
    ds_read_b128 v[208:211], v236 offset:40960
    v_mfma_f32_16x16x32_bf16 v[124:127], v[24:27], v[20:23], v[124:127]
    ds_read_b128 v[212:215], v236 offset:43008
    v_mfma_f32_16x16x32_bf16 v[176:179], v[196:199], v[24:27], v[176:179]
    ds_read_b64_tr_b16 v[216:217], v238 offset:36864
    v_mfma_f32_16x16x32_bf16 v[68:71], v[28:31], v[8:11], v[68:71]
    ds_read_b64_tr_b16 v[218:219], v238 offset:38144
    v_mfma_f32_16x16x32_bf16 v[88:91], v[28:31], v[12:15], v[88:91]
    ds_read_b64_tr_b16 v[220:221], v239 offset:36864
    v_mfma_f32_16x16x32_bf16 v[108:111], v[28:31], v[16:19], v[108:111]
    ds_read_b64_tr_b16 v[222:223], v239 offset:38144
    v_mfma_f32_16x16x32_bf16 v[128:131], v[28:31], v[20:23], v[128:131]
    ds_read_b64_tr_b16 v[224:225], v240 offset:36864
    v_mfma_f32_16x16x32_bf16 v[180:183], v[196:199], v[28:31], v[180:183]
    ds_read_b64_tr_b16 v[226:227], v240 offset:38144
    v_mfma_f32_16x16x32_bf16 v[72:75], v[32:35], v[8:11], v[72:75]
    ds_read_b64_tr_b16 v[228:229], v241 offset:36864
    v_mfma_f32_16x16x32_bf16 v[92:95], v[32:35], v[12:15], v[92:95]
    ds_read_b64_tr_b16 v[230:231], v241 offset:38144
    v_mfma_f32_16x16x32_bf16 v[112:115], v[32:35], v[16:19], v[112:115]
    ds_read_b64_tr_b16 v[232:233], v242 offset:36864
    v_mfma_f32_16x16x32_bf16 v[132:135], v[32:35], v[20:23], v[132:135]
    ds_read_b64_tr_b16 v[234:235], v242 offset:38144
    v_mfma_f32_16x16x32_bf16 v[184:187], v[196:199], v[32:35], v[184:187]
    v_mfma_f32_16x16x32_bf16 v[76:79], v[36:39], v[8:11], v[76:79]
    v_mfma_f32_16x16x32_bf16 v[96:99], v[36:39], v[12:15], v[96:99]
    v_mfma_f32_16x16x32_bf16 v[116:119], v[36:39], v[16:19], v[116:119]
    v_mfma_f32_16x16x32_bf16 v[136:139], v[36:39], v[20:23], v[136:139]
    v_mfma_f32_16x16x32_bf16 v[188:191], v[196:199], v[36:39], v[188:191]
    v_mfma_f32_16x16x32_bf16 v[80:83], v[40:43], v[8:11], v[80:83]
    v_mfma_f32_16x16x32_bf16 v[100:103], v[40:43], v[12:15], v[100:103]
    v_mfma_f32_16x16x32_bf16 v[120:123], v[40:43], v[16:19], v[120:123]
    v_mfma_f32_16x16x32_bf16 v[140:143], v[40:43], v[20:23], v[140:143]
    v_mfma_f32_16x16x32_bf16 v[192:195], v[196:199], v[40:43], v[192:195]
    s_waitcnt lgkmcnt(0)
    v_mfma_f32_16x16x32_bf16 v[64:67], v[216:219], v[200:203], v[64:67]
    ds_read_b128 v[8:11], v237 offset:36864
    v_mfma_f32_16x16x32_bf16 v[84:87], v[216:219], v[204:207], v[84:87]
    ds_read_b128 v[12:15], v237 offset:38912
    v_mfma_f32_16x16x32_bf16 v[104:107], v[216:219], v[208:211], v[104:107]
    ds_read_b128 v[16:19], v237 offset:40960
    v_mfma_f32_16x16x32_bf16 v[124:127], v[216:219], v[212:215], v[124:127]
    ds_read_b128 v[20:23], v237 offset:43008
    v_mfma_f32_16x16x32_bf16 v[68:71], v[220:223], v[200:203], v[68:71]
    ds_read_b64_tr_b16 v[24:25], v243 offset:36864
    v_mfma_f32_16x16x32_bf16 v[88:91], v[220:223], v[204:207], v[88:91]
    ds_read_b64_tr_b16 v[26:27], v243 offset:38144
    v_mfma_f32_16x16x32_bf16 v[108:111], v[220:223], v[208:211], v[108:111]
    ds_read_b64_tr_b16 v[28:29], v244 offset:36864
    v_mfma_f32_16x16x32_bf16 v[128:131], v[220:223], v[212:215], v[128:131]
    ds_read_b64_tr_b16 v[30:31], v244 offset:38144
    v_mfma_f32_16x16x32_bf16 v[72:75], v[224:227], v[200:203], v[72:75]
    ds_read_b64_tr_b16 v[32:33], v245 offset:36864
    v_mfma_f32_16x16x32_bf16 v[92:95], v[224:227], v[204:207], v[92:95]
    ds_read_b64_tr_b16 v[34:35], v245 offset:38144
    v_mfma_f32_16x16x32_bf16 v[112:115], v[224:227], v[208:211], v[112:115]
    ds_read_b64_tr_b16 v[36:37], v246 offset:36864
    v_mfma_f32_16x16x32_bf16 v[132:135], v[224:227], v[212:215], v[132:135]
    ds_read_b64_tr_b16 v[38:39], v246 offset:38144
    v_mfma_f32_16x16x32_bf16 v[76:79], v[228:231], v[200:203], v[76:79]
    ds_read_b64_tr_b16 v[40:41], v247 offset:36864
    v_mfma_f32_16x16x32_bf16 v[96:99], v[228:231], v[204:207], v[96:99]
    ds_read_b64_tr_b16 v[42:43], v247 offset:38144
    v_mfma_f32_16x16x32_bf16 v[116:119], v[228:231], v[208:211], v[116:119]
    v_mfma_f32_16x16x32_bf16 v[136:139], v[228:231], v[212:215], v[136:139]
    v_mfma_f32_16x16x32_bf16 v[80:83], v[232:235], v[200:203], v[80:83]
    v_mfma_f32_16x16x32_bf16 v[100:103], v[232:235], v[204:207], v[100:103]
    v_mfma_f32_16x16x32_bf16 v[120:123], v[232:235], v[208:211], v[120:123]
    v_mfma_f32_16x16x32_bf16 v[140:143], v[232:235], v[212:215], v[140:143]
    v_mfma_f32_16x16x32_bf16 v[144:147], v[196:199], v[200:203], v[144:147]
    v_mfma_f32_16x16x32_bf16 v[160:163], v[200:203], v[200:203], v[160:163]
    v_mfma_f32_16x16x32_bf16 v[148:151], v[196:199], v[204:207], v[148:151]
    v_mfma_f32_16x16x32_bf16 v[164:167], v[204:207], v[204:207], v[164:167]
    v_mfma_f32_16x16x32_bf16 v[152:155], v[196:199], v[208:211], v[152:155]
    v_mfma_f32_16x16x32_bf16 v[168:171], v[208:211], v[208:211], v[168:171]
    v_mfma_f32_16x16x32_bf16 v[156:159], v[196:199], v[212:215], v[156:159]
    v_mfma_f32_16x16x32_bf16 v[172:175], v[212:215], v[212:215], v[172:175]
    s_waitcnt lgkmcnt(0)
    s_barrier
    v_mfma_f32_16x16x32_bf16 v[64:67], v[24:27], v[8:11], v[64:67]
    ds_read_b128 v[200:203], v2 offset:0
    v_mfma_f32_16x16x32_bf16 v[84:87], v[24:27], v[12:15], v[84:87]
    ds_read_b128 v[204:207], v2 offset:2048
    v_mfma_f32_16x16x32_bf16 v[104:107], v[24:27], v[16:19], v[104:107]
    ds_read_b128 v[208:211], v2 offset:4096
    v_mfma_f32_16x16x32_bf16 v[124:127], v[24:27], v[20:23], v[124:127]
    ds_read_b128 v[212:215], v2 offset:6144
    v_mfma_f32_16x16x32_bf16 v[176:179], v[196:199], v[24:27], v[176:179]
    ds_read_b64_tr_b16 v[216:217], v44 offset:0
    v_mfma_f32_16x16x32_bf16 v[68:71], v[28:31], v[8:11], v[68:71]
    ds_read_b64_tr_b16 v[218:219], v44 offset:1280
    v_mfma_f32_16x16x32_bf16 v[88:91], v[28:31], v[12:15], v[88:91]
    ds_read_b64_tr_b16 v[220:221], v45 offset:0
    v_mfma_f32_16x16x32_bf16 v[108:111], v[28:31], v[16:19], v[108:111]
    ds_read_b64_tr_b16 v[222:223], v45 offset:1280
    v_mfma_f32_16x16x32_bf16 v[128:131], v[28:31], v[20:23], v[128:131]
    ds_read_b64_tr_b16 v[224:225], v46 offset:0
    v_mfma_f32_16x16x32_bf16 v[180:183], v[196:199], v[28:31], v[180:183]
    ds_read_b64_tr_b16 v[226:227], v46 offset:1280
    v_mfma_f32_16x16x32_bf16 v[72:75], v[32:35], v[8:11], v[72:75]
    ds_read_b64_tr_b16 v[228:229], v47 offset:0
    v_mfma_f32_16x16x32_bf16 v[92:95], v[32:35], v[12:15], v[92:95]
    ds_read_b64_tr_b16 v[230:231], v47 offset:1280
    v_mfma_f32_16x16x32_bf16 v[112:115], v[32:35], v[16:19], v[112:115]
    ds_read_b64_tr_b16 v[232:233], v48 offset:0
    v_mfma_f32_16x16x32_bf16 v[132:135], v[32:35], v[20:23], v[132:135]
    ds_read_b64_tr_b16 v[234:235], v48 offset:1280
    v_mfma_f32_16x16x32_bf16 v[184:187], v[196:199], v[32:35], v[184:187]
    v_mfma_f32_16x16x32_bf16 v[76:79], v[36:39], v[8:11], v[76:79]
    v_mfma_f32_16x16x32_bf16 v[96:99], v[36:39], v[12:15], v[96:99]
    v_mfma_f32_16x16x32_bf16 v[116:119], v[36:39], v[16:19], v[116:119]
    v_mfma_f32_16x16x32_bf16 v[136:139], v[36:39], v[20:23], v[136:139]
    v_mfma_f32_16x16x32_bf16 v[188:191], v[196:199], v[36:39], v[188:191]
    v_mfma_f32_16x16x32_bf16 v[80:83], v[40:43], v[8:11], v[80:83]
    v_mfma_f32_16x16x32_bf16 v[100:103], v[40:43], v[12:15], v[100:103]
    v_mfma_f32_16x16x32_bf16 v[120:123], v[40:43], v[16:19], v[120:123]
    v_mfma_f32_16x16x32_bf16 v[140:143], v[40:43], v[20:23], v[140:143]
    v_mfma_f32_16x16x32_bf16 v[192:195], v[196:199], v[40:43], v[192:195]
    s_waitcnt lgkmcnt(0)
    v_mfma_f32_16x16x32_bf16 v[64:67], v[216:219], v[200:203], v[64:67]
    ds_read_b128 v[8:11], v3 offset:0
    v_mfma_f32_16x16x32_bf16 v[84:87], v[216:219], v[204:207], v[84:87]
    ds_read_b128 v[12:15], v3 offset:2048
    v_mfma_f32_16x16x32_bf16 v[104:107], v[216:219], v[208:211], v[104:107]
    ds_read_b128 v[16:19], v3 offset:4096
    v_mfma_f32_16x16x32_bf16 v[124:127], v[216:219], v[212:215], v[124:127]
    ds_read_b128 v[20:23], v3 offset:6144
    v_mfma_f32_16x16x32_bf16 v[68:71], v[220:223], v[200:203], v[68:71]
    ds_read_b64_tr_b16 v[24:25], v49 offset:0
    v_mfma_f32_16x16x32_bf16 v[88:91], v[220:223], v[204:207], v[88:91]
    ds_read_b64_tr_b16 v[26:27], v49 offset:1280
    v_mfma_f32_16x16x32_bf16 v[108:111], v[220:223], v[208:211], v[108:111]
    ds_read_b64_tr_b16 v[28:29], v50 offset:0
    v_mfma_f32_16x16x32_bf16 v[128:131], v[220:223], v[212:215], v[128:131]
    ds_read_b64_tr_b16 v[30:31], v50 offset:1280
    v_mfma_f32_16x16x32_bf16 v[72:75], v[224:227], v[200:203], v[72:75]
    ds_read_b64_tr_b16 v[32:33], v51 offset:0
    v_mfma_f32_16x16x32_bf16 v[92:95], v[224:227], v[204:207], v[92:95]
    ds_read_b64_tr_b16 v[34:35], v51 offset:1280
    v_mfma_f32_16x16x32_bf16 v[112:115], v[224:227], v[208:211], v[112:115]
    ds_read_b64_tr_b16 v[36:37], v52 offset:0
    v_mfma_f32_16x16x32_bf16 v[132:135], v[224:227], v[212:215], v[132:135]
    ds_read_b64_tr_b16 v[38:39], v52 offset:1280
    v_mfma_f32_16x16x32_bf16 v[76:79], v[228:231], v[200:203], v[76:79]
    ds_read_b64_tr_b16 v[40:41], v53 offset:0
    v_mfma_f32_16x16x32_bf16 v[96:99], v[228:231], v[204:207], v[96:99]
    ds_read_b64_tr_b16 v[42:43], v53 offset:1280
    v_mfma_f32_16x16x32_bf16 v[116:119], v[228:231], v[208:211], v[116:119]
    v_mfma_f32_16x16x32_bf16 v[136:139], v[228:231], v[212:215], v[136:139]
    v_mfma_f32_16x16x32_bf16 v[80:83], v[232:235], v[200:203], v[80:83]
    v_mfma_f32_16x16x32_bf16 v[100:103], v[232:235], v[204:207], v[100:103]
    v_mfma_f32_16x16x32_bf16 v[120:123], v[232:235], v[208:211], v[120:123]
    v_mfma_f32_16x16x32_bf16 v[140:143], v[232:235], v[212:215], v[140:143]
    v_mfma_f32_16x16x32_bf16 v[144:147], v[196:199], v[200:203], v[144:147]
    v_mfma_f32_16x16x32_bf16 v[160:163], v[200:203], v[200:203], v[160:163]
    v_mfma_f32_16x16x32_bf16 v[148:151], v[196:199], v[204:207], v[148:151]
    v_mfma_f32_16x16x32_bf16 v[164:167], v[204:207], v[204:207], v[164:167]
    v_mfma_f32_16x16x32_bf16 v[152:155], v[196:199], v[208:211], v[152:155]
    v_mfma_f32_16x16x32_bf16 v[168:171], v[208:211], v[208:211], v[168:171]
    v_mfma_f32_16x16x32_bf16 v[156:159], v[196:199], v[212:215], v[156:159]
    v_mfma_f32_16x16x32_bf16 v[172:175], v[212:215], v[212:215], v[172:175]
    s_waitcnt lgkmcnt(0)
    s_barrier
    v_mfma_f32_16x16x32_bf16 v[64:67], v[24:27], v[8:11], v[64:67]
    ds_read_b128 v[200:203], v2 offset:36864
    v_mfma_f32_16x16x32_bf16 v[84:87], v[24:27], v[12:15], v[84:87]
    ds_read_b128 v[204:207], v2 offset:38912
    v_mfma_f32_16x16x32_bf16 v[104:107], v[24:27], v[16:19], v[104:107]
    ds_read_b128 v[208:211], v2 offset:40960
    v_mfma_f32_16x16x32_bf16 v[124:127], v[24:27], v[20:23], v[124:127]
    ds_read_b128 v[212:215], v2 offset:43008
    v_mfma_f32_16x16x32_bf16 v[176:179], v[196:199], v[24:27], v[176:179]
    ds_read_b64_tr_b16 v[216:217], v44 offset:36864
    v_mfma_f32_16x16x32_bf16 v[68:71], v[28:31], v[8:11], v[68:71]
    ds_read_b64_tr_b16 v[218:219], v44 offset:38144
    v_mfma_f32_16x16x32_bf16 v[88:91], v[28:31], v[12:15], v[88:91]
    ds_read_b64_tr_b16 v[220:221], v45 offset:36864
    v_mfma_f32_16x16x32_bf16 v[108:111], v[28:31], v[16:19], v[108:111]
    ds_read_b64_tr_b16 v[222:223], v45 offset:38144
    v_mfma_f32_16x16x32_bf16 v[128:131], v[28:31], v[20:23], v[128:131]
    ds_read_b64_tr_b16 v[224:225], v46 offset:36864
    v_mfma_f32_16x16x32_bf16 v[180:183], v[196:199], v[28:31], v[180:183]
    ds_read_b64_tr_b16 v[226:227], v46 offset:38144
    v_mfma_f32_16x16x32_bf16 v[72:75], v[32:35], v[8:11], v[72:75]
    ds_read_b64_tr_b16 v[228:229], v47 offset:36864
    v_mfma_f32_16x16x32_bf16 v[92:95], v[32:35], v[12:15], v[92:95]
    ds_read_b64_tr_b16 v[230:231], v47 offset:38144
    v_mfma_f32_16x16x32_bf16 v[112:115], v[32:35], v[16:19], v[112:115]
    ds_read_b64_tr_b16 v[232:233], v48 offset:36864
    v_mfma_f32_16x16x32_bf16 v[132:135], v[32:35], v[20:23], v[132:135]
    ds_read_b64_tr_b16 v[234:235], v48 offset:38144
    v_mfma_f32_16x16x32_bf16 v[184:187], v[196:199], v[32:35], v[184:187]
    v_mfma_f32_16x16x32_bf16 v[76:79], v[36:39], v[8:11], v[76:79]
    v_mfma_f32_16x16x32_bf16 v[96:99], v[36:39], v[12:15], v[96:99]
    v_mfma_f32_16x16x32_bf16 v[116:119], v[36:39], v[16:19], v[116:119]
    v_mfma_f32_16x16x32_bf16 v[136:139], v[36:39], v[20:23], v[136:139]
    v_mfma_f32_16x16x32_bf16 v[188:191], v[196:199], v[36:39], v[188:191]
    v_mfma_f32_16x16x32_bf16 v[80:83], v[40:43], v[8:11], v[80:83]
    v_mfma_f32_16x16x32_bf16 v[100:103], v[40:43], v[12:15], v[100:103]
    v_mfma_f32_16x16x32_bf16 v[120:123], v[40:43], v[16:19], v[120:123]
    v_mfma_f32_16x16x32_bf16 v[140:143], v[40:43], v[20:23], v[140:143]
    v_mfma_f32_16x16x32_bf16 v[192:195], v[196:199], v[40:43], v[192:195]
    s_waitcnt lgkmcnt(0)
    v_mfma_f32_16x16x32_bf16 v[64:67], v[216:219], v[200:203], v[64:67]
    ds_read_b128 v[8:11], v3 offset:36864
    v_mfma_f32_16x16x32_bf16 v[84:87], v[216:219], v[204:207], v[84:87]
    ds_read_b128 v[12:15], v3 offset:38912
    v_mfma_f32_16x16x32_bf16 v[104:107], v[216:219], v[208:211], v[104:107]
    ds_read_b128 v[16:19], v3 offset:40960
    v_mfma_f32_16x16x32_bf16 v[124:127], v[216:219], v[212:215], v[124:127]
    ds_read_b128 v[20:23], v3 offset:43008
    v_mfma_f32_16x16x32_bf16 v[68:71], v[220:223], v[200:203], v[68:71]
    ds_read_b64_tr_b16 v[24:25], v49 offset:36864
    v_mfma_f32_16x16x32_bf16 v[88:91], v[220:223], v[204:207], v[88:91]
    ds_read_b64_tr_b16 v[26:27], v49 offset:38144
    v_mfma_f32_16x16x32_bf16 v[108:111], v[220:223], v[208:211], v[108:111]
    ds_read_b64_tr_b16 v[28:29], v50 offset:36864
    v_mfma_f32_16x16x32_bf16 v[128:131], v[220:223], v[212:215], v[128:131]
    ds_read_b64_tr_b16 v[30:31], v50 offset:38144
    v_mfma_f32_16x16x32_bf16 v[72:75], v[224:227], v[200:203], v[72:75]
    ds_read_b64_tr_b16 v[32:33], v51 offset:36864
    v_mfma_f32_16x16x32_bf16 v[92:95], v[224:227], v[204:207], v[92:95]
    ds_read_b64_tr_b16 v[34:35], v51 offset:38144
    v_mfma_f32_16x16x32_bf16 v[112:115], v[224:227], v[208:211], v[112:115]
    ds_read_b64_tr_b16 v[36:37], v52 offset:36864
    v_mfma_f32_16x16x32_bf16 v[132:135], v[224:227], v[212:215], v[132:135]
    ds_read_b64_tr_b16 v[38:39], v52 offset:38144
    v_mfma_f32_16x16x32_bf16 v[76:79], v[228:231], v[200:203], v[76:79]
    ds_read_b64_tr_b16 v[40:41], v53 offset:36864
    v_mfma_f32_16x16x32_bf16 v[96:99], v[228:231], v[204:207], v[96:99]
    ds_read_b64_tr_b16 v[42:43], v53 offset:38144
    v_mfma_f32_16x16x32_bf16 v[116:119], v[228:231], v[208:211], v[116:119]
    v_mfma_f32_16x16x32_bf16 v[136:139], v[228:231], v[212:215], v[136:139]
    v_mfma_f32_16x16x32_bf16 v[80:83], v[232:235], v[200:203], v[80:83]
    v_mfma_f32_16x16x32_bf16 v[100:103], v[232:235], v[204:207], v[100:103]
    v_mfma_f32_16x16x32_bf16 v[120:123], v[232:235], v[208:211], v[120:123]
    v_mfma_f32_16x16x32_bf16 v[140:143], v[232:235], v[212:215], v[140:143]
    v_mfma_f32_16x16x32_bf16 v[144:147], v[196:199], v[200:203], v[144:147]
    v_mfma_f32_16x16x32_bf16 v[160:163], v[200:203], v[200:203], v[160:163]
    v_mfma_f32_16x16x32_bf16 v[148:151], v[196:199], v[204:207], v[148:151]
    v_mfma_f32_16x16x32_bf16 v[164:167], v[204:207], v[204:207], v[164:167]
    v_mfma_f32_16x16x32_bf16 v[152:155], v[196:199], v[208:211], v[152:155]
    v_mfma_f32_16x16x32_bf16 v[168:171], v[208:211], v[208:211], v[168:171]
    v_mfma_f32_16x16x32_bf16 v[156:159], v[196:199], v[212:215], v[156:159]
    v_mfma_f32_16x16x32_bf16 v[172:175], v[212:215], v[212:215], v[172:175]
    s_waitcnt lgkmcnt(0)
    v_mfma_f32_16x16x32_bf16 v[64:67], v[24:27], v[8:11], v[64:67]
    v_mfma_f32_16x16x32_bf16 v[84:87], v[24:27], v[12:15], v[84:87]
    v_mfma_f32_16x16x32_bf16 v[104:107], v[24:27], v[16:19], v[104:107]
    v_mfma_f32_16x16x32_bf16 v[124:127], v[24:27], v[20:23], v[124:127]
    v_mfma_f32_16x16x32_bf16 v[176:179], v[196:199], v[24:27], v[176:179]
    v_mfma_f32_16x16x32_bf16 v[68:71], v[28:31], v[8:11], v[68:71]
    v_mfma_f32_16x16x32_bf16 v[88:91], v[28:31], v[12:15], v[88:91]
    v_mfma_f32_16x16x32_bf16 v[108:111], v[28:31], v[16:19], v[108:111]
    v_mfma_f32_16x16x32_bf16 v[128:131], v[28:31], v[20:23], v[128:131]
    v_mfma_f32_16x16x32_bf16 v[180:183], v[196:199], v[28:31], v[180:183]
    v_mfma_f32_16x16x32_bf16 v[72:75], v[32:35], v[8:11], v[72:75]
    v_mfma_f32_16x16x32_bf16 v[92:95], v[32:35], v[12:15], v[92:95]
    v_mfma_f32_16x16x32_bf16 v[112:115], v[32:35], v[16:19], v[112:115]
    v_mfma_f32_16x16x32_bf16 v[132:135], v[32:35], v[20:23], v[132:135]
    v_mfma_f32_16x16x32_bf16 v[184:187], v[196:199], v[32:35], v[184:187]
    v_mfma_f32_16x16x32_bf16 v[76:79], v[36:39], v[8:11], v[76:79]
    v_mfma_f32_16x16x32_bf16 v[96:99], v[36:39], v[12:15], v[96:99]
    v_mfma_f32_16x16x32_bf16 v[116:119], v[36:39], v[16:19], v[116:119]
    v_mfma_f32_16x16x32_bf16 v[136:139], v[36:39], v[20:23], v[136:139]
    v_mfma_f32_16x16x32_bf16 v[188:191], v[196:199], v[36:39], v[188:191]
    v_mfma_f32_16x16x32_bf16 v[80:83], v[40:43], v[8:11], v[80:83]
    v_mfma_f32_16x16x32_bf16 v[100:103], v[40:43], v[12:15], v[100:103]
    v_mfma_f32_16x16x32_bf16 v[120:123], v[40:43], v[16:19], v[120:123]
    v_mfma_f32_16x16x32_bf16 v[140:143], v[40:43], v[20:23], v[140:143]
    v_mfma_f32_16x16x32_bf16 v[192:195], v[196:199], v[40:43], v[192:195]
    s_branch Lj1done
Lj1v:
    s_barrier
    ds_read_b128 v[200:203], v2 offset:0
    ds_read_b128 v[204:207], v2 offset:2048
    ds_read_b128 v[208:211], v2 offset:4096
    ds_read_b128 v[212:215], v2 offset:6144
    ds_read_b64_tr_b16 v[216:217], v44 offset:0
    ds_read_b64_tr_b16 v[218:219], v44 offset:1280
    ds_read_b64_tr_b16 v[220:221], v45 offset:0
    ds_read_b64_tr_b16 v[222:223], v45 offset:1280
    ds_read_b64_tr_b16 v[224:225], v46 offset:0
    ds_read_b64_tr_b16 v[226:227], v46 offset:1280
    ds_read_b64_tr_b16 v[228:229], v47 offset:0
    ds_read_b64_tr_b16 v[230:231], v47 offset:1280
    ds_read_b64_tr_b16 v[232:233], v48 offset:0
    ds_read_b64_tr_b16 v[234:235], v48 offset:1280
    s_waitcnt lgkmcnt(0)
    v_mfma_f32_16x16x32_bf16 v[64:67], v[200:203], v[216:219], v[64:67]
    ds_read_b128 v[8:11], v3 offset:0
    v_mfma_f32_16x16x32_bf16 v[84:87], v[204:207], v[216:219], v[84:87]
    ds_read_b128 v[12:15], v3 offset:2048
    v_mfma_f32_16x16x32_bf16 v[104:107], v[208:211], v[216:219], v[104:107]
    ds_read_b128 v[16:19], v3 offset:4096
    v_mfma_f32_16x16x32_bf16 v[124:127], v[212:215], v[216:219], v[124:127]
    ds_read_b128 v[20:23], v3 offset:6144
    v_mfma_f32_16x16x32_bf16 v[68:71], v[200:203], v[220:223], v[68:71]
    ds_read_b64_tr_b16 v[24:25], v49 offset:0
    v_mfma_f32_16x16x32_bf16 v[88:91], v[204:207], v[220:223], v[88:91]
    ds_read_b64_tr_b16 v[26:27], v49 offset:1280
    v_mfma_f32_16x16x32_bf16 v[108:111], v[208:211], v[220:223], v[108:111]
    ds_read_b64_tr_b16 v[28:29], v50 offset:0
    v_mfma_f32_16x16x32_bf16 v[128:131], v[212:215], v[220:223], v[128:131]
    ds_read_b64_tr_b16 v[30:31], v50 offset:1280
    v_mfma_f32_16x16x32_bf16 v[72:75], v[200:203], v[224:227], v[72:75]
    ds_read_b64_tr_b16 v[32:33], v51 offset:0
    v_mfma_f32_16x16x32_bf16 v[92:95], v[204:207], v[224:227], v[92:95]
    ds_read_b64_tr_b16 v[34:35], v51 offset:1280
    v_mfma_f32_16x16x32_bf16 v[112:115], v[208:211], v[224:227], v[112:115]
    ds_read_b64_tr_b16 v[36:37], v52 offset:0
    v_mfma_f32_16x16x32_bf16 v[132:135], v[212:215], v[224:227], v[132:135]
    ds_read_b64_tr_b16 v[38:39], v52 offset:1280
    v_mfma_f32_16x16x32_bf16 v[76:79], v[200:203], v[228:231], v[76:79]
    ds_read_b64_tr_b16 v[40:41], v53 offset:0
    v_mfma_f32_16x16x32_bf16 v[96:99], v[204:207], v[228:231], v[96:99]
    ds_read_b64_tr_b16 v[42:43], v53 offset:1280
    v_mfma_f32_16x16x32_bf16 v[116:119], v[208:211], v[228:231], v[116:119]
    v_mfma_f32_16x16x32_bf16 v[136:139], v[212:215], v[228:231], v[136:139]
    v_mfma_f32_16x16x32_bf16 v[80:83], v[200:203], v[232:235], v[80:83]
    v_mfma_f32_16x16x32_bf16 v[100:103], v[204:207], v[232:235], v[100:103]
    v_mfma_f32_16x16x32_bf16 v[120:123], v[208:211], v[232:235], v[120:123]
    v_mfma_f32_16x16x32_bf16 v[140:143], v[212:215], v[232:235], v[140:143]
    v_mfma_f32_16x16x32_bf16 v[144:147], v[196:199], v[200:203], v[144:147]
    v_mfma_f32_16x16x32_bf16 v[160:163], v[200:203], v[200:203], v[160:163]
    v_mfma_f32_16x16x32_bf16 v[148:151], v[196:199], v[204:207], v[148:151]
    v_mfma_f32_16x16x32_bf16 v[164:167], v[204:207], v[204:207], v[164:167]
    v_mfma_f32_16x16x32_bf16 v[152:155], v[196:199], v[208:211], v[152:155]
    v_mfma_f32_16x16x32_bf16 v[168:171], v[208:211], v[208:211], v[168:171]
    v_mfma_f32_16x16x32_bf16 v[156:159], v[196:199], v[212:215], v[156:159]
    v_mfma_f32_16x16x32_bf16 v[172:175], v[212:215], v[212:215], v[172:175]
    s_waitcnt lgkmcnt(0)
    s_waitcnt vmcnt(0)
    s_barrier
    v_mfma_f32_16x16x32_bf16 v[64:67], v[8:11], v[24:27], v[64:67]
    ds_read_b128 v[200:203], v2 offset:36864
    v_mfma_f32_16x16x32_bf16 v[84:87], v[12:15], v[24:27], v[84:87]
    ds_read_b128 v[204:207], v2 offset:38912
    v_mfma_f32_16x16x32_bf16 v[104:107], v[16:19], v[24:27], v[104:107]
    ds_read_b128 v[208:211], v2 offset:40960
    v_mfma_f32_16x16x32_bf16 v[124:127], v[20:23], v[24:27], v[124:127]
    ds_read_b128 v[212:215], v2 offset:43008
    v_mfma_f32_16x16x32_bf16 v[176:179], v[196:199], v[24:27], v[176:179]
    ds_read_b64_tr_b16 v[216:217], v44 offset:36864
    v_mfma_f32_16x16x32_bf16 v[68:71], v[8:11], v[28:31], v[68:71]
    ds_read_b64_tr_b16 v[218:219], v44 offset:38144
    v_mfma_f32_16x16x32_bf16 v[88:91], v[12:15], v[28:31], v[88:91]
    ds_read_b64_tr_b16 v[220:221], v45 offset:36864
    v_mfma_f32_16x16x32_bf16 v[108:111], v[16:19], v[28:31], v[108:111]
    ds_read_b64_tr_b16 v[222:223], v45 offset:38144
    v_mfma_f32_16x16x32_bf16 v[128:131], v[20:23], v[28:31], v[128:131]
    ds_read_b64_tr_b16 v[224:225], v46 offset:36864
    v_mfma_f32_16x16x32_bf16 v[180:183], v[196:199], v[28:31], v[180:183]
    ds_read_b64_tr_b16 v[226:227], v46 offset:38144
    v_mfma_f32_16x16x32_bf16 v[72:75], v[8:11], v[32:35], v[72:75]
    ds_read_b64_tr_b16 v[228:229], v47 offset:36864
    v_mfma_f32_16x16x32_bf16 v[92:95], v[12:15], v[32:35], v[92:95]
    ds_read_b64_tr_b16 v[230:231], v47 offset:38144
    v_mfma_f32_16x16x32_bf16 v[112:115], v[16:19], v[32:35], v[112:115]
    ds_read_b64_tr_b16 v[232:233], v48 offset:36864
    v_mfma_f32_16x16x32_bf16 v[132:135], v[20:23], v[32:35], v[132:135]
    ds_read_b64_tr_b16 v[234:235], v48 offset:38144
    v_mfma_f32_16x16x32_bf16 v[184:187], v[196:199], v[32:35], v[184:187]
    v_mfma_f32_16x16x32_bf16 v[76:79], v[8:11], v[36:39], v[76:79]
    v_mfma_f32_16x16x32_bf16 v[96:99], v[12:15], v[36:39], v[96:99]
    v_mfma_f32_16x16x32_bf16 v[116:119], v[16:19], v[36:39], v[116:119]
    v_mfma_f32_16x16x32_bf16 v[136:139], v[20:23], v[36:39], v[136:139]
    v_mfma_f32_16x16x32_bf16 v[188:191], v[196:199], v[36:39], v[188:191]
    v_mfma_f32_16x16x32_bf16 v[80:83], v[8:11], v[40:43], v[80:83]
    v_mfma_f32_16x16x32_bf16 v[100:103], v[12:15], v[40:43], v[100:103]
    v_mfma_f32_16x16x32_bf16 v[120:123], v[16:19], v[40:43], v[120:123]
    v_mfma_f32_16x16x32_bf16 v[140:143], v[20:23], v[40:43], v[140:143]
    v_mfma_f32_16x16x32_bf16 v[192:195], v[196:199], v[40:43], v[192:195]
    s_waitcnt lgkmcnt(0)
    v_mfma_f32_16x16x32_bf16 v[64:67], v[200:203], v[216:219], v[64:67]
    ds_read_b128 v[8:11], v3 offset:36864
    v_mfma_f32_16x16x32_bf16 v[84:87], v[204:207], v[216:219], v[84:87]
    ds_read_b128 v[12:15], v3 offset:38912
    v_mfma_f32_16x16x32_bf16 v[104:107], v[208:211], v[216:219], v[104:107]
    ds_read_b128 v[16:19], v3 offset:40960
    v_mfma_f32_16x16x32_bf16 v[124:127], v[212:215], v[216:219], v[124:127]
    ds_read_b128 v[20:23], v3 offset:43008
    v_mfma_f32_16x16x32_bf16 v[68:71], v[200:203], v[220:223], v[68:71]
    ds_read_b64_tr_b16 v[24:25], v49 offset:36864
    v_mfma_f32_16x16x32_bf16 v[88:91], v[204:207], v[220:223], v[88:91]
    ds_read_b64_tr_b16 v[26:27], v49 offset:38144
    v_mfma_f32_16x16x32_bf16 v[108:111], v[208:211], v[220:223], v[108:111]
    ds_read_b64_tr_b16 v[28:29], v50 offset:36864
    v_mfma_f32_16x16x32_bf16 v[128:131], v[212:215], v[220:223], v[128:131]
    ds_read_b64_tr_b16 v[30:31], v50 offset:38144
    v_mfma_f32_16x16x32_bf16 v[72:75], v[200:203], v[224:227], v[72:75]
    ds_read_b64_tr_b16 v[32:33], v51 offset:36864
    v_mfma_f32_16x16x32_bf16 v[92:95], v[204:207], v[224:227], v[92:95]
    ds_read_b64_tr_b16 v[34:35], v51 offset:38144
    v_mfma_f32_16x16x32_bf16 v[112:115], v[208:211], v[224:227], v[112:115]
    ds_read_b64_tr_b16 v[36:37], v52 offset:36864
    v_mfma_f32_16x16x32_bf16 v[132:135], v[212:215], v[224:227], v[132:135]
    ds_read_b64_tr_b16 v[38:39], v52 offset:38144
    v_mfma_f32_16x16x32_bf16 v[76:79], v[200:203], v[228:231], v[76:79]
    ds_read_b64_tr_b16 v[40:41], v53 offset:36864
    v_mfma_f32_16x16x32_bf16 v[96:99], v[204:207], v[228:231], v[96:99]
    ds_read_b64_tr_b16 v[42:43], v53 offset:38144
    v_mfma_f32_16x16x32_bf16 v[116:119], v[208:211], v[228:231], v[116:119]
    v_mfma_f32_16x16x32_bf16 v[136:139], v[212:215], v[228:231], v[136:139]
    v_mfma_f32_16x16x32_bf16 v[80:83], v[200:203], v[232:235], v[80:83]
    v_mfma_f32_16x16x32_bf16 v[100:103], v[204:207], v[232:235], v[100:103]
    v_mfma_f32_16x16x32_bf16 v[120:123], v[208:211], v[232:235], v[120:123]
    v_mfma_f32_16x16x32_bf16 v[140:143], v[212:215], v[232:235], v[140:143]
    v_mfma_f32_16x16x32_bf16 v[144:147], v[196:199], v[200:203], v[144:147]
    v_mfma_f32_16x16x32_bf16 v[160:163], v[200:203], v[200:203], v[160:163]
    v_mfma_f32_16x16x32_bf16 v[148:151], v[196:199], v[204:207], v[148:151]
    v_mfma_f32_16x16x32_bf16 v[164:167], v[204:207], v[204:207], v[164:167]
    v_mfma_f32_16x16x32_bf16 v[152:155], v[196:199], v[208:211], v[152:155]
    v_mfma_f32_16x16x32_bf16 v[168:171], v[208:211], v[208:211], v[168:171]
    v_mfma_f32_16x16x32_bf16 v[156:159], v[196:199], v[212:215], v[156:159]
    v_mfma_f32_16x16x32_bf16 v[172:175], v[212:215], v[212:215], v[172:175]
    s_waitcnt lgkmcnt(0)
    s_barrier
    v_mfma_f32_16x16x32_bf16 v[64:67], v[8:11], v[24:27], v[64:67]
    ds_read_b128 v[200:203], v236 offset:0
    v_mfma_f32_16x16x32_bf16 v[84:87], v[12:15], v[24:27], v[84:87]
    ds_read_b128 v[204:207], v236 offset:2048
    v_mfma_f32_16x16x32_bf16 v[104:107], v[16:19], v[24:27], v[104:107]
    ds_read_b128 v[208:211], v236 offset:4096
    v_mfma_f32_16x16x32_bf16 v[124:127], v[20:23], v[24:27], v[124:127]
    ds_read_b128 v[212:215], v236 offset:6144
    v_mfma_f32_16x16x32_bf16 v[176:179], v[196:199], v[24:27], v[176:179]
    ds_read_b64_tr_b16 v[216:217], v238 offset:0
    v_mfma_f32_16x16x32_bf16 v[68:71], v[8:11], v[28:31], v[68:71]
    ds_read_b64_tr_b16 v[218:219], v238 offset:1280
    v_mfma_f32_16x16x32_bf16 v[88:91], v[12:15], v[28:31], v[88:91]
    ds_read_b64_tr_b16 v[220:221], v239 offset:0
    v_mfma_f32_16x16x32_bf16 v[108:111], v[16:19], v[28:31], v[108:111]
    ds_read_b64_tr_b16 v[222:223], v239 offset:1280
    v_mfma_f32_16x16x32_bf16 v[128:131], v[20:23], v[28:31], v[128:131]
    ds_read_b64_tr_b16 v[224:225], v240 offset:0
    v_mfma_f32_16x16x32_bf16 v[180:183], v[196:199], v[28:31], v[180:183]
    ds_read_b64_tr_b16 v[226:227], v240 offset:1280
    v_mfma_f32_16x16x32_bf16 v[72:75], v[8:11], v[32:35], v[72:75]
    ds_read_b64_tr_b16 v[228:229], v241 offset:0
    v_mfma_f32_16x16x32_bf16 v[92:95], v[12:15], v[32:35], v[92:95]
    ds_read_b64_tr_b16 v[230:231], v241 offset:1280
    v_mfma_f32_16x16x32_bf16 v[112:115], v[16:19], v[32:35], v[112:115]
    ds_read_b64_tr_b16 v[232:233], v242 offset:0
    v_mfma_f32_16x16x32_bf16 v[132:135], v[20:23], v[32:35], v[132:135]
    ds_read_b64_tr_b16 v[234:235], v242 offset:1280
    v_mfma_f32_16x16x32_bf16 v[184:187], v[196:199], v[32:35], v[184:187]
    v_mfma_f32_16x16x32_bf16 v[76:79], v[8:11], v[36:39], v[76:79]
    v_mfma_f32_16x16x32_bf16 v[96:99], v[12:15], v[36:39], v[96:99]
    v_mfma_f32_16x16x32_bf16 v[116:119], v[16:19], v[36:39], v[116:119]
    v_mfma_f32_16x16x32_bf16 v[136:139], v[20:23], v[36:39], v[136:139]
    v_mfma_f32_16x16x32_bf16 v[188:191], v[196:199], v[36:39], v[188:191]
    v_mfma_f32_16x16x32_bf16 v[80:83], v[8:11], v[40:43], v[80:83]
    v_mfma_f32_16x16x32_bf16 v[100:103], v[12:15], v[40:43], v[100:103]
    v_mfma_f32_16x16x32_bf16 v[120:123], v[16:19], v[40:43], v[120:123]
    v_mfma_f32_16x16x32_bf16 v[140:143], v[20:23], v[40:43], v[140:143]
    v_mfma_f32_16x16x32_bf16 v[192:195], v[196:199], v[40:43], v[192:195]
    s_waitcnt lgkmcnt(0)
    v_mfma_f32_16x16x32_bf16 v[64:67], v[200:203], v[216:219], v[64:67]
    ds_read_b128 v[8:11], v237 offset:0
    v_mfma_f32_16x16x32_bf16 v[84:87], v[204:207], v[216:219], v[84:87]
    ds_read_b128 v[12:15], v237 offset:2048
    v_mfma_f32_16x16x32_bf16 v[104:107], v[208:211], v[216:219], v[104:107]
    ds_read_b128 v[16:19], v237 offset:4096
    v_mfma_f32_16x16x32_bf16 v[124:127], v[212:215], v[216:219], v[124:127]
    ds_read_b128 v[20:23], v237 offset:6144
    v_mfma_f32_16x16x32_bf16 v[68:71], v[200:203], v[220:223], v[68:71]
    ds_read_b64_tr_b16 v[24:25], v243 offset:0
    v_mfma_f32_16x16x32_bf16 v[88:91], v[204:207], v[220:223], v[88:91]
    ds_read_b64_tr_b16 v[26:27], v243 offset:1280
    v_mfma_f32_16x16x32_bf16 v[108:111], v[208:211], v[220:223], v[108:111]
    ds_read_b64_tr_b16 v[28:29], v244 offset:0
    v_mfma_f32_16x16x32_bf16 v[128:131], v[212:215], v[220:223], v[128:131]
    ds_read_b64_tr_b16 v[30:31], v244 offset:1280
    v_mfma_f32_16x16x32_bf16 v[72:75], v[200:203], v[224:227], v[72:75]
    ds_read_b64_tr_b16 v[32:33], v245 offset:0
    v_mfma_f32_16x16x32_bf16 v[92:95], v[204:207], v[224:227], v[92:95]
    ds_read_b64_tr_b16 v[34:35], v245 offset:1280
    v_mfma_f32_16x16x32_bf16 v[112:115], v[208:211], v[224:227], v[112:115]
    ds_read_b64_tr_b16 v[36:37], v246 offset:0
    v_mfma_f32_16x16x32_bf16 v[132:135], v[212:215], v[224:227], v[132:135]
    ds_read_b64_tr_b16 v[38:39], v246 offset:1280
    v_mfma_f32_16x16x32_bf16 v[76:79], v[200:203], v[228:231], v[76:79]
    ds_read_b64_tr_b16 v[40:41], v247 offset:0
    v_mfma_f32_16x16x32_bf16 v[96:99], v[204:207], v[228:231], v[96:99]
    ds_read_b64_tr_b16 v[42:43], v247 offset:1280
    v_mfma_f32_16x16x32_bf16 v[116:119], v[208:211], v[228:231], v[116:119]
    v_mfma_f32_16x16x32_bf16 v[136:139], v[212:215], v[228:231], v[136:139]
    v_mfma_f32_16x16x32_bf16 v[80:83], v[200:203], v[232:235], v[80:83]
    v_mfma_f32_16x16x32_bf16 v[100:103], v[204:207], v[232:235], v[100:103]
    v_mfma_f32_16x16x32_bf16 v[120:123], v[208:211], v[232:235], v[120:123]
    v_mfma_f32_16x16x32_bf16 v[140:143], v[212:215], v[232:235], v[140:143]
    v_mfma_f32_16x16x32_bf16 v[144:147], v[196:199], v[200:203], v[144:147]
    v_mfma_f32_16x16x32_bf16 v[160:163], v[200:203], v[200:203], v[160:163]
    v_mfma_f32_16x16x32_bf16 v[148:151], v[196:199], v[204:207], v[148:151]
    v_mfma_f32_16x16x32_bf16 v[164:167], v[204:207], v[204:207], v[164:167]
    v_mfma_f32_16x16x32_bf16 v[152:155], v[196:199], v[208:211], v[152:155]
    v_mfma_f32_16x16x32_bf16 v[168:171], v[208:211], v[208:211], v[168:171]
    v_mfma_f32_16x16x32_bf16 v[156:159], v[196:199], v[212:215], v[156:159]
    v_mfma_f32_16x16x32_bf16 v[172:175], v[212:215], v[212:215], v[172:175]
    s_waitcnt lgkmcnt(0)
    s_barrier
    v_mfma_f32_16x16x32_bf16 v[64:67], v[8:11], v[24:27], v[64:67]
    ds_read_b128 v[200:203], v236 offset:36864
    v_mfma_f32_16x16x32_bf16 v[84:87], v[12:15], v[24:27], v[84:87]
    ds_read_b128 v[204:207], v236 offset:38912
    v_mfma_f32_16x16x32_bf16 v[104:107], v[16:19], v[24:27], v[104:107]
    ds_read_b128 v[208:211], v236 offset:40960
    v_mfma_f32_16x16x32_bf16 v[124:127], v[20:23], v[24:27], v[124:127]
    ds_read_b128 v[212:215], v236 offset:43008
    v_mfma_f32_16x16x32_bf16 v[176:179], v[196:199], v[24:27], v[176:179]
    ds_read_b64_tr_b16 v[216:217], v238 offset:36864
    v_mfma_f32_16x16x32_bf16 v[68:71], v[8:11], v[28:31], v[68:71]
    ds_read_b64_tr_b16 v[218:219], v238 offset:38144
    v_mfma_f32_16x16x32_bf16 v[88:91], v[12:15], v[28:31], v[88:91]
    ds_read_b64_tr_b16 v[220:221], v239 offset:36864
    v_mfma_f32_16x16x32_bf16 v[108:111], v[16:19], v[28:31], v[108:111]
    ds_read_b64_tr_b16 v[222:223], v239 offset:38144
    v_mfma_f32_16x16x32_bf16 v[128:131], v[20:23], v[28:31], v[128:131]
    ds_read_b64_tr_b16 v[224:225], v240 offset:36864
    v_mfma_f32_16x16x32_bf16 v[180:183], v[196:199], v[28:31], v[180:183]
    ds_read_b64_tr_b16 v[226:227], v240 offset:38144
    v_mfma_f32_16x16x32_bf16 v[72:75], v[8:11], v[32:35], v[72:75]
    ds_read_b64_tr_b16 v[228:229], v241 offset:36864
    v_mfma_f32_16x16x32_bf16 v[92:95], v[12:15], v[32:35], v[92:95]
    ds_read_b64_tr_b16 v[230:231], v241 offset:38144
    v_mfma_f32_16x16x32_bf16 v[112:115], v[16:19], v[32:35], v[112:115]
    ds_read_b64_tr_b16 v[232:233], v242 offset:36864
    v_mfma_f32_16x16x32_bf16 v[132:135], v[20:23], v[32:35], v[132:135]
    ds_read_b64_tr_b16 v[234:235], v242 offset:38144
    v_mfma_f32_16x16x32_bf16 v[184:187], v[196:199], v[32:35], v[184:187]
    v_mfma_f32_16x16x32_bf16 v[76:79], v[8:11], v[36:39], v[76:79]
    v_mfma_f32_16x16x32_bf16 v[96:99], v[12:15], v[36:39], v[96:99]
    v_mfma_f32_16x16x32_bf16 v[116:119], v[16:19], v[36:39], v[116:119]
    v_mfma_f32_16x16x32_bf16 v[136:139], v[20:23], v[36:39], v[136:139]
    v_mfma_f32_16x16x32_bf16 v[188:191], v[196:199], v[36:39], v[188:191]
    v_mfma_f32_16x16x32_bf16 v[80:83], v[8:11], v[40:43], v[80:83]
    v_mfma_f32_16x16x32_bf16 v[100:103], v[12:15], v[40:43], v[100:103]
    v_mfma_f32_16x16x32_bf16 v[120:123], v[16:19], v[40:43], v[120:123]
    v_mfma_f32_16x16x32_bf16 v[140:143], v[20:23], v[40:43], v[140:143]
    v_mfma_f32_16x16x32_bf16 v[192:195], v[196:199], v[40:43], v[192:195]
    s_waitcnt lgkmcnt(0)
    v_mfma_f32_16x16x32_bf16 v[64:67], v[200:203], v[216:219], v[64:67]
    ds_read_b128 v[8:11], v237 offset:36864
    v_mfma_f32_16x16x32_bf16 v[84:87], v[204:207], v[216:219], v[84:87]
    ds_read_b128 v[12:15], v237 offset:38912
    v_mfma_f32_16x16x32_bf16 v[104:107], v[208:211], v[216:219], v[104:107]
    ds_read_b128 v[16:19], v237 offset:40960
    v_mfma_f32_16x16x32_bf16 v[124:127], v[212:215], v[216:219], v[124:127]
    ds_read_b128 v[20:23], v237 offset:43008
    v_mfma_f32_16x16x32_bf16 v[68:71], v[200:203], v[220:223], v[68:71]
    ds_read_b64_tr_b16 v[24:25], v243 offset:36864
    v_mfma_f32_16x16x32_bf16 v[88:91], v[204:207], v[220:223], v[88:91]
    ds_read_b64_tr_b16 v[26:27], v243 offset:38144
    v_mfma_f32_16x16x32_bf16 v[108:111], v[208:211], v[220:223], v[108:111]
    ds_read_b64_tr_b16 v[28:29], v244 offset:36864
    v_mfma_f32_16x16x32_bf16 v[128:131], v[212:215], v[220:223], v[128:131]
    ds_read_b64_tr_b16 v[30:31], v244 offset:38144
    v_mfma_f32_16x16x32_bf16 v[72:75], v[200:203], v[224:227], v[72:75]
    ds_read_b64_tr_b16 v[32:33], v245 offset:36864
    v_mfma_f32_16x16x32_bf16 v[92:95], v[204:207], v[224:227], v[92:95]
    ds_read_b64_tr_b16 v[34:35], v245 offset:38144
    v_mfma_f32_16x16x32_bf16 v[112:115], v[208:211], v[224:227], v[112:115]
    ds_read_b64_tr_b16 v[36:37], v246 offset:36864
    v_mfma_f32_16x16x32_bf16 v[132:135], v[212:215], v[224:227], v[132:135]
    ds_read_b64_tr_b16 v[38:39], v246 offset:38144
    v_mfma_f32_16x16x32_bf16 v[76:79], v[200:203], v[228:231], v[76:79]
    ds_read_b64_tr_b16 v[40:41], v247 offset:36864
    v_mfma_f32_16x16x32_bf16 v[96:99], v[204:207], v[228:231], v[96:99]
    ds_read_b64_tr_b16 v[42:43], v247 offset:38144
    v_mfma_f32_16x16x32_bf16 v[116:119], v[208:211], v[228:231], v[116:119]
    v_mfma_f32_16x16x32_bf16 v[136:139], v[212:215], v[228:231], v[136:139]
    v_mfma_f32_16x16x32_bf16 v[80:83], v[200:203], v[232:235], v[80:83]
    v_mfma_f32_16x16x32_bf16 v[100:103], v[204:207], v[232:235], v[100:103]
    v_mfma_f32_16x16x32_bf16 v[120:123], v[208:211], v[232:235], v[120:123]
    v_mfma_f32_16x16x32_bf16 v[140:143], v[212:215], v[232:235], v[140:143]
    v_mfma_f32_16x16x32_bf16 v[144:147], v[196:199], v[200:203], v[144:147]
    v_mfma_f32_16x16x32_bf16 v[160:163], v[200:203], v[200:203], v[160:163]
    v_mfma_f32_16x16x32_bf16 v[148:151], v[196:199], v[204:207], v[148:151]
    v_mfma_f32_16x16x32_bf16 v[164:167], v[204:207], v[204:207], v[164:167]
    v_mfma_f32_16x16x32_bf16 v[152:155], v[196:199], v[208:211], v[152:155]
    v_mfma_f32_16x16x32_bf16 v[168:171], v[208:211], v[208:211], v[168:171]
    v_mfma_f32_16x16x32_bf16 v[156:159], v[196:199], v[212:215], v[156:159]
    v_mfma_f32_16x16x32_bf16 v[172:175], v[212:215], v[212:215], v[172:175]
    s_waitcnt lgkmcnt(0)
    s_barrier
    v_mfma_f32_16x16x32_bf16 v[64:67], v[8:11], v[24:27], v[64:67]
    ds_read_b128 v[200:203], v2 offset:0
    v_mfma_f32_16x16x32_bf16 v[84:87], v[12:15], v[24:27], v[84:87]
    ds_read_b128 v[204:207], v2 offset:2048
    v_mfma_f32_16x16x32_bf16 v[104:107], v[16:19], v[24:27], v[104:107]
    ds_read_b128 v[208:211], v2 offset:4096
    v_mfma_f32_16x16x32_bf16 v[124:127], v[20:23], v[24:27], v[124:127]
    ds_read_b128 v[212:215], v2 offset:6144
    v_mfma_f32_16x16x32_bf16 v[176:179], v[196:199], v[24:27], v[176:179]
    ds_read_b64_tr_b16 v[216:217], v44 offset:0
    v_mfma_f32_16x16x32_bf16 v[68:71], v[8:11], v[28:31], v[68:71]
    ds_read_b64_tr_b16 v[218:219], v44 offset:1280
    v_mfma_f32_16x16x32_bf16 v[88:91], v[12:15], v[28:31], v[88:91]
    ds_read_b64_tr_b16 v[220:221], v45 offset:0
    v_mfma_f32_16x16x32_bf16 v[108:111], v[16:19], v[28:31], v[108:111]
    ds_read_b64_tr_b16 v[222:223], v45 offset:1280
    v_mfma_f32_16x16x32_bf16 v[128:131], v[20:23], v[28:31], v[128:131]
    ds_read_b64_tr_b16 v[224:225], v46 offset:0
    v_mfma_f32_16x16x32_bf16 v[180:183], v[196:199], v[28:31], v[180:183]
    ds_read_b64_tr_b16 v[226:227], v46 offset:1280
    v_mfma_f32_16x16x32_bf16 v[72:75], v[8:11], v[32:35], v[72:75]
    ds_read_b64_tr_b16 v[228:229], v47 offset:0
    v_mfma_f32_16x16x32_bf16 v[92:95], v[12:15], v[32:35], v[92:95]
    ds_read_b64_tr_b16 v[230:231], v47 offset:1280
    v_mfma_f32_16x16x32_bf16 v[112:115], v[16:19], v[32:35], v[112:115]
    ds_read_b64_tr_b16 v[232:233], v48 offset:0
    v_mfma_f32_16x16x32_bf16 v[132:135], v[20:23], v[32:35], v[132:135]
    ds_read_b64_tr_b16 v[234:235], v48 offset:1280
    v_mfma_f32_16x16x32_bf16 v[184:187], v[196:199], v[32:35], v[184:187]
    v_mfma_f32_16x16x32_bf16 v[76:79], v[8:11], v[36:39], v[76:79]
    v_mfma_f32_16x16x32_bf16 v[96:99], v[12:15], v[36:39], v[96:99]
    v_mfma_f32_16x16x32_bf16 v[116:119], v[16:19], v[36:39], v[116:119]
    v_mfma_f32_16x16x32_bf16 v[136:139], v[20:23], v[36:39], v[136:139]
    v_mfma_f32_16x16x32_bf16 v[188:191], v[196:199], v[36:39], v[188:191]
    v_mfma_f32_16x16x32_bf16 v[80:83], v[8:11], v[40:43], v[80:83]
    v_mfma_f32_16x16x32_bf16 v[100:103], v[12:15], v[40:43], v[100:103]
    v_mfma_f32_16x16x32_bf16 v[120:123], v[16:19], v[40:43], v[120:123]
    v_mfma_f32_16x16x32_bf16 v[140:143], v[20:23], v[40:43], v[140:143]
    v_mfma_f32_16x16x32_bf16 v[192:195], v[196:199], v[40:43], v[192:195]
    s_waitcnt lgkmcnt(0)
    v_mfma_f32_16x16x32_bf16 v[64:67], v[200:203], v[216:219], v[64:67]
    ds_read_b128 v[8:11], v3 offset:0
    v_mfma_f32_16x16x32_bf16 v[84:87], v[204:207], v[216:219], v[84:87]
    ds_read_b128 v[12:15], v3 offset:2048
    v_mfma_f32_16x16x32_bf16 v[104:107], v[208:211], v[216:219], v[104:107]
    ds_read_b128 v[16:19], v3 offset:4096
    v_mfma_f32_16x16x32_bf16 v[124:127], v[212:215], v[216:219], v[124:127]
    ds_read_b128 v[20:23], v3 offset:6144
    v_mfma_f32_16x16x32_bf16 v[68:71], v[200:203], v[220:223], v[68:71]
    ds_read_b64_tr_b16 v[24:25], v49 offset:0
    v_mfma_f32_16x16x32_bf16 v[88:91], v[204:207], v[220:223], v[88:91]
    ds_read_b64_tr_b16 v[26:27], v49 offset:1280
    v_mfma_f32_16x16x32_bf16 v[108:111], v[208:211], v[220:223], v[108:111]
    ds_read_b64_tr_b16 v[28:29], v50 offset:0
    v_mfma_f32_16x16x32_bf16 v[128:131], v[212:215], v[220:223], v[128:131]
    ds_read_b64_tr_b16 v[30:31], v50 offset:1280
    v_mfma_f32_16x16x32_bf16 v[72:75], v[200:203], v[224:227], v[72:75]
    ds_read_b64_tr_b16 v[32:33], v51 offset:0
    v_mfma_f32_16x16x32_bf16 v[92:95], v[204:207], v[224:227], v[92:95]
    ds_read_b64_tr_b16 v[34:35], v51 offset:1280
    v_mfma_f32_16x16x32_bf16 v[112:115], v[208:211], v[224:227], v[112:115]
    ds_read_b64_tr_b16 v[36:37], v52 offset:0
    v_mfma_f32_16x16x32_bf16 v[132:135], v[212:215], v[224:227], v[132:135]
    ds_read_b64_tr_b16 v[38:39], v52 offset:1280
    v_mfma_f32_16x16x32_bf16 v[76:79], v[200:203], v[228:231], v[76:79]
    ds_read_b64_tr_b16 v[40:41], v53 offset:0
    v_mfma_f32_16x16x32_bf16 v[96:99], v[204:207], v[228:231], v[96:99]
    ds_read_b64_tr_b16 v[42:43], v53 offset:1280
    v_mfma_f32_16x16x32_bf16 v[116:119], v[208:211], v[228:231], v[116:119]
    v_mfma_f32_16x16x32_bf16 v[136:139], v[212:215], v[228:231], v[136:139]
    v_mfma_f32_16x16x32_bf16 v[80:83], v[200:203], v[232:235], v[80:83]
    v_mfma_f32_16x16x32_bf16 v[100:103], v[204:207], v[232:235], v[100:103]
    v_mfma_f32_16x16x32_bf16 v[120:123], v[208:211], v[232:235], v[120:123]
    v_mfma_f32_16x16x32_bf16 v[140:143], v[212:215], v[232:235], v[140:143]
    v_mfma_f32_16x16x32_bf16 v[144:147], v[196:199], v[200:203], v[144:147]
    v_mfma_f32_16x16x32_bf16 v[160:163], v[200:203], v[200:203], v[160:163]
    v_mfma_f32_16x16x32_bf16 v[148:151], v[196:199], v[204:207], v[148:151]
    v_mfma_f32_16x16x32_bf16 v[164:167], v[204:207], v[204:207], v[164:167]
    v_mfma_f32_16x16x32_bf16 v[152:155], v[196:199], v[208:211], v[152:155]
    v_mfma_f32_16x16x32_bf16 v[168:171], v[208:211], v[208:211], v[168:171]
    v_mfma_f32_16x16x32_bf16 v[156:159], v[196:199], v[212:215], v[156:159]
    v_mfma_f32_16x16x32_bf16 v[172:175], v[212:215], v[212:215], v[172:175]
    s_waitcnt lgkmcnt(0)
    s_barrier
    v_mfma_f32_16x16x32_bf16 v[64:67], v[8:11], v[24:27], v[64:67]
    ds_read_b128 v[200:203], v2 offset:36864
    v_mfma_f32_16x16x32_bf16 v[84:87], v[12:15], v[24:27], v[84:87]
    ds_read_b128 v[204:207], v2 offset:38912
    v_mfma_f32_16x16x32_bf16 v[104:107], v[16:19], v[24:27], v[104:107]
    ds_read_b128 v[208:211], v2 offset:40960
    v_mfma_f32_16x16x32_bf16 v[124:127], v[20:23], v[24:27], v[124:127]
    ds_read_b128 v[212:215], v2 offset:43008
    v_mfma_f32_16x16x32_bf16 v[176:179], v[196:199], v[24:27], v[176:179]
    ds_read_b64_tr_b16 v[216:217], v44 offset:36864
    v_mfma_f32_16x16x32_bf16 v[68:71], v[8:11], v[28:31], v[68:71]
    ds_read_b64_tr_b16 v[218:219], v44 offset:38144
    v_mfma_f32_16x16x32_bf16 v[88:91], v[12:15], v[28:31], v[88:91]
    ds_read_b64_tr_b16 v[220:221], v45 offset:36864
    v_mfma_f32_16x16x32_bf16 v[108:111], v[16:19], v[28:31], v[108:111]
    ds_read_b64_tr_b16 v[222:223], v45 offset:38144
    v_mfma_f32_16x16x32_bf16 v[128:131], v[20:23], v[28:31], v[128:131]
    ds_read_b64_tr_b16 v[224:225], v46 offset:36864
    v_mfma_f32_16x16x32_bf16 v[180:183], v[196:199], v[28:31], v[180:183]
    ds_read_b64_tr_b16 v[226:227], v46 offset:38144
    v_mfma_f32_16x16x32_bf16 v[72:75], v[8:11], v[32:35], v[72:75]
    ds_read_b64_tr_b16 v[228:229], v47 offset:36864
    v_mfma_f32_16x16x32_bf16 v[92:95], v[12:15], v[32:35], v[92:95]
    ds_read_b64_tr_b16 v[230:231], v47 offset:38144
    v_mfma_f32_16x16x32_bf16 v[112:115], v[16:19], v[32:35], v[112:115]
    ds_read_b64_tr_b16 v[232:233], v48 offset:36864
    v_mfma_f32_16x16x32_bf16 v[132:135], v[20:23], v[32:35], v[132:135]
    ds_read_b64_tr_b16 v[234:235], v48 offset:38144
    v_mfma_f32_16x16x32_bf16 v[184:187], v[196:199], v[32:35], v[184:187]
    v_mfma_f32_16x16x32_bf16 v[76:79], v[8:11], v[36:39], v[76:79]
    v_mfma_f32_16x16x32_bf16 v[96:99], v[12:15], v[36:39], v[96:99]
    v_mfma_f32_16x16x32_bf16 v[116:119], v[16:19], v[36:39], v[116:119]
    v_mfma_f32_16x16x32_bf16 v[136:139], v[20:23], v[36:39], v[136:139]
    v_mfma_f32_16x16x32_bf16 v[188:191], v[196:199], v[36:39], v[188:191]
    v_mfma_f32_16x16x32_bf16 v[80:83], v[8:11], v[40:43], v[80:83]
    v_mfma_f32_16x16x32_bf16 v[100:103], v[12:15], v[40:43], v[100:103]
    v_mfma_f32_16x16x32_bf16 v[120:123], v[16:19], v[40:43], v[120:123]
    v_mfma_f32_16x16x32_bf16 v[140:143], v[20:23], v[40:43], v[140:143]
    v_mfma_f32_16x16x32_bf16 v[192:195], v[196:199], v[40:43], v[192:195]
    s_waitcnt lgkmcnt(0)
    v_mfma_f32_16x16x32_bf16 v[64:67], v[200:203], v[216:219], v[64:67]
    ds_read_b128 v[8:11], v3 offset:36864
    v_mfma_f32_16x16x32_bf16 v[84:87], v[204:207], v[216:219], v[84:87]
    ds_read_b128 v[12:15], v3 offset:38912
    v_mfma_f32_16x16x32_bf16 v[104:107], v[208:211], v[216:219], v[104:107]
    ds_read_b128 v[16:19], v3 offset:40960
    v_mfma_f32_16x16x32_bf16 v[124:127], v[212:215], v[216:219], v[124:127]
    ds_read_b128 v[20:23], v3 offset:43008
    v_mfma_f32_16x16x32_bf16 v[68:71], v[200:203], v[220:223], v[68:71]
    ds_read_b64_tr_b16 v[24:25], v49 offset:36864
    v_mfma_f32_16x16x32_bf16 v[88:91], v[204:207], v[220:223], v[88:91]
    ds_read_b64_tr_b16 v[26:27], v49 offset:38144
    v_mfma_f32_16x16x32_bf16 v[108:111], v[208:211], v[220:223], v[108:111]
    ds_read_b64_tr_b16 v[28:29], v50 offset:36864
    v_mfma_f32_16x16x32_bf16 v[128:131], v[212:215], v[220:223], v[128:131]
    ds_read_b64_tr_b16 v[30:31], v50 offset:38144
    v_mfma_f32_16x16x32_bf16 v[72:75], v[200:203], v[224:227], v[72:75]
    ds_read_b64_tr_b16 v[32:33], v51 offset:36864
    v_mfma_f32_16x16x32_bf16 v[92:95], v[204:207], v[224:227], v[92:95]
    ds_read_b64_tr_b16 v[34:35], v51 offset:38144
    v_mfma_f32_16x16x32_bf16 v[112:115], v[208:211], v[224:227], v[112:115]
    ds_read_b64_tr_b16 v[36:37], v52 offset:36864
    v_mfma_f32_16x16x32_bf16 v[132:135], v[212:215], v[224:227], v[132:135]
    ds_read_b64_tr_b16 v[38:39], v52 offset:38144
    v_mfma_f32_16x16x32_bf16 v[76:79], v[200:203], v[228:231], v[76:79]
    ds_read_b64_tr_b16 v[40:41], v53 offset:36864
    v_mfma_f32_16x16x32_bf16 v[96:99], v[204:207], v[228:231], v[96:99]
    ds_read_b64_tr_b16 v[42:43], v53 offset:38144
    v_mfma_f32_16x16x32_bf16 v[116:119], v[208:211], v[228:231], v[116:119]
    v_mfma_f32_16x16x32_bf16 v[136:139], v[212:215], v[228:231], v[136:139]
    v_mfma_f32_16x16x32_bf16 v[80:83], v[200:203], v[232:235], v[80:83]
    v_mfma_f32_16x16x32_bf16 v[100:103], v[204:207], v[232:235], v[100:103]
    v_mfma_f32_16x16x32_bf16 v[120:123], v[208:211], v[232:235], v[120:123]
    v_mfma_f32_16x16x32_bf16 v[140:143], v[212:215], v[232:235], v[140:143]
    v_mfma_f32_16x16x32_bf16 v[144:147], v[196:199], v[200:203], v[144:147]
    v_mfma_f32_16x16x32_bf16 v[160:163], v[200:203], v[200:203], v[160:163]
    v_mfma_f32_16x16x32_bf16 v[148:151], v[196:199], v[204:207], v[148:151]
    v_mfma_f32_16x16x32_bf16 v[164:167], v[204:207], v[204:207], v[164:167]
    v_mfma_f32_16x16x32_bf16 v[152:155], v[196:199], v[208:211], v[152:155]
    v_mfma_f32_16x16x32_bf16 v[168:171], v[208:211], v[208:211], v[168:171]
    v_mfma_f32_16x16x32_bf16 v[156:159], v[196:199], v[212:215], v[156:159]
    v_mfma_f32_16x16x32_bf16 v[172:175], v[212:215], v[212:215], v[172:175]
    s_waitcnt lgkmcnt(0)
    s_barrier
    v_mfma_f32_16x16x32_bf16 v[64:67], v[8:11], v[24:27], v[64:67]
    ds_read_b128 v[200:203], v236 offset:0
    v_mfma_f32_16x16x32_bf16 v[84:87], v[12:15], v[24:27], v[84:87]
    ds_read_b128 v[204:207], v236 offset:2048
    v_mfma_f32_16x16x32_bf16 v[104:107], v[16:19], v[24:27], v[104:107]
    ds_read_b128 v[208:211], v236 offset:4096
    v_mfma_f32_16x16x32_bf16 v[124:127], v[20:23], v[24:27], v[124:127]
    ds_read_b128 v[212:215], v236 offset:6144
    v_mfma_f32_16x16x32_bf16 v[176:179], v[196:199], v[24:27], v[176:179]
    ds_read_b64_tr_b16 v[216:217], v238 offset:0
    v_mfma_f32_16x16x32_bf16 v[68:71], v[8:11], v[28:31], v[68:71]
    ds_read_b64_tr_b16 v[218:219], v238 offset:1280
    v_mfma_f32_16x16x32_bf16 v[88:91], v[12:15], v[28:31], v[88:91]
    ds_read_b64_tr_b16 v[220:221], v239 offset:0
    v_mfma_f32_16x16x32_bf16 v[108:111], v[16:19], v[28:31], v[108:111]
    ds_read_b64_tr_b16 v[222:223], v239 offset:1280
    v_mfma_f32_16x16x32_bf16 v[128:131], v[20:23], v[28:31], v[128:131]
    ds_read_b64_tr_b16 v[224:225], v240 offset:0
    v_mfma_f32_16x16x32_bf16 v[180:183], v[196:199], v[28:31], v[180:183]
    ds_read_b64_tr_b16 v[226:227], v240 offset:1280
    v_mfma_f32_16x16x32_bf16 v[72:75], v[8:11], v[32:35], v[72:75]
    ds_read_b64_tr_b16 v[228:229], v241 offset:0
    v_mfma_f32_16x16x32_bf16 v[92:95], v[12:15], v[32:35], v[92:95]
    ds_read_b64_tr_b16 v[230:231], v241 offset:1280
    v_mfma_f32_16x16x32_bf16 v[112:115], v[16:19], v[32:35], v[112:115]
    ds_read_b64_tr_b16 v[232:233], v242 offset:0
    v_mfma_f32_16x16x32_bf16 v[132:135], v[20:23], v[32:35], v[132:135]
    ds_read_b64_tr_b16 v[234:235], v242 offset:1280
    v_mfma_f32_16x16x32_bf16 v[184:187], v[196:199], v[32:35], v[184:187]
    v_mfma_f32_16x16x32_bf16 v[76:79], v[8:11], v[36:39], v[76:79]
    v_mfma_f32_16x16x32_bf16 v[96:99], v[12:15], v[36:39], v[96:99]
    v_mfma_f32_16x16x32_bf16 v[116:119], v[16:19], v[36:39], v[116:119]
    v_mfma_f32_16x16x32_bf16 v[136:139], v[20:23], v[36:39], v[136:139]
    v_mfma_f32_16x16x32_bf16 v[188:191], v[196:199], v[36:39], v[188:191]
    v_mfma_f32_16x16x32_bf16 v[80:83], v[8:11], v[40:43], v[80:83]
    v_mfma_f32_16x16x32_bf16 v[100:103], v[12:15], v[40:43], v[100:103]
    v_mfma_f32_16x16x32_bf16 v[120:123], v[16:19], v[40:43], v[120:123]
    v_mfma_f32_16x16x32_bf16 v[140:143], v[20:23], v[40:43], v[140:143]
    v_mfma_f32_16x16x32_bf16 v[192:195], v[196:199], v[40:43], v[192:195]
    s_waitcnt lgkmcnt(0)
    v_mfma_f32_16x16x32_bf16 v[64:67], v[200:203], v[216:219], v[64:67]
    ds_read_b128 v[8:11], v237 offset:0
    v_mfma_f32_16x16x32_bf16 v[84:87], v[204:207], v[216:219], v[84:87]
    ds_read_b128 v[12:15], v237 offset:2048
    v_mfma_f32_16x16x32_bf16 v[104:107], v[208:211], v[216:219], v[104:107]
    ds_read_b128 v[16:19], v237 offset:4096
    v_mfma_f32_16x16x32_bf16 v[124:127], v[212:215], v[216:219], v[124:127]
    ds_read_b128 v[20:23], v237 offset:6144
    v_mfma_f32_16x16x32_bf16 v[68:71], v[200:203], v[220:223], v[68:71]
    ds_read_b64_tr_b16 v[24:25], v243 offset:0
    v_mfma_f32_16x16x32_bf16 v[88:91], v[204:207], v[220:223], v[88:91]
    ds_read_b64_tr_b16 v[26:27], v243 offset:1280
    v_mfma_f32_16x16x32_bf16 v[108:111], v[208:211], v[220:223], v[108:111]
    ds_read_b64_tr_b16 v[28:29], v244 offset:0
    v_mfma_f32_16x16x32_bf16 v[128:131], v[212:215], v[220:223], v[128:131]
    ds_read_b64_tr_b16 v[30:31], v244 offset:1280
    v_mfma_f32_16x16x32_bf16 v[72:75], v[200:203], v[224:227], v[72:75]
    ds_read_b64_tr_b16 v[32:33], v245 offset:0
    v_mfma_f32_16x16x32_bf16 v[92:95], v[204:207], v[224:227], v[92:95]
    ds_read_b64_tr_b16 v[34:35], v245 offset:1280
    v_mfma_f32_16x16x32_bf16 v[112:115], v[208:211], v[224:227], v[112:115]
    ds_read_b64_tr_b16 v[36:37], v246 offset:0
    v_mfma_f32_16x16x32_bf16 v[132:135], v[212:215], v[224:227], v[132:135]
    ds_read_b64_tr_b16 v[38:39], v246 offset:1280
    v_mfma_f32_16x16x32_bf16 v[76:79], v[200:203], v[228:231], v[76:79]
    ds_read_b64_tr_b16 v[40:41], v247 offset:0
    v_mfma_f32_16x16x32_bf16 v[96:99], v[204:207], v[228:231], v[96:99]
    ds_read_b64_tr_b16 v[42:43], v247 offset:1280
    v_mfma_f32_16x16x32_bf16 v[116:119], v[208:211], v[228:231], v[116:119]
    v_mfma_f32_16x16x32_bf16 v[136:139], v[212:215], v[228:231], v[136:139]
    v_mfma_f32_16x16x32_bf16 v[80:83], v[200:203], v[232:235], v[80:83]
    v_mfma_f32_16x16x32_bf16 v[100:103], v[204:207], v[232:235], v[100:103]
    v_mfma_f32_16x16x32_bf16 v[120:123], v[208:211], v[232:235], v[120:123]
    v_mfma_f32_16x16x32_bf16 v[140:143], v[212:215], v[232:235], v[140:143]
    v_mfma_f32_16x16x32_bf16 v[144:147], v[196:199], v[200:203], v[144:147]
    v_mfma_f32_16x16x32_bf16 v[160:163], v[200:203], v[200:203], v[160:163]
    v_mfma_f32_16x16x32_bf16 v[148:151], v[196:199], v[204:207], v[148:151]
    v_mfma_f32_16x16x32_bf16 v[164:167], v[204:207], v[204:207], v[164:167]
    v_mfma_f32_16x16x32_bf16 v[152:155], v[196:199], v[208:211], v[152:155]
    v_mfma_f32_16x16x32_bf16 v[168:171], v[208:211], v[208:211], v[168:171]
    v_mfma_f32_16x16x32_bf16 v[156:159], v[196:199], v[212:215], v[156:159]
    v_mfma_f32_16x16x32_bf16 v[172:175], v[212:215], v[212:215], v[172:175]
    s_waitcnt lgkmcnt(0)
    s_barrier
    v_mfma_f32_16x16x32_bf16 v[64:67], v[8:11], v[24:27], v[64:67]
    ds_read_b128 v[200:203], v236 offset:36864
    v_mfma_f32_16x16x32_bf16 v[84:87], v[12:15], v[24:27], v[84:87]
    ds_read_b128 v[204:207], v236 offset:38912
    v_mfma_f32_16x16x32_bf16 v[104:107], v[16:19], v[24:27], v[104:107]
    ds_read_b128 v[208:211], v236 offset:40960
    v_mfma_f32_16x16x32_bf16 v[124:127], v[20:23], v[24:27], v[124:127]
    ds_read_b128 v[212:215], v236 offset:43008
    v_mfma_f32_16x16x32_bf16 v[176:179], v[196:199], v[24:27], v[176:179]
    ds_read_b64_tr_b16 v[216:217], v238 offset:36864
    v_mfma_f32_16x16x32_bf16 v[68:71], v[8:11], v[28:31], v[68:71]
    ds_read_b64_tr_b16 v[218:219], v238 offset:38144
    v_mfma_f32_16x16x32_bf16 v[88:91], v[12:15], v[28:31], v[88:91]
    ds_read_b64_tr_b16 v[220:221], v239 offset:36864
    v_mfma_f32_16x16x32_bf16 v[108:111], v[16:19], v[28:31], v[108:111]
    ds_read_b64_tr_b16 v[222:223], v239 offset:38144
    v_mfma_f32_16x16x32_bf16 v[128:131], v[20:23], v[28:31], v[128:131]
    ds_read_b64_tr_b16 v[224:225], v240 offset:36864
    v_mfma_f32_16x16x32_bf16 v[180:183], v[196:199], v[28:31], v[180:183]
    ds_read_b64_tr_b16 v[226:227], v240 offset:38144
    v_mfma_f32_16x16x32_bf16 v[72:75], v[8:11], v[32:35], v[72:75]
    ds_read_b64_tr_b16 v[228:229], v241 offset:36864
    v_mfma_f32_16x16x32_bf16 v[92:95], v[12:15], v[32:35], v[92:95]
    ds_read_b64_tr_b16 v[230:231], v241 offset:38144
    v_mfma_f32_16x16x32_bf16 v[112:115], v[16:19], v[32:35], v[112:115]
    ds_read_b64_tr_b16 v[232:233], v242 offset:36864
    v_mfma_f32_16x16x32_bf16 v[132:135], v[20:23], v[32:35], v[132:135]
    ds_read_b64_tr_b16 v[234:235], v242 offset:38144
    v_mfma_f32_16x16x32_bf16 v[184:187], v[196:199], v[32:35], v[184:187]
    v_mfma_f32_16x16x32_bf16 v[76:79], v[8:11], v[36:39], v[76:79]
    v_mfma_f32_16x16x32_bf16 v[96:99], v[12:15], v[36:39], v[96:99]
    v_mfma_f32_16x16x32_bf16 v[116:119], v[16:19], v[36:39], v[116:119]
    v_mfma_f32_16x16x32_bf16 v[136:139], v[20:23], v[36:39], v[136:139]
    v_mfma_f32_16x16x32_bf16 v[188:191], v[196:199], v[36:39], v[188:191]
    v_mfma_f32_16x16x32_bf16 v[80:83], v[8:11], v[40:43], v[80:83]
    v_mfma_f32_16x16x32_bf16 v[100:103], v[12:15], v[40:43], v[100:103]
    v_mfma_f32_16x16x32_bf16 v[120:123], v[16:19], v[40:43], v[120:123]
    v_mfma_f32_16x16x32_bf16 v[140:143], v[20:23], v[40:43], v[140:143]
    v_mfma_f32_16x16x32_bf16 v[192:195], v[196:199], v[40:43], v[192:195]
    s_waitcnt lgkmcnt(0)
    v_mfma_f32_16x16x32_bf16 v[64:67], v[200:203], v[216:219], v[64:67]
    ds_read_b128 v[8:11], v237 offset:36864
    v_mfma_f32_16x16x32_bf16 v[84:87], v[204:207], v[216:219], v[84:87]
    ds_read_b128 v[12:15], v237 offset:38912
    v_mfma_f32_16x16x32_bf16 v[104:107], v[208:211], v[216:219], v[104:107]
    ds_read_b128 v[16:19], v237 offset:40960
    v_mfma_f32_16x16x32_bf16 v[124:127], v[212:215], v[216:219], v[124:127]
    ds_read_b128 v[20:23], v237 offset:43008
    v_mfma_f32_16x16x32_bf16 v[68:71], v[200:203], v[220:223], v[68:71]
    ds_read_b64_tr_b16 v[24:25], v243 offset:36864
    v_mfma_f32_16x16x32_bf16 v[88:91], v[204:207], v[220:223], v[88:91]
    ds_read_b64_tr_b16 v[26:27], v243 offset:38144
    v_mfma_f32_16x16x32_bf16 v[108:111], v[208:211], v[220:223], v[108:111]
    ds_read_b64_tr_b16 v[28:29], v244 offset:36864
    v_mfma_f32_16x16x32_bf16 v[128:131], v[212:215], v[220:223], v[128:131]
    ds_read_b64_tr_b16 v[30:31], v244 offset:38144
    v_mfma_f32_16x16x32_bf16 v[72:75], v[200:203], v[224:227], v[72:75]
    ds_read_b64_tr_b16 v[32:33], v245 offset:36864
    v_mfma_f32_16x16x32_bf16 v[92:95], v[204:207], v[224:227], v[92:95]
    ds_read_b64_tr_b16 v[34:35], v245 offset:38144
    v_mfma_f32_16x16x32_bf16 v[112:115], v[208:211], v[224:227], v[112:115]
    ds_read_b64_tr_b16 v[36:37], v246 offset:36864
    v_mfma_f32_16x16x32_bf16 v[132:135], v[212:215], v[224:227], v[132:135]
    ds_read_b64_tr_b16 v[38:39], v246 offset:38144
    v_mfma_f32_16x16x32_bf16 v[76:79], v[200:203], v[228:231], v[76:79]
    ds_read_b64_tr_b16 v[40:41], v247 offset:36864
    v_mfma_f32_16x16x32_bf16 v[96:99], v[204:207], v[228:231], v[96:99]
    ds_read_b64_tr_b16 v[42:43], v247 offset:38144
    v_mfma_f32_16x16x32_bf16 v[116:119], v[208:211], v[228:231], v[116:119]
    v_mfma_f32_16x16x32_bf16 v[136:139], v[212:215], v[228:231], v[136:139]
    v_mfma_f32_16x16x32_bf16 v[80:83], v[200:203], v[232:235], v[80:83]
    v_mfma_f32_16x16x32_bf16 v[100:103], v[204:207], v[232:235], v[100:103]
    v_mfma_f32_16x16x32_bf16 v[120:123], v[208:211], v[232:235], v[120:123]
    v_mfma_f32_16x16x32_bf16 v[140:143], v[212:215], v[232:235], v[140:143]
    v_mfma_f32_16x16x32_bf16 v[144:147], v[196:199], v[200:203], v[144:147]
    v_mfma_f32_16x16x32_bf16 v[160:163], v[200:203], v[200:203], v[160:163]
    v_mfma_f32_16x16x32_bf16 v[148:151], v[196:199], v[204:207], v[148:151]
    v_mfma_f32_16x16x32_bf16 v[164:167], v[204:207], v[204:207], v[164:167]
    v_mfma_f32_16x16x32_bf16 v[152:155], v[196:199], v[208:211], v[152:155]
    v_mfma_f32_16x16x32_bf16 v[168:171], v[208:211], v[208:211], v[168:171]
    v_mfma_f32_16x16x32_bf16 v[156:159], v[196:199], v[212:215], v[156:159]
    v_mfma_f32_16x16x32_bf16 v[172:175], v[212:215], v[212:215], v[172:175]
    s_waitcnt lgkmcnt(0)
    s_barrier
    v_mfma_f32_16x16x32_bf16 v[64:67], v[8:11], v[24:27], v[64:67]
    ds_read_b128 v[200:203], v2 offset:0
    v_mfma_f32_16x16x32_bf16 v[84:87], v[12:15], v[24:27], v[84:87]
    ds_read_b128 v[204:207], v2 offset:2048
    v_mfma_f32_16x16x32_bf16 v[104:107], v[16:19], v[24:27], v[104:107]
    ds_read_b128 v[208:211], v2 offset:4096
    v_mfma_f32_16x16x32_bf16 v[124:127], v[20:23], v[24:27], v[124:127]
    ds_read_b128 v[212:215], v2 offset:6144
    v_mfma_f32_16x16x32_bf16 v[176:179], v[196:199], v[24:27], v[176:179]
    ds_read_b64_tr_b16 v[216:217], v44 offset:0
    v_mfma_f32_16x16x32_bf16 v[68:71], v[8:11], v[28:31], v[68:71]
    ds_read_b64_tr_b16 v[218:219], v44 offset:1280
    v_mfma_f32_16x16x32_bf16 v[88:91], v[12:15], v[28:31], v[88:91]
    ds_read_b64_tr_b16 v[220:221], v45 offset:0
    v_mfma_f32_16x16x32_bf16 v[108:111], v[16:19], v[28:31], v[108:111]
    ds_read_b64_tr_b16 v[222:223], v45 offset:1280
    v_mfma_f32_16x16x32_bf16 v[128:131], v[20:23], v[28:31], v[128:131]
    ds_read_b64_tr_b16 v[224:225], v46 offset:0
    v_mfma_f32_16x16x32_bf16 v[180:183], v[196:199], v[28:31], v[180:183]
    ds_read_b64_tr_b16 v[226:227], v46 offset:1280
    v_mfma_f32_16x16x32_bf16 v[72:75], v[8:11], v[32:35], v[72:75]
    ds_read_b64_tr_b16 v[228:229], v47 offset:0
    v_mfma_f32_16x16x32_bf16 v[92:95], v[12:15], v[32:35], v[92:95]
    ds_read_b64_tr_b16 v[230:231], v47 offset:1280
    v_mfma_f32_16x16x32_bf16 v[112:115], v[16:19], v[32:35], v[112:115]
    ds_read_b64_tr_b16 v[232:233], v48 offset:0
    v_mfma_f32_16x16x32_bf16 v[132:135], v[20:23], v[32:35], v[132:135]
    ds_read_b64_tr_b16 v[234:235], v48 offset:1280
    v_mfma_f32_16x16x32_bf16 v[184:187], v[196:199], v[32:35], v[184:187]
    v_mfma_f32_16x16x32_bf16 v[76:79], v[8:11], v[36:39], v[76:79]
    v_mfma_f32_16x16x32_bf16 v[96:99], v[12:15], v[36:39], v[96:99]
    v_mfma_f32_16x16x32_bf16 v[116:119], v[16:19], v[36:39], v[116:119]
    v_mfma_f32_16x16x32_bf16 v[136:139], v[20:23], v[36:39], v[136:139]
    v_mfma_f32_16x16x32_bf16 v[188:191], v[196:199], v[36:39], v[188:191]
    v_mfma_f32_16x16x32_bf16 v[80:83], v[8:11], v[40:43], v[80:83]
    v_mfma_f32_16x16x32_bf16 v[100:103], v[12:15], v[40:43], v[100:103]
    v_mfma_f32_16x16x32_bf16 v[120:123], v[16:19], v[40:43], v[120:123]
    v_mfma_f32_16x16x32_bf16 v[140:143], v[20:23], v[40:43], v[140:143]
    v_mfma_f32_16x16x32_bf16 v[192:195], v[196:199], v[40:43], v[192:195]
    s_waitcnt lgkmcnt(0)
    v_mfma_f32_16x16x32_bf16 v[64:67], v[200:203], v[216:219], v[64:67]
    ds_read_b128 v[8:11], v3 offset:0
    v_mfma_f32_16x16x32_bf16 v[84:87], v[204:207], v[216:219], v[84:87]
    ds_read_b128 v[12:15], v3 offset:2048
    v_mfma_f32_16x16x32_bf16 v[104:107], v[208:211], v[216:219], v[104:107]
    ds_read_b128 v[16:19], v3 offset:4096
    v_mfma_f32_16x16x32_bf16 v[124:127], v[212:215], v[216:219], v[124:127]
    ds_read_b128 v[20:23], v3 offset:6144
    v_mfma_f32_16x16x32_bf16 v[68:71], v[200:203], v[220:223], v[68:71]
    ds_read_b64_tr_b16 v[24:25], v49 offset:0
    v_mfma_f32_16x16x32_bf16 v[88:91], v[204:207], v[220:223], v[88:91]
    ds_read_b64_tr_b16 v[26:27], v49 offset:1280
    v_mfma_f32_16x16x32_bf16 v[108:111], v[208:211], v[220:223], v[108:111]
    ds_read_b64_tr_b16 v[28:29], v50 offset:0
    v_mfma_f32_16x16x32_bf16 v[128:131], v[212:215], v[220:223], v[128:131]
    ds_read_b64_tr_b16 v[30:31], v50 offset:1280
    v_mfma_f32_16x16x32_bf16 v[72:75], v[200:203], v[224:227], v[72:75]
    ds_read_b64_tr_b16 v[32:33], v51 offset:0
    v_mfma_f32_16x16x32_bf16 v[92:95], v[204:207], v[224:227], v[92:95]
    ds_read_b64_tr_b16 v[34:35], v51 offset:1280
    v_mfma_f32_16x16x32_bf16 v[112:115], v[208:211], v[224:227], v[112:115]
    ds_read_b64_tr_b16 v[36:37], v52 offset:0
    v_mfma_f32_16x16x32_bf16 v[132:135], v[212:215], v[224:227], v[132:135]
    ds_read_b64_tr_b16 v[38:39], v52 offset:1280
    v_mfma_f32_16x16x32_bf16 v[76:79], v[200:203], v[228:231], v[76:79]
    ds_read_b64_tr_b16 v[40:41], v53 offset:0
    v_mfma_f32_16x16x32_bf16 v[96:99], v[204:207], v[228:231], v[96:99]
    ds_read_b64_tr_b16 v[42:43], v53 offset:1280
    v_mfma_f32_16x16x32_bf16 v[116:119], v[208:211], v[228:231], v[116:119]
    v_mfma_f32_16x16x32_bf16 v[136:139], v[212:215], v[228:231], v[136:139]
    v_mfma_f32_16x16x32_bf16 v[80:83], v[200:203], v[232:235], v[80:83]
    v_mfma_f32_16x16x32_bf16 v[100:103], v[204:207], v[232:235], v[100:103]
    v_mfma_f32_16x16x32_bf16 v[120:123], v[208:211], v[232:235], v[120:123]
    v_mfma_f32_16x16x32_bf16 v[140:143], v[212:215], v[232:235], v[140:143]
    v_mfma_f32_16x16x32_bf16 v[144:147], v[196:199], v[200:203], v[144:147]
    v_mfma_f32_16x16x32_bf16 v[160:163], v[200:203], v[200:203], v[160:163]
    v_mfma_f32_16x16x32_bf16 v[148:151], v[196:199], v[204:207], v[148:151]
    v_mfma_f32_16x16x32_bf16 v[164:167], v[204:207], v[204:207], v[164:167]
    v_mfma_f32_16x16x32_bf16 v[152:155], v[196:199], v[208:211], v[152:155]
    v_mfma_f32_16x16x32_bf16 v[168:171], v[208:211], v[208:211], v[168:171]
    v_mfma_f32_16x16x32_bf16 v[156:159], v[196:199], v[212:215], v[156:159]
    v_mfma_f32_16x16x32_bf16 v[172:175], v[212:215], v[212:215], v[172:175]
    s_waitcnt lgkmcnt(0)
    s_barrier
    v_mfma_f32_16x16x32_bf16 v[64:67], v[8:11], v[24:27], v[64:67]
    ds_read_b128 v[200:203], v2 offset:36864
    v_mfma_f32_16x16x32_bf16 v[84:87], v[12:15], v[24:27], v[84:87]
    ds_read_b128 v[204:207], v2 offset:38912
    v_mfma_f32_16x16x32_bf16 v[104:107], v[16:19], v[24:27], v[104:107]
    ds_read_b128 v[208:211], v2 offset:40960
    v_mfma_f32_16x16x32_bf16 v[124:127], v[20:23], v[24:27], v[124:127]
    ds_read_b128 v[212:215], v2 offset:43008
    v_mfma_f32_16x16x32_bf16 v[176:179], v[196:199], v[24:27], v[176:179]
    ds_read_b64_tr_b16 v[216:217], v44 offset:36864
    v_mfma_f32_16x16x32_bf16 v[68:71], v[8:11], v[28:31], v[68:71]
    ds_read_b64_tr_b16 v[218:219], v44 offset:38144
    v_mfma_f32_16x16x32_bf16 v[88:91], v[12:15], v[28:31], v[88:91]
    ds_read_b64_tr_b16 v[220:221], v45 offset:36864
    v_mfma_f32_16x16x32_bf16 v[108:111], v[16:19], v[28:31], v[108:111]
    ds_read_b64_tr_b16 v[222:223], v45 offset:38144
    v_mfma_f32_16x16x32_bf16 v[128:131], v[20:23], v[28:31], v[128:131]
    ds_read_b64_tr_b16 v[224:225], v46 offset:36864
    v_mfma_f32_16x16x32_bf16 v[180:183], v[196:199], v[28:31], v[180:183]
    ds_read_b64_tr_b16 v[226:227], v46 offset:38144
    v_mfma_f32_16x16x32_bf16 v[72:75], v[8:11], v[32:35], v[72:75]
    ds_read_b64_tr_b16 v[228:229], v47 offset:36864
    v_mfma_f32_16x16x32_bf16 v[92:95], v[12:15], v[32:35], v[92:95]
    ds_read_b64_tr_b16 v[230:231], v47 offset:38144
    v_mfma_f32_16x16x32_bf16 v[112:115], v[16:19], v[32:35], v[112:115]
    ds_read_b64_tr_b16 v[232:233], v48 offset:36864
    v_mfma_f32_16x16x32_bf16 v[132:135], v[20:23], v[32:35], v[132:135]
    ds_read_b64_tr_b16 v[234:235], v48 offset:38144
    v_mfma_f32_16x16x32_bf16 v[184:187], v[196:199], v[32:35], v[184:187]
    v_mfma_f32_16x16x32_bf16 v[76:79], v[8:11], v[36:39], v[76:79]
    v_mfma_f32_16x16x32_bf16 v[96:99], v[12:15], v[36:39], v[96:99]
    v_mfma_f32_16x16x32_bf16 v[116:119], v[16:19], v[36:39], v[116:119]
    v_mfma_f32_16x16x32_bf16 v[136:139], v[20:23], v[36:39], v[136:139]
    v_mfma_f32_16x16x32_bf16 v[188:191], v[196:199], v[36:39], v[188:191]
    v_mfma_f32_16x16x32_bf16 v[80:83], v[8:11], v[40:43], v[80:83]
    v_mfma_f32_16x16x32_bf16 v[100:103], v[12:15], v[40:43], v[100:103]
    v_mfma_f32_16x16x32_bf16 v[120:123], v[16:19], v[40:43], v[120:123]
    v_mfma_f32_16x16x32_bf16 v[140:143], v[20:23], v[40:43], v[140:143]
    v_mfma_f32_16x16x32_bf16 v[192:195], v[196:199], v[40:43], v[192:195]
    s_waitcnt lgkmcnt(0)
    v_mfma_f32_16x16x32_bf16 v[64:67], v[200:203], v[216:219], v[64:67]
    ds_read_b128 v[8:11], v3 offset:36864
    v_mfma_f32_16x16x32_bf16 v[84:87], v[204:207], v[216:219], v[84:87]
    ds_read_b128 v[12:15], v3 offset:38912
    v_mfma_f32_16x16x32_bf16 v[104:107], v[208:211], v[216:219], v[104:107]
    ds_read_b128 v[16:19], v3 offset:40960
    v_mfma_f32_16x16x32_bf16 v[124:127], v[212:215], v[216:219], v[124:127]
    ds_read_b128 v[20:23], v3 offset:43008
    v_mfma_f32_16x16x32_bf16 v[68:71], v[200:203], v[220:223], v[68:71]
    ds_read_b64_tr_b16 v[24:25], v49 offset:36864
    v_mfma_f32_16x16x32_bf16 v[88:91], v[204:207], v[220:223], v[88:91]
    ds_read_b64_tr_b16 v[26:27], v49 offset:38144
    v_mfma_f32_16x16x32_bf16 v[108:111], v[208:211], v[220:223], v[108:111]
    ds_read_b64_tr_b16 v[28:29], v50 offset:36864
    v_mfma_f32_16x16x32_bf16 v[128:131], v[212:215], v[220:223], v[128:131]
    ds_read_b64_tr_b16 v[30:31], v50 offset:38144
    v_mfma_f32_16x16x32_bf16 v[72:75], v[200:203], v[224:227], v[72:75]
    ds_read_b64_tr_b16 v[32:33], v51 offset:36864
    v_mfma_f32_16x16x32_bf16 v[92:95], v[204:207], v[224:227], v[92:95]
    ds_read_b64_tr_b16 v[34:35], v51 offset:38144
    v_mfma_f32_16x16x32_bf16 v[112:115], v[208:211], v[224:227], v[112:115]
    ds_read_b64_tr_b16 v[36:37], v52 offset:36864
    v_mfma_f32_16x16x32_bf16 v[132:135], v[212:215], v[224:227], v[132:135]
    ds_read_b64_tr_b16 v[38:39], v52 offset:38144
    v_mfma_f32_16x16x32_bf16 v[76:79], v[200:203], v[228:231], v[76:79]
    ds_read_b64_tr_b16 v[40:41], v53 offset:36864
    v_mfma_f32_16x16x32_bf16 v[96:99], v[204:207], v[228:231], v[96:99]
    ds_read_b64_tr_b16 v[42:43], v53 offset:38144
    v_mfma_f32_16x16x32_bf16 v[116:119], v[208:211], v[228:231], v[116:119]
    v_mfma_f32_16x16x32_bf16 v[136:139], v[212:215], v[228:231], v[136:139]
    v_mfma_f32_16x16x32_bf16 v[80:83], v[200:203], v[232:235], v[80:83]
    v_mfma_f32_16x16x32_bf16 v[100:103], v[204:207], v[232:235], v[100:103]
    v_mfma_f32_16x16x32_bf16 v[120:123], v[208:211], v[232:235], v[120:123]
    v_mfma_f32_16x16x32_bf16 v[140:143], v[212:215], v[232:235], v[140:143]
    v_mfma_f32_16x16x32_bf16 v[144:147], v[196:199], v[200:203], v[144:147]
    v_mfma_f32_16x16x32_bf16 v[160:163], v[200:203], v[200:203], v[160:163]
    v_mfma_f32_16x16x32_bf16 v[148:151], v[196:199], v[204:207], v[148:151]
    v_mfma_f32_16x16x32_bf16 v[164:167], v[204:207], v[204:207], v[164:167]
    v_mfma_f32_16x16x32_bf16 v[152:155], v[196:199], v[208:211], v[152:155]
    v_mfma_f32_16x16x32_bf16 v[168:171], v[208:211], v[208:211], v[168:171]
    v_mfma_f32_16x16x32_bf16 v[156:159], v[196:199], v[212:215], v[156:159]
    v_mfma_f32_16x16x32_bf16 v[172:175], v[212:215], v[212:215], v[172:175]
    s_waitcnt lgkmcnt(0)
    v_mfma_f32_16x16x32_bf16 v[64:67], v[8:11], v[24:27], v[64:67]
    v_mfma_f32_16x16x32_bf16 v[84:87], v[12:15], v[24:27], v[84:87]
    v_mfma_f32_16x16x32_bf16 v[104:107], v[16:19], v[24:27], v[104:107]
    v_mfma_f32_16x16x32_bf16 v[124:127], v[20:23], v[24:27], v[124:127]
    v_mfma_f32_16x16x32_bf16 v[176:179], v[196:199], v[24:27], v[176:179]
    v_mfma_f32_16x16x32_bf16 v[68:71], v[8:11], v[28:31], v[68:71]
    v_mfma_f32_16x16x32_bf16 v[88:91], v[12:15], v[28:31], v[88:91]
    v_mfma_f32_16x16x32_bf16 v[108:111], v[16:19], v[28:31], v[108:111]
    v_mfma_f32_16x16x32_bf16 v[128:131], v[20:23], v[28:31], v[128:131]
    v_mfma_f32_16x16x32_bf16 v[180:183], v[196:199], v[28:31], v[180:183]
    v_mfma_f32_16x16x32_bf16 v[72:75], v[8:11], v[32:35], v[72:75]
    v_mfma_f32_16x16x32_bf16 v[92:95], v[12:15], v[32:35], v[92:95]
    v_mfma_f32_16x16x32_bf16 v[112:115], v[16:19], v[32:35], v[112:115]
    v_mfma_f32_16x16x32_bf16 v[132:135], v[20:23], v[32:35], v[132:135]
    v_mfma_f32_16x16x32_bf16 v[184:187], v[196:199], v[32:35], v[184:187]
    v_mfma_f32_16x16x32_bf16 v[76:79], v[8:11], v[36:39], v[76:79]
    v_mfma_f32_16x16x32_bf16 v[96:99], v[12:15], v[36:39], v[96:99]
    v_mfma_f32_16x16x32_bf16 v[116:119], v[16:19], v[36:39], v[116:119]
    v_mfma_f32_16x16x32_bf16 v[136:139], v[20:23], v[36:39], v[136:139]
    v_mfma_f32_16x16x32_bf16 v[188:191], v[196:199], v[36:39], v[188:191]
    v_mfma_f32_16x16x32_bf16 v[80:83], v[8:11], v[40:43], v[80:83]
    v_mfma_f32_16x16x32_bf16 v[100:103], v[12:15], v[40:43], v[100:103]
    v_mfma_f32_16x16x32_bf16 v[120:123], v[16:19], v[40:43], v[120:123]
    v_mfma_f32_16x16x32_bf16 v[140:143], v[20:23], v[40:43], v[140:143]
    v_mfma_f32_16x16x32_bf16 v[192:195], v[196:199], v[40:43], v[192:195]
Lj1done:
    s_lshl_b32 s3, s59, 9
    s_lshl_b32 s29, s58, 8
    s_add_u32 s3, s3, s29
    s_add_u32 s3, s3, 147456
    v_lshlrev_b32 v6, 2, v4
    v_add_u32 v6, s3, v6
    s_mul_i32 s3, s58, 640
    s_mul_i32 s29, s59, 320
    s_add_u32 s3, s3, s29
    s_add_u32 s3, s3, 149504
    v_lshlrev_b32 v7, 2, v4
    v_add_u32 v7, s3, v7
    s_mov_b32 s60, 0x22222222
    s_mov_b32 s61, s60
    s_mov_b32 s62, 0x44444444
    s_mov_b32 s63, s62
    s_mov_b32 s64, 0x88888888
    s_mov_b32 s65, s64
    s_nop 3
    v_cndmask_b32 v160, v160, v161, s[60:61]
    v_cndmask_b32 v160, v160, v162, s[62:63]
    v_cndmask_b32 v160, v160, v163, s[64:65]
    v_cndmask_b32 v164, v164, v165, s[60:61]
    v_cndmask_b32 v164, v164, v166, s[62:63]
    v_cndmask_b32 v164, v164, v167, s[64:65]
    v_cndmask_b32 v168, v168, v169, s[60:61]
    v_cndmask_b32 v168, v168, v170, s[62:63]
    v_cndmask_b32 v168, v168, v171, s[64:65]
    v_cndmask_b32 v172, v172, v173, s[60:61]
    v_cndmask_b32 v172, v172, v174, s[62:63]
    v_cndmask_b32 v172, v172, v175, s[64:65]
    s_mov_b32 exec_lo, 0x00f0000f
    s_mov_b32 exec_hi, 0xf0000f00
    ds_write_b32 v6, v144 offset:0
    ds_write_b32 v6, v160 offset:1024
    ds_write_b32 v6, v148 offset:64
    ds_write_b32 v6, v164 offset:1088
    ds_write_b32 v6, v152 offset:128
    ds_write_b32 v6, v168 offset:1152
    ds_write_b32 v6, v156 offset:192
    ds_write_b32 v6, v172 offset:1216
    ds_write_b32 v7, v176 offset:0
    ds_write_b32 v7, v180 offset:64
    ds_write_b32 v7, v184 offset:128
    ds_write_b32 v7, v188 offset:192
    ds_write_b32 v7, v192 offset:256
    s_mov_b64 exec, -1
    s_waitcnt lgkmcnt(0)
    s_barrier
    s_lshr_b32 s61, s24, 2
    s_and_b32 s62, s24, 3
    s_mul_i32 s60, s61, 2621440
    s_mul_i32 s3, s62, 5120
    s_add_u32 s60, s60, s3
    s_lshl_b32 s3, s59, 11
    s_add_u32 s63, s60, s3
    s_lshl_b32 s3, s59, 9
    s_add_u32 s64, s60, s3
    s_add_u32 s64, s64, 4096
    v_lshrrev_b32 v3, 1, v5
    v_sub_u32 v3, v5, v3
    v_lshlrev_b32 v3, 8, v3
    v_and_b32 v2, 1, v5
    v_lshlrev_b32 v2, 3, v2
    v_sub_u32 v3, v3, v2
    s_lshl_b32 s65, s23, 7
    s_lshl_b32 s3, s58, 6
    s_add_u32 s65, s65, s3
    s_mov_b32 s66, 0x3acccccd
    s_mov_b32 s67, 0x3727c5ac
    s_cmp_eq_u32 s61, 2
    s_cbranch_scc1 Lj1ev
    s_lshl_b32 s3, s58, 8
    s_add_u32 s3, s3, 147456
    v_lshlrev_b32 v6, 2, v4
    v_add_u32 v6, s3, v6
    s_mul_i32 s3, s59, 320
    s_add_u32 s3, s3, 149504
    v_lshlrev_b32 v7, 4, v5
    v_add_u32 v7, s3, v7
    ds_read2_b32 v[8:9], v6 offset0:0 offset1:128
    ds_read_b32 v10, v6 offset:1024
    ds_read_b32 v11, v6 offset:1536
    ds_read2_b32 v[12:13], v6 offset0:16 offset1:144
    ds_read_b32 v14, v6 offset:1088
    ds_read_b32 v15, v6 offset:1600
    ds_read2_b32 v[16:17], v6 offset0:32 offset1:160
    ds_read_b32 v18, v6 offset:1152
    ds_read_b32 v19, v6 offset:1664
    ds_read2_b32 v[20:21], v6 offset0:48 offset1:176
    ds_read_b32 v22, v6 offset:1216
    ds_read_b32 v23, v6 offset:1728
    ds_read_b128 v[144:147], v7 offset:0
    ds_read_b128 v[164:167], v7 offset:640
    ds_read_b128 v[148:151], v7 offset:64
    ds_read_b128 v[168:171], v7 offset:704
    ds_read_b128 v[152:155], v7 offset:128
    ds_read_b128 v[172:175], v7 offset:768
    ds_read_b128 v[156:159], v7 offset:192
    ds_read_b128 v[176:179], v7 offset:832
    ds_read_b128 v[160:163], v7 offset:256
    ds_read_b128 v[180:183], v7 offset:896
    s_lshr_b32 s3, s62, 1
    s_add_u32 s3, s3, 1
    s_sub_u32 s29, 0, s3
    s_bitcmp1_b32 s62, 0
    s_cselect_b32 s3, s29, s3
    s_cmp_eq_u32 s61, 3
    s_cselect_b32 s68, s3, 0
    s_add_u32 s3, s65, s68
    v_add_u32 v24, s3, v4
    s_movk_i32 s69, 0x5000
    v_add_u32 v25, 0, v24
    v_and_b32 v26, 0x7ff, v25
    v_cmp_eq_u32 vcc, v25, v26
    v_lshrrev_b32 v25, 4, v26
    v_and_b32 v26, 15, v26
    v_cndmask_b32 v32, 0, 1.0, vcc
    v_mul_lo_u32 v25, v25, s69
    v_lshl_add_u32 v26, v5, 4, v26
    v_lshl_add_u32 v28, v26, 4, v25
    v_add_u32 v25, 16, v24
    v_and_b32 v26, 0x7ff, v25
    v_cmp_eq_u32 vcc, v25, v26
    v_lshrrev_b32 v25, 4, v26
    v_and_b32 v26, 15, v26
    v_cndmask_b32 v33, 0, 1.0, vcc
    v_mul_lo_u32 v25, v25, s69
    v_lshl_add_u32 v26, v5, 4, v26
    v_lshl_add_u32 v29, v26, 4, v25
    v_add_u32 v25, 32, v24
    v_and_b32 v26, 0x7ff, v25
    v_cmp_eq_u32 vcc, v25, v26
    v_lshrrev_b32 v25, 4, v26
    v_and_b32 v26, 15, v26
    v_cndmask_b32 v34, 0, 1.0, vcc
    v_mul_lo_u32 v25, v25, s69
    v_lshl_add_u32 v26, v5, 4, v26
    v_lshl_add_u32 v30, v26, 4, v25
    v_add_u32 v25, 48, v24
    v_and_b32 v26, 0x7ff, v25
    v_cmp_eq_u32 vcc, v25, v26
    v_lshrrev_b32 v25, 4, v26
    v_and_b32 v26, 15, v26
    v_cndmask_b32 v35, 0, 1.0, vcc
    v_mul_lo_u32 v25, v25, s69
    v_lshl_add_u32 v26, v5, 4, v26
    v_lshl_add_u32 v31, v26, 4, v25
    s_waitcnt lgkmcnt(0)
    v_add_f32 v8, v8, v9
    v_add_f32 v10, v10, v11
    v_mul_f32 v8, s66, v8
    v_mul_f32 v10, s66, v10
    v_fma_f32 v10, -v8, v8, v10
    v_max_f32 v10, 0, v10
    v_add_f32 v11, s67, v10
    v_rsq_f32 v9, v11
    v_add_f32 v12, v12, v13
    v_add_f32 v14, v14, v15
    v_mul_f32 v12, s66, v12
    v_mul_f32 v14, s66, v14
    v_fma_f32 v14, -v12, v12, v14
    v_max_f32 v14, 0, v14
    v_add_f32 v15, s67, v14
    v_rsq_f32 v13, v15
    v_add_f32 v16, v16, v17
    v_add_f32 v18, v18, v19
    v_mul_f32 v16, s66, v16
    v_mul_f32 v18, s66, v18
    v_fma_f32 v18, -v16, v16, v18
    v_max_f32 v18, 0, v18
    v_add_f32 v19, s67, v18
    v_rsq_f32 v17, v19
    v_add_f32 v20, v20, v21
    v_add_f32 v22, v22, v23
    v_mul_f32 v20, s66, v20
    v_mul_f32 v22, s66, v22
    v_fma_f32 v22, -v20, v20, v22
    v_max_f32 v22, 0, v22
    v_add_f32 v23, s67, v22
    v_rsq_f32 v21, v23
    v_pk_add_f32 v[144:145], v[144:145], v[164:165]
    v_pk_add_f32 v[146:147], v[146:147], v[166:167]
    v_pk_add_f32 v[148:149], v[148:149], v[168:169]
    v_pk_add_f32 v[150:151], v[150:151], v[170:171]
    v_pk_add_f32 v[152:153], v[152:153], v[172:173]
    v_pk_add_f32 v[154:155], v[154:155], v[174:175]
    v_pk_add_f32 v[156:157], v[156:157], v[176:177]
    v_pk_add_f32 v[158:159], v[158:159], v[178:179]
    v_pk_add_f32 v[160:161], v[160:161], v[180:181]
    v_pk_add_f32 v[162:163], v[162:163], v[182:183]
    s_cmp_lg_u32 s24, 12
    s_cbranch_scc1 Lj1nost
    s_cmp_lg_u32 s59, 0
    s_cbranch_scc1 Lj1nost
    s_lshl_b32 s3, s65, 3
    s_add_u32 s3, s3, 0x1c00000
    v_lshlrev_b32 v6, 3, v4
    s_mov_b64 exec, 0xffff
    buffer_store_dwordx2 v[8:9], v6, s[8:11], s3 offen offset:0 sc1
    buffer_store_dwordx2 v[12:13], v6, s[8:11], s3 offen offset:128 sc1
    buffer_store_dwordx2 v[16:17], v6, s[8:11], s3 offen offset:256 sc1
    buffer_store_dwordx2 v[20:21], v6, s[8:11], s3 offen offset:384 sc1
    s_mov_b64 exec, -1
Lj1nost:
    s_cmp_lg_u32 s61, 3
    s_cbranch_scc1 Lj1nh
    v_mul_f32 v11, v9, v9
    v_fma_f32 v11, v11, v10, s67
    v_rsq_f32 v11, v11
    v_mul_f32 v10, v9, v32
    v_mul_f32 v11, v10, v11
    v_mov_b32 v10, v8

    v_mul_f32 v15, v13, v13
    v_fma_f32 v15, v15, v14, s67
    v_rsq_f32 v15, v15
    v_mul_f32 v14, v13, v33
    v_mul_f32 v15, v14, v15
    v_mov_b32 v14, v12

    v_mul_f32 v19, v17, v17
    v_fma_f32 v19, v19, v18, s67
    v_rsq_f32 v19, v19
    v_mul_f32 v18, v17, v34
    v_mul_f32 v19, v18, v19
    v_mov_b32 v18, v16

    v_mul_f32 v23, v21, v21
    v_fma_f32 v23, v23, v22, s67
    v_rsq_f32 v23, v23
    v_mul_f32 v22, v21, v35
    v_mul_f32 v23, v22, v23
    v_mov_b32 v22, v20

    s_branch Lj1nh2
Lj1nh:
    v_mov_b32 v10, v8
    v_mov_b32 v11, v9
    v_mov_b32 v14, v12
    v_mov_b32 v15, v13
    v_mov_b32 v18, v16
    v_mov_b32 v19, v17
    v_mov_b32 v22, v20
    v_mov_b32 v23, v21
Lj1nh2:
    s_mov_b32 s54, 0xbdd2d3e8
    s_mov_b32 s55, s54
    v_mov_b32 v44, 0xc0135761
    v_mov_b32 v45, v44
    v_pk_fma_f32 v[64:65], v[144:145], v[10:11], v[64:65] op_sel_hi:[1,0,1] neg_lo:[1,0,0] neg_hi:[1,0,0]
    v_pk_fma_f32 v[66:67], v[146:147], v[10:11], v[66:67] op_sel_hi:[1,0,1] neg_lo:[1,0,0] neg_hi:[1,0,0]
    v_pk_fma_f32 v[68:69], v[148:149], v[10:11], v[68:69] op_sel_hi:[1,0,1] neg_lo:[1,0,0] neg_hi:[1,0,0]
    v_pk_fma_f32 v[70:71], v[150:151], v[10:11], v[70:71] op_sel_hi:[1,0,1] neg_lo:[1,0,0] neg_hi:[1,0,0]
    v_pk_fma_f32 v[72:73], v[152:153], v[10:11], v[72:73] op_sel_hi:[1,0,1] neg_lo:[1,0,0] neg_hi:[1,0,0]
    v_pk_fma_f32 v[74:75], v[154:155], v[10:11], v[74:75] op_sel_hi:[1,0,1] neg_lo:[1,0,0] neg_hi:[1,0,0]
    v_pk_fma_f32 v[76:77], v[156:157], v[10:11], v[76:77] op_sel_hi:[1,0,1] neg_lo:[1,0,0] neg_hi:[1,0,0]
    v_pk_fma_f32 v[78:79], v[158:159], v[10:11], v[78:79] op_sel_hi:[1,0,1] neg_lo:[1,0,0] neg_hi:[1,0,0]
    v_pk_fma_f32 v[80:81], v[160:161], v[10:11], v[80:81] op_sel_hi:[1,0,1] neg_lo:[1,0,0] neg_hi:[1,0,0]
    v_pk_fma_f32 v[82:83], v[162:163], v[10:11], v[82:83] op_sel_hi:[1,0,1] neg_lo:[1,0,0] neg_hi:[1,0,0]
    v_pk_mul_f32 v[64:65], v[64:65], v[10:11] op_sel:[0,1] op_sel_hi:[1,1]
    v_pk_mul_f32 v[66:67], v[66:67], v[10:11] op_sel:[0,1] op_sel_hi:[1,1]
    v_pk_mul_f32 v[68:69], v[68:69], v[10:11] op_sel:[0,1] op_sel_hi:[1,1]
    v_pk_mul_f32 v[70:71], v[70:71], v[10:11] op_sel:[0,1] op_sel_hi:[1,1]
    v_pk_mul_f32 v[72:73], v[72:73], v[10:11] op_sel:[0,1] op_sel_hi:[1,1]
    v_pk_mul_f32 v[74:75], v[74:75], v[10:11] op_sel:[0,1] op_sel_hi:[1,1]
    v_pk_mul_f32 v[76:77], v[76:77], v[10:11] op_sel:[0,1] op_sel_hi:[1,1]
    v_pk_mul_f32 v[78:79], v[78:79], v[10:11] op_sel:[0,1] op_sel_hi:[1,1]
    v_pk_mul_f32 v[80:81], v[80:81], v[10:11] op_sel:[0,1] op_sel_hi:[1,1]
    v_pk_mul_f32 v[82:83], v[82:83], v[10:11] op_sel:[0,1] op_sel_hi:[1,1]
    s_cmp_lg_u32 s61, 3
    s_cbranch_scc1 Lsk1
    v_pk_mul_f32 v[36:37], v[64:65], v[64:65]
    v_pk_mul_f32 v[38:39], v[66:67], v[66:67]
    v_pk_mul_f32 v[40:41], v[68:69], v[68:69]
    v_pk_mul_f32 v[42:43], v[70:71], v[70:71]
    v_pk_fma_f32 v[36:37], v[36:37], s[54:55], v[44:45]
    v_pk_fma_f32 v[38:39], v[38:39], s[54:55], v[44:45]
    v_pk_fma_f32 v[40:41], v[40:41], s[54:55], v[44:45]
    v_pk_fma_f32 v[42:43], v[42:43], s[54:55], v[44:45]
    v_pk_mul_f32 v[36:37], v[36:37], v[64:65]
    v_pk_mul_f32 v[38:39], v[38:39], v[66:67]
    v_pk_mul_f32 v[40:41], v[40:41], v[68:69]
    v_pk_mul_f32 v[42:43], v[42:43], v[70:71]
    v_exp_f32 v36, v36
    v_exp_f32 v37, v37
    v_exp_f32 v38, v38
    v_exp_f32 v39, v39
    v_exp_f32 v40, v40
    v_exp_f32 v41, v41
    v_exp_f32 v42, v42
    v_exp_f32 v43, v43
    v_pk_add_f32 v[36:37], v[36:37], 1.0 op_sel_hi:[1,0]
    v_pk_add_f32 v[38:39], v[38:39], 1.0 op_sel_hi:[1,0]
    v_pk_add_f32 v[40:41], v[40:41], 1.0 op_sel_hi:[1,0]
    v_pk_add_f32 v[42:43], v[42:43], 1.0 op_sel_hi:[1,0]
    v_rcp_f32 v36, v36
    v_rcp_f32 v37, v37
    v_rcp_f32 v38, v38
    v_rcp_f32 v39, v39
    v_rcp_f32 v40, v40
    v_rcp_f32 v41, v41
    v_rcp_f32 v42, v42
    v_rcp_f32 v43, v43
    v_pk_mul_f32 v[64:65], v[64:65], v[36:37]
    v_pk_mul_f32 v[66:67], v[66:67], v[38:39]
    v_pk_mul_f32 v[68:69], v[68:69], v[40:41]
    v_pk_mul_f32 v[70:71], v[70:71], v[42:43]
    v_pk_mul_f32 v[36:37], v[72:73], v[72:73]
    v_pk_mul_f32 v[38:39], v[74:75], v[74:75]
    v_pk_mul_f32 v[40:41], v[76:77], v[76:77]
    v_pk_mul_f32 v[42:43], v[78:79], v[78:79]
    v_pk_fma_f32 v[36:37], v[36:37], s[54:55], v[44:45]
    v_pk_fma_f32 v[38:39], v[38:39], s[54:55], v[44:45]
    v_pk_fma_f32 v[40:41], v[40:41], s[54:55], v[44:45]
    v_pk_fma_f32 v[42:43], v[42:43], s[54:55], v[44:45]
    v_pk_mul_f32 v[36:37], v[36:37], v[72:73]
    v_pk_mul_f32 v[38:39], v[38:39], v[74:75]
    v_pk_mul_f32 v[40:41], v[40:41], v[76:77]
    v_pk_mul_f32 v[42:43], v[42:43], v[78:79]
    v_exp_f32 v36, v36
    v_exp_f32 v37, v37
    v_exp_f32 v38, v38
    v_exp_f32 v39, v39
    v_exp_f32 v40, v40
    v_exp_f32 v41, v41
    v_exp_f32 v42, v42
    v_exp_f32 v43, v43
    v_pk_add_f32 v[36:37], v[36:37], 1.0 op_sel_hi:[1,0]
    v_pk_add_f32 v[38:39], v[38:39], 1.0 op_sel_hi:[1,0]
    v_pk_add_f32 v[40:41], v[40:41], 1.0 op_sel_hi:[1,0]
    v_pk_add_f32 v[42:43], v[42:43], 1.0 op_sel_hi:[1,0]
    v_rcp_f32 v36, v36
    v_rcp_f32 v37, v37
    v_rcp_f32 v38, v38
    v_rcp_f32 v39, v39
    v_rcp_f32 v40, v40
    v_rcp_f32 v41, v41
    v_rcp_f32 v42, v42
    v_rcp_f32 v43, v43
    v_pk_mul_f32 v[72:73], v[72:73], v[36:37]
    v_pk_mul_f32 v[74:75], v[74:75], v[38:39]
    v_pk_mul_f32 v[76:77], v[76:77], v[40:41]
    v_pk_mul_f32 v[78:79], v[78:79], v[42:43]
    v_pk_mul_f32 v[36:37], v[80:81], v[80:81]
    v_pk_mul_f32 v[38:39], v[82:83], v[82:83]
    v_pk_fma_f32 v[36:37], v[36:37], s[54:55], v[44:45]
    v_pk_fma_f32 v[38:39], v[38:39], s[54:55], v[44:45]
    v_pk_mul_f32 v[36:37], v[36:37], v[80:81]
    v_pk_mul_f32 v[38:39], v[38:39], v[82:83]
    v_exp_f32 v36, v36
    v_exp_f32 v37, v37
    v_exp_f32 v38, v38
    v_exp_f32 v39, v39
    v_pk_add_f32 v[36:37], v[36:37], 1.0 op_sel_hi:[1,0]
    v_pk_add_f32 v[38:39], v[38:39], 1.0 op_sel_hi:[1,0]
    v_rcp_f32 v36, v36
    v_rcp_f32 v37, v37
    v_rcp_f32 v38, v38
    v_rcp_f32 v39, v39
    v_pk_mul_f32 v[80:81], v[80:81], v[36:37]
    v_pk_mul_f32 v[82:83], v[82:83], v[38:39]
Lsk1:
    v_cvt_pk_bf16_f32 v200, v64, v65
    v_cvt_pk_bf16_f32 v201, v66, v67
    v_cvt_pk_bf16_f32 v202, v68, v69
    v_cvt_pk_bf16_f32 v203, v70, v71
    v_cvt_pk_bf16_f32 v204, v72, v73
    v_cvt_pk_bf16_f32 v205, v74, v75
    v_cvt_pk_bf16_f32 v206, v76, v77
    v_cvt_pk_bf16_f32 v207, v78, v79
    v_cvt_pk_bf16_f32 v208, v80, v81
    v_cvt_pk_bf16_f32 v209, v82, v83
    buffer_store_dwordx4 v[200:203], v28, s[8:11], s63 offen offset:0 sc1
    buffer_store_dwordx4 v[204:207], v28, s[8:11], s63 offen offset:1024 sc1
    v_sub_u32 v2, v28, v3
    buffer_store_dwordx2 v[208:209], v2, s[8:11], s64 offen offset:0 sc1
    v_pk_fma_f32 v[84:85], v[144:145], v[14:15], v[84:85] op_sel_hi:[1,0,1] neg_lo:[1,0,0] neg_hi:[1,0,0]
    v_pk_fma_f32 v[86:87], v[146:147], v[14:15], v[86:87] op_sel_hi:[1,0,1] neg_lo:[1,0,0] neg_hi:[1,0,0]
    v_pk_fma_f32 v[88:89], v[148:149], v[14:15], v[88:89] op_sel_hi:[1,0,1] neg_lo:[1,0,0] neg_hi:[1,0,0]
    v_pk_fma_f32 v[90:91], v[150:151], v[14:15], v[90:91] op_sel_hi:[1,0,1] neg_lo:[1,0,0] neg_hi:[1,0,0]
    v_pk_fma_f32 v[92:93], v[152:153], v[14:15], v[92:93] op_sel_hi:[1,0,1] neg_lo:[1,0,0] neg_hi:[1,0,0]
    v_pk_fma_f32 v[94:95], v[154:155], v[14:15], v[94:95] op_sel_hi:[1,0,1] neg_lo:[1,0,0] neg_hi:[1,0,0]
    v_pk_fma_f32 v[96:97], v[156:157], v[14:15], v[96:97] op_sel_hi:[1,0,1] neg_lo:[1,0,0] neg_hi:[1,0,0]
    v_pk_fma_f32 v[98:99], v[158:159], v[14:15], v[98:99] op_sel_hi:[1,0,1] neg_lo:[1,0,0] neg_hi:[1,0,0]
    v_pk_fma_f32 v[100:101], v[160:161], v[14:15], v[100:101] op_sel_hi:[1,0,1] neg_lo:[1,0,0] neg_hi:[1,0,0]
    v_pk_fma_f32 v[102:103], v[162:163], v[14:15], v[102:103] op_sel_hi:[1,0,1] neg_lo:[1,0,0] neg_hi:[1,0,0]
    v_pk_mul_f32 v[84:85], v[84:85], v[14:15] op_sel:[0,1] op_sel_hi:[1,1]
    v_pk_mul_f32 v[86:87], v[86:87], v[14:15] op_sel:[0,1] op_sel_hi:[1,1]
    v_pk_mul_f32 v[88:89], v[88:89], v[14:15] op_sel:[0,1] op_sel_hi:[1,1]
    v_pk_mul_f32 v[90:91], v[90:91], v[14:15] op_sel:[0,1] op_sel_hi:[1,1]
    v_pk_mul_f32 v[92:93], v[92:93], v[14:15] op_sel:[0,1] op_sel_hi:[1,1]
    v_pk_mul_f32 v[94:95], v[94:95], v[14:15] op_sel:[0,1] op_sel_hi:[1,1]
    v_pk_mul_f32 v[96:97], v[96:97], v[14:15] op_sel:[0,1] op_sel_hi:[1,1]
    v_pk_mul_f32 v[98:99], v[98:99], v[14:15] op_sel:[0,1] op_sel_hi:[1,1]
    v_pk_mul_f32 v[100:101], v[100:101], v[14:15] op_sel:[0,1] op_sel_hi:[1,1]
    v_pk_mul_f32 v[102:103], v[102:103], v[14:15] op_sel:[0,1] op_sel_hi:[1,1]
    s_cmp_lg_u32 s61, 3
    s_cbranch_scc1 Lsk2
    v_pk_mul_f32 v[36:37], v[84:85], v[84:85]
    v_pk_mul_f32 v[38:39], v[86:87], v[86:87]
    v_pk_mul_f32 v[40:41], v[88:89], v[88:89]
    v_pk_mul_f32 v[42:43], v[90:91], v[90:91]
    v_pk_fma_f32 v[36:37], v[36:37], s[54:55], v[44:45]
    v_pk_fma_f32 v[38:39], v[38:39], s[54:55], v[44:45]
    v_pk_fma_f32 v[40:41], v[40:41], s[54:55], v[44:45]
    v_pk_fma_f32 v[42:43], v[42:43], s[54:55], v[44:45]
    v_pk_mul_f32 v[36:37], v[36:37], v[84:85]
    v_pk_mul_f32 v[38:39], v[38:39], v[86:87]
    v_pk_mul_f32 v[40:41], v[40:41], v[88:89]
    v_pk_mul_f32 v[42:43], v[42:43], v[90:91]
    v_exp_f32 v36, v36
    v_exp_f32 v37, v37
    v_exp_f32 v38, v38
    v_exp_f32 v39, v39
    v_exp_f32 v40, v40
    v_exp_f32 v41, v41
    v_exp_f32 v42, v42
    v_exp_f32 v43, v43
    v_pk_add_f32 v[36:37], v[36:37], 1.0 op_sel_hi:[1,0]
    v_pk_add_f32 v[38:39], v[38:39], 1.0 op_sel_hi:[1,0]
    v_pk_add_f32 v[40:41], v[40:41], 1.0 op_sel_hi:[1,0]
    v_pk_add_f32 v[42:43], v[42:43], 1.0 op_sel_hi:[1,0]
    v_rcp_f32 v36, v36
    v_rcp_f32 v37, v37
    v_rcp_f32 v38, v38
    v_rcp_f32 v39, v39
    v_rcp_f32 v40, v40
    v_rcp_f32 v41, v41
    v_rcp_f32 v42, v42
    v_rcp_f32 v43, v43
    v_pk_mul_f32 v[84:85], v[84:85], v[36:37]
    v_pk_mul_f32 v[86:87], v[86:87], v[38:39]
    v_pk_mul_f32 v[88:89], v[88:89], v[40:41]
    v_pk_mul_f32 v[90:91], v[90:91], v[42:43]
    v_pk_mul_f32 v[36:37], v[92:93], v[92:93]
    v_pk_mul_f32 v[38:39], v[94:95], v[94:95]
    v_pk_mul_f32 v[40:41], v[96:97], v[96:97]
    v_pk_mul_f32 v[42:43], v[98:99], v[98:99]
    v_pk_fma_f32 v[36:37], v[36:37], s[54:55], v[44:45]
    v_pk_fma_f32 v[38:39], v[38:39], s[54:55], v[44:45]
    v_pk_fma_f32 v[40:41], v[40:41], s[54:55], v[44:45]
    v_pk_fma_f32 v[42:43], v[42:43], s[54:55], v[44:45]
    v_pk_mul_f32 v[36:37], v[36:37], v[92:93]
    v_pk_mul_f32 v[38:39], v[38:39], v[94:95]
    v_pk_mul_f32 v[40:41], v[40:41], v[96:97]
    v_pk_mul_f32 v[42:43], v[42:43], v[98:99]
    v_exp_f32 v36, v36
    v_exp_f32 v37, v37
    v_exp_f32 v38, v38
    v_exp_f32 v39, v39
    v_exp_f32 v40, v40
    v_exp_f32 v41, v41
    v_exp_f32 v42, v42
    v_exp_f32 v43, v43
    v_pk_add_f32 v[36:37], v[36:37], 1.0 op_sel_hi:[1,0]
    v_pk_add_f32 v[38:39], v[38:39], 1.0 op_sel_hi:[1,0]
    v_pk_add_f32 v[40:41], v[40:41], 1.0 op_sel_hi:[1,0]
    v_pk_add_f32 v[42:43], v[42:43], 1.0 op_sel_hi:[1,0]
    v_rcp_f32 v36, v36
    v_rcp_f32 v37, v37
    v_rcp_f32 v38, v38
    v_rcp_f32 v39, v39
    v_rcp_f32 v40, v40
    v_rcp_f32 v41, v41
    v_rcp_f32 v42, v42
    v_rcp_f32 v43, v43
    v_pk_mul_f32 v[92:93], v[92:93], v[36:37]
    v_pk_mul_f32 v[94:95], v[94:95], v[38:39]
    v_pk_mul_f32 v[96:97], v[96:97], v[40:41]
    v_pk_mul_f32 v[98:99], v[98:99], v[42:43]
    v_pk_mul_f32 v[36:37], v[100:101], v[100:101]
    v_pk_mul_f32 v[38:39], v[102:103], v[102:103]
    v_pk_fma_f32 v[36:37], v[36:37], s[54:55], v[44:45]
    v_pk_fma_f32 v[38:39], v[38:39], s[54:55], v[44:45]
    v_pk_mul_f32 v[36:37], v[36:37], v[100:101]
    v_pk_mul_f32 v[38:39], v[38:39], v[102:103]
    v_exp_f32 v36, v36
    v_exp_f32 v37, v37
    v_exp_f32 v38, v38
    v_exp_f32 v39, v39
    v_pk_add_f32 v[36:37], v[36:37], 1.0 op_sel_hi:[1,0]
    v_pk_add_f32 v[38:39], v[38:39], 1.0 op_sel_hi:[1,0]
    v_rcp_f32 v36, v36
    v_rcp_f32 v37, v37
    v_rcp_f32 v38, v38
    v_rcp_f32 v39, v39
    v_pk_mul_f32 v[100:101], v[100:101], v[36:37]
    v_pk_mul_f32 v[102:103], v[102:103], v[38:39]
Lsk2:
    v_cvt_pk_bf16_f32 v212, v84, v85
    v_cvt_pk_bf16_f32 v213, v86, v87
    v_cvt_pk_bf16_f32 v214, v88, v89
    v_cvt_pk_bf16_f32 v215, v90, v91
    v_cvt_pk_bf16_f32 v216, v92, v93
    v_cvt_pk_bf16_f32 v217, v94, v95
    v_cvt_pk_bf16_f32 v218, v96, v97
    v_cvt_pk_bf16_f32 v219, v98, v99
    v_cvt_pk_bf16_f32 v220, v100, v101
    v_cvt_pk_bf16_f32 v221, v102, v103
    buffer_store_dwordx4 v[212:215], v29, s[8:11], s63 offen offset:0 sc1
    buffer_store_dwordx4 v[216:219], v29, s[8:11], s63 offen offset:1024 sc1
    v_sub_u32 v2, v29, v3
    buffer_store_dwordx2 v[220:221], v2, s[8:11], s64 offen offset:0 sc1
    v_pk_fma_f32 v[104:105], v[144:145], v[18:19], v[104:105] op_sel_hi:[1,0,1] neg_lo:[1,0,0] neg_hi:[1,0,0]
    v_pk_fma_f32 v[106:107], v[146:147], v[18:19], v[106:107] op_sel_hi:[1,0,1] neg_lo:[1,0,0] neg_hi:[1,0,0]
    v_pk_fma_f32 v[108:109], v[148:149], v[18:19], v[108:109] op_sel_hi:[1,0,1] neg_lo:[1,0,0] neg_hi:[1,0,0]
    v_pk_fma_f32 v[110:111], v[150:151], v[18:19], v[110:111] op_sel_hi:[1,0,1] neg_lo:[1,0,0] neg_hi:[1,0,0]
    v_pk_fma_f32 v[112:113], v[152:153], v[18:19], v[112:113] op_sel_hi:[1,0,1] neg_lo:[1,0,0] neg_hi:[1,0,0]
    v_pk_fma_f32 v[114:115], v[154:155], v[18:19], v[114:115] op_sel_hi:[1,0,1] neg_lo:[1,0,0] neg_hi:[1,0,0]
    v_pk_fma_f32 v[116:117], v[156:157], v[18:19], v[116:117] op_sel_hi:[1,0,1] neg_lo:[1,0,0] neg_hi:[1,0,0]
    v_pk_fma_f32 v[118:119], v[158:159], v[18:19], v[118:119] op_sel_hi:[1,0,1] neg_lo:[1,0,0] neg_hi:[1,0,0]
    v_pk_fma_f32 v[120:121], v[160:161], v[18:19], v[120:121] op_sel_hi:[1,0,1] neg_lo:[1,0,0] neg_hi:[1,0,0]
    v_pk_fma_f32 v[122:123], v[162:163], v[18:19], v[122:123] op_sel_hi:[1,0,1] neg_lo:[1,0,0] neg_hi:[1,0,0]
    v_pk_mul_f32 v[104:105], v[104:105], v[18:19] op_sel:[0,1] op_sel_hi:[1,1]
    v_pk_mul_f32 v[106:107], v[106:107], v[18:19] op_sel:[0,1] op_sel_hi:[1,1]
    v_pk_mul_f32 v[108:109], v[108:109], v[18:19] op_sel:[0,1] op_sel_hi:[1,1]
    v_pk_mul_f32 v[110:111], v[110:111], v[18:19] op_sel:[0,1] op_sel_hi:[1,1]
    v_pk_mul_f32 v[112:113], v[112:113], v[18:19] op_sel:[0,1] op_sel_hi:[1,1]
    v_pk_mul_f32 v[114:115], v[114:115], v[18:19] op_sel:[0,1] op_sel_hi:[1,1]
    v_pk_mul_f32 v[116:117], v[116:117], v[18:19] op_sel:[0,1] op_sel_hi:[1,1]
    v_pk_mul_f32 v[118:119], v[118:119], v[18:19] op_sel:[0,1] op_sel_hi:[1,1]
    v_pk_mul_f32 v[120:121], v[120:121], v[18:19] op_sel:[0,1] op_sel_hi:[1,1]
    v_pk_mul_f32 v[122:123], v[122:123], v[18:19] op_sel:[0,1] op_sel_hi:[1,1]
    s_cmp_lg_u32 s61, 3
    s_cbranch_scc1 Lsk3
    v_pk_mul_f32 v[36:37], v[104:105], v[104:105]
    v_pk_mul_f32 v[38:39], v[106:107], v[106:107]
    v_pk_mul_f32 v[40:41], v[108:109], v[108:109]
    v_pk_mul_f32 v[42:43], v[110:111], v[110:111]
    v_pk_fma_f32 v[36:37], v[36:37], s[54:55], v[44:45]
    v_pk_fma_f32 v[38:39], v[38:39], s[54:55], v[44:45]
    v_pk_fma_f32 v[40:41], v[40:41], s[54:55], v[44:45]
    v_pk_fma_f32 v[42:43], v[42:43], s[54:55], v[44:45]
    v_pk_mul_f32 v[36:37], v[36:37], v[104:105]
    v_pk_mul_f32 v[38:39], v[38:39], v[106:107]
    v_pk_mul_f32 v[40:41], v[40:41], v[108:109]
    v_pk_mul_f32 v[42:43], v[42:43], v[110:111]
    v_exp_f32 v36, v36
    v_exp_f32 v37, v37
    v_exp_f32 v38, v38
    v_exp_f32 v39, v39
    v_exp_f32 v40, v40
    v_exp_f32 v41, v41
    v_exp_f32 v42, v42
    v_exp_f32 v43, v43
    v_pk_add_f32 v[36:37], v[36:37], 1.0 op_sel_hi:[1,0]
    v_pk_add_f32 v[38:39], v[38:39], 1.0 op_sel_hi:[1,0]
    v_pk_add_f32 v[40:41], v[40:41], 1.0 op_sel_hi:[1,0]
    v_pk_add_f32 v[42:43], v[42:43], 1.0 op_sel_hi:[1,0]
    v_rcp_f32 v36, v36
    v_rcp_f32 v37, v37
    v_rcp_f32 v38, v38
    v_rcp_f32 v39, v39
    v_rcp_f32 v40, v40
    v_rcp_f32 v41, v41
    v_rcp_f32 v42, v42
    v_rcp_f32 v43, v43
    v_pk_mul_f32 v[104:105], v[104:105], v[36:37]
    v_pk_mul_f32 v[106:107], v[106:107], v[38:39]
    v_pk_mul_f32 v[108:109], v[108:109], v[40:41]
    v_pk_mul_f32 v[110:111], v[110:111], v[42:43]
    v_pk_mul_f32 v[36:37], v[112:113], v[112:113]
    v_pk_mul_f32 v[38:39], v[114:115], v[114:115]
    v_pk_mul_f32 v[40:41], v[116:117], v[116:117]
    v_pk_mul_f32 v[42:43], v[118:119], v[118:119]
    v_pk_fma_f32 v[36:37], v[36:37], s[54:55], v[44:45]
    v_pk_fma_f32 v[38:39], v[38:39], s[54:55], v[44:45]
    v_pk_fma_f32 v[40:41], v[40:41], s[54:55], v[44:45]
    v_pk_fma_f32 v[42:43], v[42:43], s[54:55], v[44:45]
    v_pk_mul_f32 v[36:37], v[36:37], v[112:113]
    v_pk_mul_f32 v[38:39], v[38:39], v[114:115]
    v_pk_mul_f32 v[40:41], v[40:41], v[116:117]
    v_pk_mul_f32 v[42:43], v[42:43], v[118:119]
    v_exp_f32 v36, v36
    v_exp_f32 v37, v37
    v_exp_f32 v38, v38
    v_exp_f32 v39, v39
    v_exp_f32 v40, v40
    v_exp_f32 v41, v41
    v_exp_f32 v42, v42
    v_exp_f32 v43, v43
    v_pk_add_f32 v[36:37], v[36:37], 1.0 op_sel_hi:[1,0]
    v_pk_add_f32 v[38:39], v[38:39], 1.0 op_sel_hi:[1,0]
    v_pk_add_f32 v[40:41], v[40:41], 1.0 op_sel_hi:[1,0]
    v_pk_add_f32 v[42:43], v[42:43], 1.0 op_sel_hi:[1,0]
    v_rcp_f32 v36, v36
    v_rcp_f32 v37, v37
    v_rcp_f32 v38, v38
    v_rcp_f32 v39, v39
    v_rcp_f32 v40, v40
    v_rcp_f32 v41, v41
    v_rcp_f32 v42, v42
    v_rcp_f32 v43, v43
    v_pk_mul_f32 v[112:113], v[112:113], v[36:37]
    v_pk_mul_f32 v[114:115], v[114:115], v[38:39]
    v_pk_mul_f32 v[116:117], v[116:117], v[40:41]
    v_pk_mul_f32 v[118:119], v[118:119], v[42:43]
    v_pk_mul_f32 v[36:37], v[120:121], v[120:121]
    v_pk_mul_f32 v[38:39], v[122:123], v[122:123]
    v_pk_fma_f32 v[36:37], v[36:37], s[54:55], v[44:45]
    v_pk_fma_f32 v[38:39], v[38:39], s[54:55], v[44:45]
    v_pk_mul_f32 v[36:37], v[36:37], v[120:121]
    v_pk_mul_f32 v[38:39], v[38:39], v[122:123]
    v_exp_f32 v36, v36
    v_exp_f32 v37, v37
    v_exp_f32 v38, v38
    v_exp_f32 v39, v39
    v_pk_add_f32 v[36:37], v[36:37], 1.0 op_sel_hi:[1,0]
    v_pk_add_f32 v[38:39], v[38:39], 1.0 op_sel_hi:[1,0]
    v_rcp_f32 v36, v36
    v_rcp_f32 v37, v37
    v_rcp_f32 v38, v38
    v_rcp_f32 v39, v39
    v_pk_mul_f32 v[120:121], v[120:121], v[36:37]
    v_pk_mul_f32 v[122:123], v[122:123], v[38:39]
Lsk3:
    v_cvt_pk_bf16_f32 v200, v104, v105
    v_cvt_pk_bf16_f32 v201, v106, v107
    v_cvt_pk_bf16_f32 v202, v108, v109
    v_cvt_pk_bf16_f32 v203, v110, v111
    v_cvt_pk_bf16_f32 v204, v112, v113
    v_cvt_pk_bf16_f32 v205, v114, v115
    v_cvt_pk_bf16_f32 v206, v116, v117
    v_cvt_pk_bf16_f32 v207, v118, v119
    v_cvt_pk_bf16_f32 v208, v120, v121
    v_cvt_pk_bf16_f32 v209, v122, v123
    buffer_store_dwordx4 v[200:203], v30 , s[8:11], s63 offen offset:0 sc1
    buffer_store_dwordx4 v[204:207], v30 , s[8:11], s63 offen offset:1024 sc1
    v_sub_u32 v2, v30 , v3
    buffer_store_dwordx2 v[208:209], v2, s[8:11], s64 offen offset:0 sc1
    v_pk_fma_f32 v[124:125], v[144:145], v[22:23], v[124:125] op_sel_hi:[1,0,1] neg_lo:[1,0,0] neg_hi:[1,0,0]
    v_pk_fma_f32 v[126:127], v[146:147], v[22:23], v[126:127] op_sel_hi:[1,0,1] neg_lo:[1,0,0] neg_hi:[1,0,0]
    v_pk_fma_f32 v[128:129], v[148:149], v[22:23], v[128:129] op_sel_hi:[1,0,1] neg_lo:[1,0,0] neg_hi:[1,0,0]
    v_pk_fma_f32 v[130:131], v[150:151], v[22:23], v[130:131] op_sel_hi:[1,0,1] neg_lo:[1,0,0] neg_hi:[1,0,0]
    v_pk_fma_f32 v[132:133], v[152:153], v[22:23], v[132:133] op_sel_hi:[1,0,1] neg_lo:[1,0,0] neg_hi:[1,0,0]
    v_pk_fma_f32 v[134:135], v[154:155], v[22:23], v[134:135] op_sel_hi:[1,0,1] neg_lo:[1,0,0] neg_hi:[1,0,0]
    v_pk_fma_f32 v[136:137], v[156:157], v[22:23], v[136:137] op_sel_hi:[1,0,1] neg_lo:[1,0,0] neg_hi:[1,0,0]
    v_pk_fma_f32 v[138:139], v[158:159], v[22:23], v[138:139] op_sel_hi:[1,0,1] neg_lo:[1,0,0] neg_hi:[1,0,0]
    v_pk_fma_f32 v[140:141], v[160:161], v[22:23], v[140:141] op_sel_hi:[1,0,1] neg_lo:[1,0,0] neg_hi:[1,0,0]
    v_pk_fma_f32 v[142:143], v[162:163], v[22:23], v[142:143] op_sel_hi:[1,0,1] neg_lo:[1,0,0] neg_hi:[1,0,0]
    v_pk_mul_f32 v[124:125], v[124:125], v[22:23] op_sel:[0,1] op_sel_hi:[1,1]
    v_pk_mul_f32 v[126:127], v[126:127], v[22:23] op_sel:[0,1] op_sel_hi:[1,1]
    v_pk_mul_f32 v[128:129], v[128:129], v[22:23] op_sel:[0,1] op_sel_hi:[1,1]
    v_pk_mul_f32 v[130:131], v[130:131], v[22:23] op_sel:[0,1] op_sel_hi:[1,1]
    v_pk_mul_f32 v[132:133], v[132:133], v[22:23] op_sel:[0,1] op_sel_hi:[1,1]
    v_pk_mul_f32 v[134:135], v[134:135], v[22:23] op_sel:[0,1] op_sel_hi:[1,1]
    v_pk_mul_f32 v[136:137], v[136:137], v[22:23] op_sel:[0,1] op_sel_hi:[1,1]
    v_pk_mul_f32 v[138:139], v[138:139], v[22:23] op_sel:[0,1] op_sel_hi:[1,1]
    v_pk_mul_f32 v[140:141], v[140:141], v[22:23] op_sel:[0,1] op_sel_hi:[1,1]
    v_pk_mul_f32 v[142:143], v[142:143], v[22:23] op_sel:[0,1] op_sel_hi:[1,1]
    s_cmp_lg_u32 s61, 3
    s_cbranch_scc1 Lsk4
    v_pk_mul_f32 v[36:37], v[124:125], v[124:125]
    v_pk_mul_f32 v[38:39], v[126:127], v[126:127]
    v_pk_mul_f32 v[40:41], v[128:129], v[128:129]
    v_pk_mul_f32 v[42:43], v[130:131], v[130:131]
    v_pk_fma_f32 v[36:37], v[36:37], s[54:55], v[44:45]
    v_pk_fma_f32 v[38:39], v[38:39], s[54:55], v[44:45]
    v_pk_fma_f32 v[40:41], v[40:41], s[54:55], v[44:45]
    v_pk_fma_f32 v[42:43], v[42:43], s[54:55], v[44:45]
    v_pk_mul_f32 v[36:37], v[36:37], v[124:125]
    v_pk_mul_f32 v[38:39], v[38:39], v[126:127]
    v_pk_mul_f32 v[40:41], v[40:41], v[128:129]
    v_pk_mul_f32 v[42:43], v[42:43], v[130:131]
    v_exp_f32 v36, v36
    v_exp_f32 v37, v37
    v_exp_f32 v38, v38
    v_exp_f32 v39, v39
    v_exp_f32 v40, v40
    v_exp_f32 v41, v41
    v_exp_f32 v42, v42
    v_exp_f32 v43, v43
    v_pk_add_f32 v[36:37], v[36:37], 1.0 op_sel_hi:[1,0]
    v_pk_add_f32 v[38:39], v[38:39], 1.0 op_sel_hi:[1,0]
    v_pk_add_f32 v[40:41], v[40:41], 1.0 op_sel_hi:[1,0]
    v_pk_add_f32 v[42:43], v[42:43], 1.0 op_sel_hi:[1,0]
    v_rcp_f32 v36, v36
    v_rcp_f32 v37, v37
    v_rcp_f32 v38, v38
    v_rcp_f32 v39, v39
    v_rcp_f32 v40, v40
    v_rcp_f32 v41, v41
    v_rcp_f32 v42, v42
    v_rcp_f32 v43, v43
    v_pk_mul_f32 v[124:125], v[124:125], v[36:37]
    v_pk_mul_f32 v[126:127], v[126:127], v[38:39]
    v_pk_mul_f32 v[128:129], v[128:129], v[40:41]
    v_pk_mul_f32 v[130:131], v[130:131], v[42:43]
    v_pk_mul_f32 v[36:37], v[132:133], v[132:133]
    v_pk_mul_f32 v[38:39], v[134:135], v[134:135]
    v_pk_mul_f32 v[40:41], v[136:137], v[136:137]
    v_pk_mul_f32 v[42:43], v[138:139], v[138:139]
    v_pk_fma_f32 v[36:37], v[36:37], s[54:55], v[44:45]
    v_pk_fma_f32 v[38:39], v[38:39], s[54:55], v[44:45]
    v_pk_fma_f32 v[40:41], v[40:41], s[54:55], v[44:45]
    v_pk_fma_f32 v[42:43], v[42:43], s[54:55], v[44:45]
    v_pk_mul_f32 v[36:37], v[36:37], v[132:133]
    v_pk_mul_f32 v[38:39], v[38:39], v[134:135]
    v_pk_mul_f32 v[40:41], v[40:41], v[136:137]
    v_pk_mul_f32 v[42:43], v[42:43], v[138:139]
    v_exp_f32 v36, v36
    v_exp_f32 v37, v37
    v_exp_f32 v38, v38
    v_exp_f32 v39, v39
    v_exp_f32 v40, v40
    v_exp_f32 v41, v41
    v_exp_f32 v42, v42
    v_exp_f32 v43, v43
    v_pk_add_f32 v[36:37], v[36:37], 1.0 op_sel_hi:[1,0]
    v_pk_add_f32 v[38:39], v[38:39], 1.0 op_sel_hi:[1,0]
    v_pk_add_f32 v[40:41], v[40:41], 1.0 op_sel_hi:[1,0]
    v_pk_add_f32 v[42:43], v[42:43], 1.0 op_sel_hi:[1,0]
    v_rcp_f32 v36, v36
    v_rcp_f32 v37, v37
    v_rcp_f32 v38, v38
    v_rcp_f32 v39, v39
    v_rcp_f32 v40, v40
    v_rcp_f32 v41, v41
    v_rcp_f32 v42, v42
    v_rcp_f32 v43, v43
    v_pk_mul_f32 v[132:133], v[132:133], v[36:37]
    v_pk_mul_f32 v[134:135], v[134:135], v[38:39]
    v_pk_mul_f32 v[136:137], v[136:137], v[40:41]
    v_pk_mul_f32 v[138:139], v[138:139], v[42:43]
    v_pk_mul_f32 v[36:37], v[140:141], v[140:141]
    v_pk_mul_f32 v[38:39], v[142:143], v[142:143]
    v_pk_fma_f32 v[36:37], v[36:37], s[54:55], v[44:45]
    v_pk_fma_f32 v[38:39], v[38:39], s[54:55], v[44:45]
    v_pk_mul_f32 v[36:37], v[36:37], v[140:141]
    v_pk_mul_f32 v[38:39], v[38:39], v[142:143]
    v_exp_f32 v36, v36
    v_exp_f32 v37, v37
    v_exp_f32 v38, v38
    v_exp_f32 v39, v39
    v_pk_add_f32 v[36:37], v[36:37], 1.0 op_sel_hi:[1,0]
    v_pk_add_f32 v[38:39], v[38:39], 1.0 op_sel_hi:[1,0]
    v_rcp_f32 v36, v36
    v_rcp_f32 v37, v37
    v_rcp_f32 v38, v38
    v_rcp_f32 v39, v39
    v_pk_mul_f32 v[140:141], v[140:141], v[36:37]
    v_pk_mul_f32 v[142:143], v[142:143], v[38:39]
Lsk4:
    v_cvt_pk_bf16_f32 v212, v124, v125
    v_cvt_pk_bf16_f32 v213, v126, v127
    v_cvt_pk_bf16_f32 v214, v128, v129
    v_cvt_pk_bf16_f32 v215, v130, v131
    v_cvt_pk_bf16_f32 v216, v132, v133
    v_cvt_pk_bf16_f32 v217, v134, v135
    v_cvt_pk_bf16_f32 v218, v136, v137
    v_cvt_pk_bf16_f32 v219, v138, v139
    v_cvt_pk_bf16_f32 v220, v140, v141
    v_cvt_pk_bf16_f32 v221, v142, v143
    buffer_store_dwordx4 v[212:215], v31, s[8:11], s63 offen offset:0 sc1
    buffer_store_dwordx4 v[216:219], v31, s[8:11], s63 offen offset:1024 sc1
    v_sub_u32 v2, v31, v3
    buffer_store_dwordx2 v[220:221], v2, s[8:11], s64 offen offset:0 sc1
    s_branch Lj1pub
Lj1ev:
    s_lshl_b32 s3, s58, 8
    s_add_u32 s3, s3, 147456
    v_lshlrev_b32 v6, 4, v5
    v_add_u32 v6, s3, v6
    s_mul_i32 s3, s59, 320
    s_add_u32 s3, s3, 149504
    v_lshlrev_b32 v7, 2, v4
    v_add_u32 v7, s3, v7
    ds_read_b128 v[144:147], v6 offset:0
    ds_read_b128 v[148:151], v6 offset:512
    ds_read_b128 v[152:155], v6 offset:1024
    ds_read_b128 v[156:159], v6 offset:1536
    ds_read_b128 v[160:163], v6 offset:64
    ds_read_b128 v[164:167], v6 offset:576
    ds_read_b128 v[168:171], v6 offset:1088
    ds_read_b128 v[172:175], v6 offset:1600
    ds_read_b128 v[176:179], v6 offset:128
    ds_read_b128 v[180:183], v6 offset:640
    ds_read_b128 v[184:187], v6 offset:1152
    ds_read_b128 v[188:191], v6 offset:1664
    ds_read_b128 v[192:195], v6 offset:192
    ds_read_b128 v[196:199], v6 offset:704
    ds_read_b128 v[200:203], v6 offset:1216
    ds_read_b128 v[204:207], v6 offset:1728
    ds_read2_b32 v[8:9], v7 offset0:0 offset1:160
    ds_read2_b32 v[10:11], v7 offset0:16 offset1:176
    ds_read2_b32 v[12:13], v7 offset0:32 offset1:192
    ds_read2_b32 v[14:15], v7 offset0:48 offset1:208
    ds_read2_b32 v[16:17], v7 offset0:64 offset1:224
    s_lshr_b32 s3, s65, 4
    s_mul_i32 s3, s3, 20480
    v_lshlrev_b32 v28, 4, v1
    v_add_u32 v28, s3, v28
    v_add_u32 v29, 20480, v28
    v_add_u32 v30, 40960, v28
    v_add_u32 v31, 61440, v28
    s_waitcnt lgkmcnt(0)
    v_add_f32 v8, v8, v9
    v_add_f32 v10, v10, v11
    v_add_f32 v12, v12, v13
    v_add_f32 v14, v14, v15
    v_add_f32 v16, v16, v17
    v_add_f32 v144, v144, v148
    v_add_f32 v152, v152, v156
    v_mul_f32 v144, s66, v144
    v_mul_f32 v152, s66, v152
    v_fma_f32 v152, -v144, v144, v152
    v_max_f32 v152, 0, v152
    v_add_f32 v152, s67, v152
    v_rsq_f32 v152, v152
    v_add_f32 v145, v145, v149
    v_add_f32 v153, v153, v157
    v_mul_f32 v145, s66, v145
    v_mul_f32 v153, s66, v153
    v_fma_f32 v153, -v145, v145, v153
    v_max_f32 v153, 0, v153
    v_add_f32 v153, s67, v153
    v_rsq_f32 v153, v153
    v_add_f32 v146, v146, v150
    v_add_f32 v154, v154, v158
    v_mul_f32 v146, s66, v146
    v_mul_f32 v154, s66, v154
    v_fma_f32 v154, -v146, v146, v154
    v_max_f32 v154, 0, v154
    v_add_f32 v154, s67, v154
    v_rsq_f32 v154, v154
    v_add_f32 v147, v147, v151
    v_add_f32 v155, v155, v159
    v_mul_f32 v147, s66, v147
    v_mul_f32 v155, s66, v155
    v_fma_f32 v155, -v147, v147, v155
    v_max_f32 v155, 0, v155
    v_add_f32 v155, s67, v155
    v_rsq_f32 v155, v155
    v_add_f32 v160, v160, v164
    v_add_f32 v168, v168, v172
    v_mul_f32 v160, s66, v160
    v_mul_f32 v168, s66, v168
    v_fma_f32 v168, -v160, v160, v168
    v_max_f32 v168, 0, v168
    v_add_f32 v168, s67, v168
    v_rsq_f32 v168, v168
    v_add_f32 v161, v161, v165
    v_add_f32 v169, v169, v173
    v_mul_f32 v161, s66, v161
    v_mul_f32 v169, s66, v169
    v_fma_f32 v169, -v161, v161, v169
    v_max_f32 v169, 0, v169
    v_add_f32 v169, s67, v169
    v_rsq_f32 v169, v169
    v_add_f32 v162, v162, v166
    v_add_f32 v170, v170, v174
    v_mul_f32 v162, s66, v162
    v_mul_f32 v170, s66, v170
    v_fma_f32 v170, -v162, v162, v170
    v_max_f32 v170, 0, v170
    v_add_f32 v170, s67, v170
    v_rsq_f32 v170, v170
    v_add_f32 v163, v163, v167
    v_add_f32 v171, v171, v175
    v_mul_f32 v163, s66, v163
    v_mul_f32 v171, s66, v171
    v_fma_f32 v171, -v163, v163, v171
    v_max_f32 v171, 0, v171
    v_add_f32 v171, s67, v171
    v_rsq_f32 v171, v171
    v_add_f32 v176, v176, v180
    v_add_f32 v184, v184, v188
    v_mul_f32 v176, s66, v176
    v_mul_f32 v184, s66, v184
    v_fma_f32 v184, -v176, v176, v184
    v_max_f32 v184, 0, v184
    v_add_f32 v184, s67, v184
    v_rsq_f32 v184, v184
    v_add_f32 v177, v177, v181
    v_add_f32 v185, v185, v189
    v_mul_f32 v177, s66, v177
    v_mul_f32 v185, s66, v185
    v_fma_f32 v185, -v177, v177, v185
    v_max_f32 v185, 0, v185
    v_add_f32 v185, s67, v185
    v_rsq_f32 v185, v185
    v_add_f32 v178, v178, v182
    v_add_f32 v186, v186, v190
    v_mul_f32 v178, s66, v178
    v_mul_f32 v186, s66, v186
    v_fma_f32 v186, -v178, v178, v186
    v_max_f32 v186, 0, v186
    v_add_f32 v186, s67, v186
    v_rsq_f32 v186, v186
    v_add_f32 v179, v179, v183
    v_add_f32 v187, v187, v191
    v_mul_f32 v179, s66, v179
    v_mul_f32 v187, s66, v187
    v_fma_f32 v187, -v179, v179, v187
    v_max_f32 v187, 0, v187
    v_add_f32 v187, s67, v187
    v_rsq_f32 v187, v187
    v_add_f32 v192, v192, v196
    v_add_f32 v200, v200, v204
    v_mul_f32 v192, s66, v192
    v_mul_f32 v200, s66, v200
    v_fma_f32 v200, -v192, v192, v200
    v_max_f32 v200, 0, v200
    v_add_f32 v200, s67, v200
    v_rsq_f32 v200, v200
    v_add_f32 v193, v193, v197
    v_add_f32 v201, v201, v205
    v_mul_f32 v193, s66, v193
    v_mul_f32 v201, s66, v201
    v_fma_f32 v201, -v193, v193, v201
    v_max_f32 v201, 0, v201
    v_add_f32 v201, s67, v201
    v_rsq_f32 v201, v201
    v_add_f32 v194, v194, v198
    v_add_f32 v202, v202, v206
    v_mul_f32 v194, s66, v194
    v_mul_f32 v202, s66, v202
    v_fma_f32 v202, -v194, v194, v202
    v_max_f32 v202, 0, v202
    v_add_f32 v202, s67, v202
    v_rsq_f32 v202, v202
    v_add_f32 v195, v195, v199
    v_add_f32 v203, v203, v207
    v_mul_f32 v195, s66, v195
    v_mul_f32 v203, s66, v203
    v_fma_f32 v203, -v195, v195, v203
    v_max_f32 v203, 0, v203
    v_add_f32 v203, s67, v203
    v_rsq_f32 v203, v203
    s_nop 0
    v_pk_fma_f32 v[64:65], v[144:145], v[8:9], v[64:65] op_sel_hi:[1,0,1] neg_lo:[1,0,0] neg_hi:[1,0,0]
    v_pk_fma_f32 v[66:67], v[146:147], v[8:9], v[66:67] op_sel_hi:[1,0,1] neg_lo:[1,0,0] neg_hi:[1,0,0]
    v_pk_fma_f32 v[68:69], v[144:145], v[10:11], v[68:69] op_sel_hi:[1,0,1] neg_lo:[1,0,0] neg_hi:[1,0,0]
    v_pk_fma_f32 v[70:71], v[146:147], v[10:11], v[70:71] op_sel_hi:[1,0,1] neg_lo:[1,0,0] neg_hi:[1,0,0]
    v_pk_fma_f32 v[72:73], v[144:145], v[12:13], v[72:73] op_sel_hi:[1,0,1] neg_lo:[1,0,0] neg_hi:[1,0,0]
    v_pk_fma_f32 v[74:75], v[146:147], v[12:13], v[74:75] op_sel_hi:[1,0,1] neg_lo:[1,0,0] neg_hi:[1,0,0]
    v_pk_fma_f32 v[76:77], v[144:145], v[14:15], v[76:77] op_sel_hi:[1,0,1] neg_lo:[1,0,0] neg_hi:[1,0,0]
    v_pk_fma_f32 v[78:79], v[146:147], v[14:15], v[78:79] op_sel_hi:[1,0,1] neg_lo:[1,0,0] neg_hi:[1,0,0]
    v_pk_fma_f32 v[80:81], v[144:145], v[16:17], v[80:81] op_sel_hi:[1,0,1] neg_lo:[1,0,0] neg_hi:[1,0,0]
    v_pk_fma_f32 v[82:83], v[146:147], v[16:17], v[82:83] op_sel_hi:[1,0,1] neg_lo:[1,0,0] neg_hi:[1,0,0]
    v_pk_mul_f32 v[64:65], v[64:65], v[152:153]
    v_pk_mul_f32 v[66:67], v[66:67], v[154:155]
    v_pk_mul_f32 v[68:69], v[68:69], v[152:153]
    v_pk_mul_f32 v[70:71], v[70:71], v[154:155]
    v_pk_mul_f32 v[72:73], v[72:73], v[152:153]
    v_pk_mul_f32 v[74:75], v[74:75], v[154:155]
    v_pk_mul_f32 v[76:77], v[76:77], v[152:153]
    v_pk_mul_f32 v[78:79], v[78:79], v[154:155]
    v_pk_mul_f32 v[80:81], v[80:81], v[152:153]
    v_pk_mul_f32 v[82:83], v[82:83], v[154:155]
    v_cvt_pk_bf16_f32 v212, v64, v65
    v_cvt_pk_bf16_f32 v213, v66, v67
    v_cvt_pk_bf16_f32 v214, v68, v69
    v_cvt_pk_bf16_f32 v215, v70, v71
    v_cvt_pk_bf16_f32 v216, v72, v73
    v_cvt_pk_bf16_f32 v217, v74, v75
    v_cvt_pk_bf16_f32 v218, v76, v77
    v_cvt_pk_bf16_f32 v219, v78, v79
    v_cvt_pk_bf16_f32 v220, v80, v81
    v_cvt_pk_bf16_f32 v221, v82, v83
    buffer_store_dwordx4 v[212:215], v28, s[8:11], s63 offen offset:0 sc1
    buffer_store_dwordx4 v[216:219], v28, s[8:11], s63 offen offset:1024 sc1
    v_sub_u32 v2, v28, v3
    buffer_store_dwordx2 v[220:221], v2, s[8:11], s64 offen offset:0 sc1
    v_pk_fma_f32 v[84:85], v[160:161], v[8:9], v[84:85] op_sel_hi:[1,0,1] neg_lo:[1,0,0] neg_hi:[1,0,0]
    v_pk_fma_f32 v[86:87], v[162:163], v[8:9], v[86:87] op_sel_hi:[1,0,1] neg_lo:[1,0,0] neg_hi:[1,0,0]
    v_pk_fma_f32 v[88:89], v[160:161], v[10:11], v[88:89] op_sel_hi:[1,0,1] neg_lo:[1,0,0] neg_hi:[1,0,0]
    v_pk_fma_f32 v[90:91], v[162:163], v[10:11], v[90:91] op_sel_hi:[1,0,1] neg_lo:[1,0,0] neg_hi:[1,0,0]
    v_pk_fma_f32 v[92:93], v[160:161], v[12:13], v[92:93] op_sel_hi:[1,0,1] neg_lo:[1,0,0] neg_hi:[1,0,0]
    v_pk_fma_f32 v[94:95], v[162:163], v[12:13], v[94:95] op_sel_hi:[1,0,1] neg_lo:[1,0,0] neg_hi:[1,0,0]
    v_pk_fma_f32 v[96:97], v[160:161], v[14:15], v[96:97] op_sel_hi:[1,0,1] neg_lo:[1,0,0] neg_hi:[1,0,0]
    v_pk_fma_f32 v[98:99], v[162:163], v[14:15], v[98:99] op_sel_hi:[1,0,1] neg_lo:[1,0,0] neg_hi:[1,0,0]
    v_pk_fma_f32 v[100:101], v[160:161], v[16:17], v[100:101] op_sel_hi:[1,0,1] neg_lo:[1,0,0] neg_hi:[1,0,0]
    v_pk_fma_f32 v[102:103], v[162:163], v[16:17], v[102:103] op_sel_hi:[1,0,1] neg_lo:[1,0,0] neg_hi:[1,0,0]
    v_pk_mul_f32 v[84:85], v[84:85], v[168:169]
    v_pk_mul_f32 v[86:87], v[86:87], v[170:171]
    v_pk_mul_f32 v[88:89], v[88:89], v[168:169]
    v_pk_mul_f32 v[90:91], v[90:91], v[170:171]
    v_pk_mul_f32 v[92:93], v[92:93], v[168:169]
    v_pk_mul_f32 v[94:95], v[94:95], v[170:171]
    v_pk_mul_f32 v[96:97], v[96:97], v[168:169]
    v_pk_mul_f32 v[98:99], v[98:99], v[170:171]
    v_pk_mul_f32 v[100:101], v[100:101], v[168:169]
    v_pk_mul_f32 v[102:103], v[102:103], v[170:171]
    v_cvt_pk_bf16_f32 v224, v84, v85
    v_cvt_pk_bf16_f32 v225, v86, v87
    v_cvt_pk_bf16_f32 v226, v88, v89
    v_cvt_pk_bf16_f32 v227, v90, v91
    v_cvt_pk_bf16_f32 v228, v92, v93
    v_cvt_pk_bf16_f32 v229, v94, v95
    v_cvt_pk_bf16_f32 v230, v96, v97
    v_cvt_pk_bf16_f32 v231, v98, v99
    v_cvt_pk_bf16_f32 v232, v100, v101
    v_cvt_pk_bf16_f32 v233, v102, v103
    buffer_store_dwordx4 v[224:227], v29, s[8:11], s63 offen offset:0 sc1
    buffer_store_dwordx4 v[228:231], v29, s[8:11], s63 offen offset:1024 sc1
    v_sub_u32 v2, v29, v3
    buffer_store_dwordx2 v[232:233], v2, s[8:11], s64 offen offset:0 sc1
    v_pk_fma_f32 v[104:105], v[176:177], v[8:9], v[104:105] op_sel_hi:[1,0,1] neg_lo:[1,0,0] neg_hi:[1,0,0]
    v_pk_fma_f32 v[106:107], v[178:179], v[8:9], v[106:107] op_sel_hi:[1,0,1] neg_lo:[1,0,0] neg_hi:[1,0,0]
    v_pk_fma_f32 v[108:109], v[176:177], v[10:11], v[108:109] op_sel_hi:[1,0,1] neg_lo:[1,0,0] neg_hi:[1,0,0]
    v_pk_fma_f32 v[110:111], v[178:179], v[10:11], v[110:111] op_sel_hi:[1,0,1] neg_lo:[1,0,0] neg_hi:[1,0,0]
    v_pk_fma_f32 v[112:113], v[176:177], v[12:13], v[112:113] op_sel_hi:[1,0,1] neg_lo:[1,0,0] neg_hi:[1,0,0]
    v_pk_fma_f32 v[114:115], v[178:179], v[12:13], v[114:115] op_sel_hi:[1,0,1] neg_lo:[1,0,0] neg_hi:[1,0,0]
    v_pk_fma_f32 v[116:117], v[176:177], v[14:15], v[116:117] op_sel_hi:[1,0,1] neg_lo:[1,0,0] neg_hi:[1,0,0]
    v_pk_fma_f32 v[118:119], v[178:179], v[14:15], v[118:119] op_sel_hi:[1,0,1] neg_lo:[1,0,0] neg_hi:[1,0,0]
    v_pk_fma_f32 v[120:121], v[176:177], v[16:17], v[120:121] op_sel_hi:[1,0,1] neg_lo:[1,0,0] neg_hi:[1,0,0]
    v_pk_fma_f32 v[122:123], v[178:179], v[16:17], v[122:123] op_sel_hi:[1,0,1] neg_lo:[1,0,0] neg_hi:[1,0,0]
    v_pk_mul_f32 v[104:105], v[104:105], v[184:185]
    v_pk_mul_f32 v[106:107], v[106:107], v[186:187]
    v_pk_mul_f32 v[108:109], v[108:109], v[184:185]
    v_pk_mul_f32 v[110:111], v[110:111], v[186:187]
    v_pk_mul_f32 v[112:113], v[112:113], v[184:185]
    v_pk_mul_f32 v[114:115], v[114:115], v[186:187]
    v_pk_mul_f32 v[116:117], v[116:117], v[184:185]
    v_pk_mul_f32 v[118:119], v[118:119], v[186:187]
    v_pk_mul_f32 v[120:121], v[120:121], v[184:185]
    v_pk_mul_f32 v[122:123], v[122:123], v[186:187]
    v_cvt_pk_bf16_f32 v212, v104, v105
    v_cvt_pk_bf16_f32 v213, v106, v107
    v_cvt_pk_bf16_f32 v214, v108, v109
    v_cvt_pk_bf16_f32 v215, v110, v111
    v_cvt_pk_bf16_f32 v216, v112, v113
    v_cvt_pk_bf16_f32 v217, v114, v115
    v_cvt_pk_bf16_f32 v218, v116, v117
    v_cvt_pk_bf16_f32 v219, v118, v119
    v_cvt_pk_bf16_f32 v220, v120, v121
    v_cvt_pk_bf16_f32 v221, v122, v123
    buffer_store_dwordx4 v[212:215], v30 , s[8:11], s63 offen offset:0 sc1
    buffer_store_dwordx4 v[216:219], v30 , s[8:11], s63 offen offset:1024 sc1
    v_sub_u32 v2, v30 , v3
    buffer_store_dwordx2 v[220:221], v2, s[8:11], s64 offen offset:0 sc1
    v_pk_fma_f32 v[124:125], v[192:193], v[8:9], v[124:125] op_sel_hi:[1,0,1] neg_lo:[1,0,0] neg_hi:[1,0,0]
    v_pk_fma_f32 v[126:127], v[194:195], v[8:9], v[126:127] op_sel_hi:[1,0,1] neg_lo:[1,0,0] neg_hi:[1,0,0]
    v_pk_fma_f32 v[128:129], v[192:193], v[10:11], v[128:129] op_sel_hi:[1,0,1] neg_lo:[1,0,0] neg_hi:[1,0,0]
    v_pk_fma_f32 v[130:131], v[194:195], v[10:11], v[130:131] op_sel_hi:[1,0,1] neg_lo:[1,0,0] neg_hi:[1,0,0]
    v_pk_fma_f32 v[132:133], v[192:193], v[12:13], v[132:133] op_sel_hi:[1,0,1] neg_lo:[1,0,0] neg_hi:[1,0,0]
    v_pk_fma_f32 v[134:135], v[194:195], v[12:13], v[134:135] op_sel_hi:[1,0,1] neg_lo:[1,0,0] neg_hi:[1,0,0]
    v_pk_fma_f32 v[136:137], v[192:193], v[14:15], v[136:137] op_sel_hi:[1,0,1] neg_lo:[1,0,0] neg_hi:[1,0,0]
    v_pk_fma_f32 v[138:139], v[194:195], v[14:15], v[138:139] op_sel_hi:[1,0,1] neg_lo:[1,0,0] neg_hi:[1,0,0]
    v_pk_fma_f32 v[140:141], v[192:193], v[16:17], v[140:141] op_sel_hi:[1,0,1] neg_lo:[1,0,0] neg_hi:[1,0,0]
    v_pk_fma_f32 v[142:143], v[194:195], v[16:17], v[142:143] op_sel_hi:[1,0,1] neg_lo:[1,0,0] neg_hi:[1,0,0]
    v_pk_mul_f32 v[124:125], v[124:125], v[200:201]
    v_pk_mul_f32 v[126:127], v[126:127], v[202:203]
    v_pk_mul_f32 v[128:129], v[128:129], v[200:201]
    v_pk_mul_f32 v[130:131], v[130:131], v[202:203]
    v_pk_mul_f32 v[132:133], v[132:133], v[200:201]
    v_pk_mul_f32 v[134:135], v[134:135], v[202:203]
    v_pk_mul_f32 v[136:137], v[136:137], v[200:201]
    v_pk_mul_f32 v[138:139], v[138:139], v[202:203]
    v_pk_mul_f32 v[140:141], v[140:141], v[200:201]
    v_pk_mul_f32 v[142:143], v[142:143], v[202:203]
    v_cvt_pk_bf16_f32 v224, v124, v125
    v_cvt_pk_bf16_f32 v225, v126, v127
    v_cvt_pk_bf16_f32 v226, v128, v129
    v_cvt_pk_bf16_f32 v227, v130, v131
    v_cvt_pk_bf16_f32 v228, v132, v133
    v_cvt_pk_bf16_f32 v229, v134, v135
    v_cvt_pk_bf16_f32 v230, v136, v137
    v_cvt_pk_bf16_f32 v231, v138, v139
    v_cvt_pk_bf16_f32 v232, v140, v141
    v_cvt_pk_bf16_f32 v233, v142, v143
    buffer_store_dwordx4 v[224:227], v31, s[8:11], s63 offen offset:0 sc1
    buffer_store_dwordx4 v[228:231], v31, s[8:11], s63 offen offset:1024 sc1
    v_sub_u32 v2, v31, v3
    buffer_store_dwordx2 v[232:233], v2, s[8:11], s64 offen offset:0 sc1
Lj1pub:
    s_lshl_b32 s70, s23, 7
    s_lshl_b32 s3, s24, 2
    s_add_u32 s70, s70, s3
    s_add_u32 s70, s70, 0x1c42000
    s_waitcnt vmcnt(0)
    s_mov_b64 exec, 1
    v_mov_b32 v7, 1
    v_mov_b32 v33, 150784
    ds_add_rtn_u32 v33, v33, v7
    s_waitcnt lgkmcnt(0)
    v_cmp_eq_u32 vcc, 3, v33
    s_cbranch_vccz Lws5
    s_mov_b64 exec, 15
    v_mov_b32 v7, 1
    v_lshlrev_b32 v33, 11, v1
    buffer_store_dword v7, v33, s[8:11], s70 offen sc1
Lws5:
    s_mov_b64 exec, -1
    v_and_b32 v4, 15, v1
    v_lshrrev_b32 v5, 4, v1
    s_lshl_b32 s65, s27, 6
    s_lshl_b32 s3, s22, 4
    s_add_u32 s65, s65, s3
    s_lshr_b32 s58, s28, 1
    s_and_b32 s59, s28, 1
    v_mul_u32_u24 v28, 1280, v4
    v_lshl_add_u32 v29, v5, 3, v28
    v_lshl_add_u32 v28, v5, 4, v28
    s_mul_i32 s60, s65, 1280
    s_mul_i32 s3, s58, 320
    s_add_u32 s60, s60, s3
    s_lshl_b32 s3, s59, 5
    s_add_u32 s61, s60, s3
    s_add_u32 s61, s61, 256
    s_lshl_b32 s3, s59, 7
    s_add_u32 s60, s60, s3
    s_lshr_b32 s64, s65, 4
    s_mul_i32 s64, s64, 20480
    s_mul_i32 s3, s58, 5120
    s_add_u32 s62, s64, s3
    s_lshl_b32 s3, s59, 9
    s_add_u32 s63, s62, s3
    s_add_u32 s63, s63, 4096
    s_lshl_b32 s3, s59, 11
    s_add_u32 s62, s62, s3
    v_lshlrev_b32 v30, 4, v1
    v_add_u32 v31, 0x10000, v30
    v_add_u32 v32, 0x20000, v30
    v_sub_u32 v2, v30, v3
    buffer_load_dwordx4 v[236:239], v28, s[4:7], s60 offen
    buffer_load_dwordx4 v[240:243], v28, s[4:7], s60 offen offset:64
    buffer_load_dwordx2 v[244:245], v29, s[4:7], s61 offen
    s_add_u32 s66, s64, 0x780000
    s_lshl_b32 s67, s65, 3
    s_add_u32 s67, s67, 0x1c00000
    v_lshlrev_b32 v6, 3, v4
    s_cmp_eq_u32 s65, 0
    s_cselect_b32 s3, 0, 20480
    s_sub_u32 s68, s62, s3
    s_sub_u32 s69, s63, s3
    s_mov_b32 s3, 0
    s_lshl_b32 s56, s3, 12
    s_mul_i32 s57, s3, 20480
    s_barrier
    s_add_u32 s20, s66, s56
    buffer_load_dwordx4 v[84:87], v30, s[8:11], s20 offen offset:0 sc1
    buffer_load_dwordx4 v[88:91], v30, s[8:11], s20 offen offset:1024 sc1
    buffer_load_dwordx4 v[92:95], v30, s[8:11], s20 offen offset:2048 sc1
    buffer_load_dwordx4 v[96:99], v30, s[8:11], s20 offen offset:3072 sc1
    s_add_u32 s56, s56, 4096
    s_cmp_ge_u32 s56, 20480
    s_cselect_b32 s56, 0, s56
    s_add_u32 s20, s66, s56
    buffer_load_dwordx4 v[100:103], v30, s[8:11], s20 offen offset:0 sc1
    buffer_load_dwordx4 v[104:107], v30, s[8:11], s20 offen offset:1024 sc1
    v_add_u32 v33, s57, v30
    ds_read_b128 v[164:167], v33 offset:0
    ds_read_b128 v[168:171], v33 offset:1024
    ds_read_b128 v[172:175], v33 offset:2048
    ds_read_b128 v[176:179], v33 offset:3072
    ds_read_b128 v[180:183], v33 offset:4096
    ds_read_b128 v[184:187], v33 offset:5120
    ds_read_b128 v[188:191], v33 offset:6144
    ds_read_b128 v[192:195], v33 offset:7168
    ds_read_b128 v[196:199], v33 offset:8192
    ds_read_b128 v[200:203], v33 offset:9216
    s_waitcnt vmcnt(5)
    s_waitcnt lgkmcnt(5)
    v_mfma_f32_16x16x32_bf16 v[64:67], v[164:167], v[84:87], 0
    ds_read_b128 v[204:207], v33 offset:10240
    v_mfma_f32_16x16x32_bf16 v[68:71], v[168:171], v[84:87], 0
    buffer_load_dwordx4 v[108:111], v30, s[8:11], s20 offen offset:2048 sc1
    ds_read_b128 v[208:211], v33 offset:11264
    ds_read_b128 v[212:215], v33 offset:12288
    v_mfma_f32_16x16x32_bf16 v[72:75], v[172:175], v[84:87], 0
    ds_read_b128 v[216:219], v33 offset:13312
    ds_read_b128 v[220:223], v33 offset:14336
    buffer_load_dwordx4 v[112:115], v30, s[8:11], s20 offen offset:3072 sc1
    v_mfma_f32_16x16x32_bf16 v[76:79], v[176:179], v[84:87], 0
    v_mfma_f32_16x16x32_bf16 v[80:83], v[180:183], v[84:87], 0
    s_waitcnt vmcnt(6)
    s_waitcnt lgkmcnt(5)
    v_mfma_f32_16x16x32_bf16 v[64:67], v[184:187], v[88:91], v[64:67]
    ds_read_b128 v[164:167], v33 offset:15360
    v_mfma_f32_16x16x32_bf16 v[68:71], v[188:191], v[88:91], v[68:71]
    s_add_u32 s56, s56, 4096
    s_cmp_ge_u32 s56, 20480
    s_cselect_b32 s56, 0, s56
    s_add_u32 s20, s66, s56
    buffer_load_dwordx4 v[116:119], v30, s[8:11], s20 offen offset:0 sc1
    ds_read_b128 v[168:171], v33 offset:16384
    ds_read_b128 v[172:175], v33 offset:17408
    v_mfma_f32_16x16x32_bf16 v[72:75], v[192:195], v[88:91], v[72:75]
    ds_read_b128 v[176:179], v33 offset:18432
    ds_read_b128 v[180:183], v33 offset:19456
    buffer_load_dwordx4 v[120:123], v30, s[8:11], s20 offen offset:1024 sc1
    v_mfma_f32_16x16x32_bf16 v[76:79], v[196:199], v[88:91], v[76:79]
    v_mfma_f32_16x16x32_bf16 v[80:83], v[200:203], v[88:91], v[80:83]
    s_waitcnt vmcnt(7)
    s_waitcnt lgkmcnt(5)
    v_mfma_f32_16x16x32_bf16 v[64:67], v[204:207], v[92:95], v[64:67]
    s_add_u32 s57, s57, 20480
    s_cmp_ge_u32 s57, 102400
    s_cselect_b32 s57, 0, s57
    v_add_u32 v33, s57, v30
    ds_read_b128 v[184:187], v33 offset:0
    v_mfma_f32_16x16x32_bf16 v[68:71], v[208:211], v[92:95], v[68:71]
    buffer_load_dwordx4 v[124:127], v30, s[8:11], s20 offen offset:2048 sc1
    ds_read_b128 v[188:191], v33 offset:1024
    ds_read_b128 v[192:195], v33 offset:2048
    v_mfma_f32_16x16x32_bf16 v[72:75], v[212:215], v[92:95], v[72:75]
    ds_read_b128 v[196:199], v33 offset:3072
    ds_read_b128 v[200:203], v33 offset:4096
    buffer_load_dwordx4 v[128:131], v30, s[8:11], s20 offen offset:3072 sc1
    v_mfma_f32_16x16x32_bf16 v[76:79], v[216:219], v[92:95], v[76:79]
    v_mfma_f32_16x16x32_bf16 v[80:83], v[220:223], v[92:95], v[80:83]
    s_waitcnt vmcnt(8)
    s_waitcnt lgkmcnt(5)
    v_mfma_f32_16x16x32_bf16 v[64:67], v[164:167], v[96:99], v[64:67]
    ds_read_b128 v[204:207], v33 offset:5120
    v_mfma_f32_16x16x32_bf16 v[68:71], v[168:171], v[96:99], v[68:71]
    s_add_u32 s56, s56, 4096
    s_cmp_ge_u32 s56, 20480
    s_cselect_b32 s56, 0, s56
    s_add_u32 s20, s66, s56
    buffer_load_dwordx4 v[132:135], v30, s[8:11], s20 offen offset:0 sc1
    ds_read_b128 v[208:211], v33 offset:6144
    ds_read_b128 v[212:215], v33 offset:7168
    v_mfma_f32_16x16x32_bf16 v[72:75], v[172:175], v[96:99], v[72:75]
    ds_read_b128 v[216:219], v33 offset:8192
    ds_read_b128 v[220:223], v33 offset:9216
    buffer_load_dwordx4 v[136:139], v30, s[8:11], s20 offen offset:1024 sc1
    v_mfma_f32_16x16x32_bf16 v[76:79], v[176:179], v[96:99], v[76:79]
    v_mfma_f32_16x16x32_bf16 v[80:83], v[180:183], v[96:99], v[80:83]
    s_waitcnt vmcnt(9)
    s_waitcnt lgkmcnt(5)
    v_mfma_f32_16x16x32_bf16 v[64:67], v[184:187], v[100:103], v[64:67]
    ds_read_b128 v[164:167], v33 offset:10240
    v_mfma_f32_16x16x32_bf16 v[68:71], v[188:191], v[100:103], v[68:71]
    buffer_load_dwordx4 v[140:143], v30, s[8:11], s20 offen offset:2048 sc1
    ds_read_b128 v[168:171], v33 offset:11264
    ds_read_b128 v[172:175], v33 offset:12288
    v_mfma_f32_16x16x32_bf16 v[72:75], v[192:195], v[100:103], v[72:75]
    ds_read_b128 v[176:179], v33 offset:13312
    ds_read_b128 v[180:183], v33 offset:14336
    buffer_load_dwordx4 v[144:147], v30, s[8:11], s20 offen offset:3072 sc1
    v_mfma_f32_16x16x32_bf16 v[76:79], v[196:199], v[100:103], v[76:79]
    v_mfma_f32_16x16x32_bf16 v[80:83], v[200:203], v[100:103], v[80:83]
    buffer_load_dwordx2 v[18:19], v6, s[8:11], s67 offen sc1
    s_waitcnt vmcnt(11)
    s_waitcnt lgkmcnt(5)
    v_mfma_f32_16x16x32_bf16 v[64:67], v[204:207], v[104:107], v[64:67]
    ds_read_b128 v[184:187], v33 offset:15360
    v_mfma_f32_16x16x32_bf16 v[68:71], v[208:211], v[104:107], v[68:71]
    s_add_u32 s56, s56, 4096
    s_cmp_ge_u32 s56, 20480
    s_cselect_b32 s56, 0, s56
    s_add_u32 s20, s66, s56
    buffer_load_dwordx4 v[148:151], v30, s[8:11], s20 offen offset:0 sc1
    ds_read_b128 v[188:191], v33 offset:16384
    ds_read_b128 v[192:195], v33 offset:17408
    v_mfma_f32_16x16x32_bf16 v[72:75], v[212:215], v[104:107], v[72:75]
    ds_read_b128 v[196:199], v33 offset:18432
    ds_read_b128 v[200:203], v33 offset:19456
    buffer_load_dwordx4 v[152:155], v30, s[8:11], s20 offen offset:1024 sc1
    v_mfma_f32_16x16x32_bf16 v[76:79], v[216:219], v[104:107], v[76:79]
    v_mfma_f32_16x16x32_bf16 v[80:83], v[220:223], v[104:107], v[80:83]
    s_waitcnt vmcnt(12)
    s_waitcnt lgkmcnt(5)
    v_mfma_f32_16x16x32_bf16 v[64:67], v[164:167], v[108:111], v[64:67]
    s_barrier
    s_add_u32 s57, s57, 20480
    s_cmp_ge_u32 s57, 102400
    s_cselect_b32 s57, 0, s57
    v_add_u32 v33, s57, v30
    ds_read_b128 v[204:207], v33 offset:0
    buffer_load_dwordx4 v[156:159], v30, s[8:11], s20 offen offset:2048 sc1
    v_mfma_f32_16x16x32_bf16 v[68:71], v[168:171], v[108:111], v[68:71]
    ds_read_b128 v[208:211], v33 offset:1024
    ds_read_b128 v[212:215], v33 offset:2048
    v_mfma_f32_16x16x32_bf16 v[72:75], v[172:175], v[108:111], v[72:75]
    ds_read_b128 v[216:219], v33 offset:3072
    ds_read_b128 v[220:223], v33 offset:4096
    buffer_load_dwordx4 v[160:163], v30, s[8:11], s20 offen offset:3072 sc1
    v_mfma_f32_16x16x32_bf16 v[76:79], v[176:179], v[108:111], v[76:79]
    v_mfma_f32_16x16x32_bf16 v[80:83], v[180:183], v[108:111], v[80:83]
    s_add_u32 s70, s62, 0x0
    s_add_u32 s71, s63, 0x0
    buffer_load_dwordx4 v[34:37], v30, s[8:11], s70 offen sc1
    buffer_load_dwordx4 v[38:41], v30, s[8:11], s70 offen offset:1024 sc1
    s_waitcnt vmcnt(15)
    s_waitcnt lgkmcnt(5)
    v_mfma_f32_16x16x32_bf16 v[64:67], v[184:187], v[112:115], v[64:67]
    ds_read_b128 v[164:167], v33 offset:5120
    v_mfma_f32_16x16x32_bf16 v[68:71], v[188:191], v[112:115], v[68:71]
    ds_read_b128 v[168:171], v33 offset:6144
    ds_read_b128 v[172:175], v33 offset:7168
    v_mfma_f32_16x16x32_bf16 v[72:75], v[192:195], v[112:115], v[72:75]
    ds_read_b128 v[176:179], v33 offset:8192
    ds_read_b128 v[180:183], v33 offset:9216
    v_mfma_f32_16x16x32_bf16 v[76:79], v[196:199], v[112:115], v[76:79]
    v_mfma_f32_16x16x32_bf16 v[80:83], v[200:203], v[112:115], v[80:83]
    buffer_load_dwordx2 v[42:43], v2, s[8:11], s71 offen sc1
    s_add_u32 s70, s62, 0x280000
    s_add_u32 s71, s63, 0x280000
    buffer_load_dwordx4 v[44:47], v30, s[8:11], s70 offen sc1
    s_waitcnt vmcnt(16)
    s_waitcnt lgkmcnt(5)
    v_mfma_f32_16x16x32_bf16 v[64:67], v[204:207], v[116:119], v[64:67]
    ds_read_b128 v[184:187], v33 offset:10240
    v_mfma_f32_16x16x32_bf16 v[68:71], v[208:211], v[116:119], v[68:71]
    ds_read_b128 v[188:191], v33 offset:11264
    ds_read_b128 v[192:195], v33 offset:12288
    v_mfma_f32_16x16x32_bf16 v[72:75], v[212:215], v[116:119], v[72:75]
    ds_read_b128 v[196:199], v33 offset:13312
    ds_read_b128 v[200:203], v33 offset:14336
    v_mfma_f32_16x16x32_bf16 v[76:79], v[216:219], v[116:119], v[76:79]
    v_mfma_f32_16x16x32_bf16 v[80:83], v[220:223], v[116:119], v[80:83]
    buffer_load_dwordx4 v[48:51], v30, s[8:11], s70 offen offset:1024 sc1
    buffer_load_dwordx2 v[52:53], v2, s[8:11], s71 offen sc1
    s_waitcnt vmcnt(17)
    s_waitcnt lgkmcnt(5)
    v_mfma_f32_16x16x32_bf16 v[64:67], v[164:167], v[120:123], v[64:67]
    ds_read_b128 v[204:207], v33 offset:15360
    v_mfma_f32_16x16x32_bf16 v[68:71], v[168:171], v[120:123], v[68:71]
    ds_read_b128 v[208:211], v33 offset:16384
    ds_read_b128 v[212:215], v33 offset:17408
    v_mfma_f32_16x16x32_bf16 v[72:75], v[172:175], v[120:123], v[72:75]
    ds_read_b128 v[216:219], v33 offset:18432
    ds_read_b128 v[220:223], v33 offset:19456
    v_mfma_f32_16x16x32_bf16 v[76:79], v[176:179], v[120:123], v[76:79]
    v_mfma_f32_16x16x32_bf16 v[80:83], v[180:183], v[120:123], v[80:83]
    s_add_u32 s70, s68, 0x280000
    s_add_u32 s71, s69, 0x280000
    buffer_load_dwordx4 v[54:57], v30, s[8:11], s70 offen sc1
    buffer_load_dwordx4 v[58:61], v30, s[8:11], s70 offen offset:1024 sc1
    s_waitcnt vmcnt(18)
    s_waitcnt lgkmcnt(5)
    v_mfma_f32_16x16x32_bf16 v[64:67], v[184:187], v[124:127], v[64:67]
    s_add_u32 s57, s57, 20480
    s_cmp_ge_u32 s57, 102400
    s_cselect_b32 s57, 0, s57
    v_add_u32 v33, s57, v30
    ds_read_b128 v[164:167], v33 offset:0
    v_mfma_f32_16x16x32_bf16 v[68:71], v[188:191], v[124:127], v[68:71]
    ds_read_b128 v[168:171], v33 offset:1024
    ds_read_b128 v[172:175], v33 offset:2048
    v_mfma_f32_16x16x32_bf16 v[72:75], v[192:195], v[124:127], v[72:75]
    ds_read_b128 v[176:179], v33 offset:3072
    ds_read_b128 v[180:183], v33 offset:4096
    v_mfma_f32_16x16x32_bf16 v[76:79], v[196:199], v[124:127], v[76:79]
    v_mfma_f32_16x16x32_bf16 v[80:83], v[200:203], v[124:127], v[80:83]
    buffer_load_dwordx2 v[62:63], v2, s[8:11], s71 offen sc1
    s_add_u32 s70, s62, 0x500000
    s_add_u32 s71, s63, 0x500000
    buffer_load_dwordx4 v[224:227], v30, s[8:11], s70 offen sc1
    s_waitcnt vmcnt(19)
    s_waitcnt lgkmcnt(5)
    v_mfma_f32_16x16x32_bf16 v[64:67], v[204:207], v[128:131], v[64:67]
    ds_read_b128 v[184:187], v33 offset:5120
    v_mfma_f32_16x16x32_bf16 v[68:71], v[208:211], v[128:131], v[68:71]
    ds_read_b128 v[188:191], v33 offset:6144
    ds_read_b128 v[192:195], v33 offset:7168
    v_mfma_f32_16x16x32_bf16 v[72:75], v[212:215], v[128:131], v[72:75]
    ds_read_b128 v[196:199], v33 offset:8192
    ds_read_b128 v[200:203], v33 offset:9216
    v_mfma_f32_16x16x32_bf16 v[76:79], v[216:219], v[128:131], v[76:79]
    v_mfma_f32_16x16x32_bf16 v[80:83], v[220:223], v[128:131], v[80:83]
    buffer_load_dwordx4 v[228:231], v30, s[8:11], s70 offen offset:1024 sc1
    buffer_load_dwordx2 v[232:233], v2, s[8:11], s71 offen sc1
    s_waitcnt vmcnt(20)
    s_waitcnt lgkmcnt(5)
    v_mfma_f32_16x16x32_bf16 v[64:67], v[164:167], v[132:135], v[64:67]
    ds_read_b128 v[204:207], v33 offset:10240
    v_mfma_f32_16x16x32_bf16 v[68:71], v[168:171], v[132:135], v[68:71]
    ds_read_b128 v[208:211], v33 offset:11264
    ds_read_b128 v[212:215], v33 offset:12288
    v_mfma_f32_16x16x32_bf16 v[72:75], v[172:175], v[132:135], v[72:75]
    ds_read_b128 v[216:219], v33 offset:13312
    ds_read_b128 v[220:223], v33 offset:14336
    v_mfma_f32_16x16x32_bf16 v[76:79], v[176:179], v[132:135], v[76:79]
    v_mfma_f32_16x16x32_bf16 v[80:83], v[180:183], v[132:135], v[80:83]
    s_add_u32 s70, s68, 0x500000
    s_add_u32 s71, s69, 0x500000
    buffer_load_dwordx4 v[8:11], v30, s[8:11], s70 offen sc1
    buffer_load_dwordx4 v[12:15], v30, s[8:11], s70 offen offset:1024 sc1
    s_waitcnt vmcnt(21)
    s_waitcnt lgkmcnt(5)
    v_mfma_f32_16x16x32_bf16 v[64:67], v[184:187], v[136:139], v[64:67]
    ds_read_b128 v[164:167], v33 offset:15360
    v_mfma_f32_16x16x32_bf16 v[68:71], v[188:191], v[136:139], v[68:71]
    ds_read_b128 v[168:171], v33 offset:16384
    ds_read_b128 v[172:175], v33 offset:17408
    v_mfma_f32_16x16x32_bf16 v[72:75], v[192:195], v[136:139], v[72:75]
    ds_read_b128 v[176:179], v33 offset:18432
    ds_read_b128 v[180:183], v33 offset:19456
    v_mfma_f32_16x16x32_bf16 v[76:79], v[196:199], v[136:139], v[76:79]
    v_mfma_f32_16x16x32_bf16 v[80:83], v[200:203], v[136:139], v[80:83]
    buffer_load_dwordx2 v[16:17], v2, s[8:11], s71 offen sc1
    s_waitcnt vmcnt(21)
    s_waitcnt lgkmcnt(5)
    v_mfma_f32_16x16x32_bf16 v[64:67], v[204:207], v[140:143], v[64:67]
    s_add_u32 s57, s57, 20480
    s_cmp_ge_u32 s57, 102400
    s_cselect_b32 s57, 0, s57
    v_add_u32 v33, s57, v30
    ds_read_b128 v[184:187], v33 offset:0
    v_mfma_f32_16x16x32_bf16 v[68:71], v[208:211], v[140:143], v[68:71]
    ds_read_b128 v[188:191], v33 offset:1024
    ds_read_b128 v[192:195], v33 offset:2048
    v_mfma_f32_16x16x32_bf16 v[72:75], v[212:215], v[140:143], v[72:75]
    ds_read_b128 v[196:199], v33 offset:3072
    ds_read_b128 v[200:203], v33 offset:4096
    v_mfma_f32_16x16x32_bf16 v[76:79], v[216:219], v[140:143], v[76:79]
    v_mfma_f32_16x16x32_bf16 v[80:83], v[220:223], v[140:143], v[80:83]
    s_waitcnt vmcnt(20)
    s_waitcnt lgkmcnt(5)
    v_mfma_f32_16x16x32_bf16 v[64:67], v[164:167], v[144:147], v[64:67]
    ds_read_b128 v[204:207], v33 offset:5120
    v_mfma_f32_16x16x32_bf16 v[68:71], v[168:171], v[144:147], v[68:71]
    ds_read_b128 v[208:211], v33 offset:6144
    ds_read_b128 v[212:215], v33 offset:7168
    v_mfma_f32_16x16x32_bf16 v[72:75], v[172:175], v[144:147], v[72:75]
    ds_read_b128 v[216:219], v33 offset:8192
    ds_read_b128 v[220:223], v33 offset:9216
    v_mfma_f32_16x16x32_bf16 v[76:79], v[176:179], v[144:147], v[76:79]
    v_mfma_f32_16x16x32_bf16 v[80:83], v[180:183], v[144:147], v[80:83]
    s_waitcnt vmcnt(18)
    s_waitcnt lgkmcnt(5)
    v_mfma_f32_16x16x32_bf16 v[64:67], v[184:187], v[148:151], v[64:67]
    ds_read_b128 v[164:167], v33 offset:10240
    v_mfma_f32_16x16x32_bf16 v[68:71], v[188:191], v[148:151], v[68:71]
    ds_read_b128 v[168:171], v33 offset:11264
    ds_read_b128 v[172:175], v33 offset:12288
    v_mfma_f32_16x16x32_bf16 v[72:75], v[192:195], v[148:151], v[72:75]
    ds_read_b128 v[176:179], v33 offset:13312
    ds_read_b128 v[180:183], v33 offset:14336
    v_mfma_f32_16x16x32_bf16 v[76:79], v[196:199], v[148:151], v[76:79]
    v_mfma_f32_16x16x32_bf16 v[80:83], v[200:203], v[148:151], v[80:83]
    s_waitcnt vmcnt(17)
    s_waitcnt lgkmcnt(5)
    v_mfma_f32_16x16x32_bf16 v[64:67], v[204:207], v[152:155], v[64:67]
    ds_read_b128 v[184:187], v33 offset:15360
    v_mfma_f32_16x16x32_bf16 v[68:71], v[208:211], v[152:155], v[68:71]
    ds_read_b128 v[188:191], v33 offset:16384
    ds_read_b128 v[192:195], v33 offset:17408
    v_mfma_f32_16x16x32_bf16 v[72:75], v[212:215], v[152:155], v[72:75]
    ds_read_b128 v[196:199], v33 offset:18432
    ds_read_b128 v[200:203], v33 offset:19456
    v_mfma_f32_16x16x32_bf16 v[76:79], v[216:219], v[152:155], v[76:79]
    v_mfma_f32_16x16x32_bf16 v[80:83], v[220:223], v[152:155], v[80:83]
    s_waitcnt vmcnt(16)
    s_waitcnt lgkmcnt(5)
    v_mfma_f32_16x16x32_bf16 v[64:67], v[164:167], v[156:159], v[64:67]
    v_mfma_f32_16x16x32_bf16 v[68:71], v[168:171], v[156:159], v[68:71]
    v_mfma_f32_16x16x32_bf16 v[72:75], v[172:175], v[156:159], v[72:75]
    v_mfma_f32_16x16x32_bf16 v[76:79], v[176:179], v[156:159], v[76:79]
    v_mfma_f32_16x16x32_bf16 v[80:83], v[180:183], v[156:159], v[80:83]
    s_waitcnt vmcnt(15)
    s_waitcnt lgkmcnt(0)
    v_mfma_f32_16x16x32_bf16 v[64:67], v[184:187], v[160:163], v[64:67]
    v_mfma_f32_16x16x32_bf16 v[68:71], v[188:191], v[160:163], v[68:71]
    v_mfma_f32_16x16x32_bf16 v[72:75], v[192:195], v[160:163], v[72:75]
    v_mfma_f32_16x16x32_bf16 v[76:79], v[196:199], v[160:163], v[76:79]
    v_mfma_f32_16x16x32_bf16 v[80:83], v[200:203], v[160:163], v[80:83]
    v_lshlrev_b32 v84, 16, v236
    v_and_b32 v85, 0xffff0000, v236
    v_lshlrev_b32 v86, 16, v237
    v_and_b32 v87, 0xffff0000, v237
    v_lshlrev_b32 v88, 16, v238
    v_and_b32 v89, 0xffff0000, v238
    v_lshlrev_b32 v90, 16, v239
    v_and_b32 v91, 0xffff0000, v239
    v_lshlrev_b32 v92, 16, v240
    v_and_b32 v93, 0xffff0000, v240
    v_lshlrev_b32 v94, 16, v241
    v_and_b32 v95, 0xffff0000, v241
    v_lshlrev_b32 v96, 16, v242
    v_and_b32 v97, 0xffff0000, v242
    v_lshlrev_b32 v98, 16, v243
    v_and_b32 v99, 0xffff0000, v243
    v_lshlrev_b32 v100, 16, v244
    v_and_b32 v101, 0xffff0000, v244
    v_lshlrev_b32 v102, 16, v245
    v_and_b32 v103, 0xffff0000, v245
    v_mul_f32 v20, v18, v19
    v_mov_b32 v21, v19
    v_pk_add_f32 v[64:65], v[64:65], v[20:21] op_sel_hi:[1,0] neg_lo:[0,1] neg_hi:[0,1]
    v_pk_add_f32 v[66:67], v[66:67], v[20:21] op_sel_hi:[1,0] neg_lo:[0,1] neg_hi:[0,1]
    v_pk_add_f32 v[68:69], v[68:69], v[20:21] op_sel_hi:[1,0] neg_lo:[0,1] neg_hi:[0,1]
    v_pk_add_f32 v[70:71], v[70:71], v[20:21] op_sel_hi:[1,0] neg_lo:[0,1] neg_hi:[0,1]
    v_pk_add_f32 v[72:73], v[72:73], v[20:21] op_sel_hi:[1,0] neg_lo:[0,1] neg_hi:[0,1]
    v_pk_add_f32 v[74:75], v[74:75], v[20:21] op_sel_hi:[1,0] neg_lo:[0,1] neg_hi:[0,1]
    v_pk_add_f32 v[76:77], v[76:77], v[20:21] op_sel_hi:[1,0] neg_lo:[0,1] neg_hi:[0,1]
    v_pk_add_f32 v[78:79], v[78:79], v[20:21] op_sel_hi:[1,0] neg_lo:[0,1] neg_hi:[0,1]
    v_pk_add_f32 v[80:81], v[80:81], v[20:21] op_sel_hi:[1,0] neg_lo:[0,1] neg_hi:[0,1]
    v_pk_add_f32 v[82:83], v[82:83], v[20:21] op_sel_hi:[1,0] neg_lo:[0,1] neg_hi:[0,1]
    v_pk_fma_f32 v[64:65], v[84:85], v[20:21], v[64:65] op_sel:[0,1,0] op_sel_hi:[1,1,1]
    v_pk_fma_f32 v[66:67], v[86:87], v[20:21], v[66:67] op_sel:[0,1,0] op_sel_hi:[1,1,1]
    v_pk_fma_f32 v[68:69], v[88:89], v[20:21], v[68:69] op_sel:[0,1,0] op_sel_hi:[1,1,1]
    v_pk_fma_f32 v[70:71], v[90:91], v[20:21], v[70:71] op_sel:[0,1,0] op_sel_hi:[1,1,1]
    v_pk_fma_f32 v[72:73], v[92:93], v[20:21], v[72:73] op_sel:[0,1,0] op_sel_hi:[1,1,1]
    v_pk_fma_f32 v[74:75], v[94:95], v[20:21], v[74:75] op_sel:[0,1,0] op_sel_hi:[1,1,1]
    v_pk_fma_f32 v[76:77], v[96:97], v[20:21], v[76:77] op_sel:[0,1,0] op_sel_hi:[1,1,1]
    v_pk_fma_f32 v[78:79], v[98:99], v[20:21], v[78:79] op_sel:[0,1,0] op_sel_hi:[1,1,1]
    v_pk_fma_f32 v[80:81], v[100:101], v[20:21], v[80:81] op_sel:[0,1,0] op_sel_hi:[1,1,1]
    v_pk_fma_f32 v[82:83], v[102:103], v[20:21], v[82:83] op_sel:[0,1,0] op_sel_hi:[1,1,1]
    s_add_u32 s66, s62, 0xa00000
    s_add_u32 s67, s63, 0xa00000
    v_cvt_pk_bf16_f32 v246, v64, v65
    v_cvt_pk_bf16_f32 v247, v66, v67
    v_cvt_pk_bf16_f32 v248, v68, v69
    v_cvt_pk_bf16_f32 v249, v70, v71
    v_cvt_pk_bf16_f32 v250, v72, v73
    v_cvt_pk_bf16_f32 v251, v74, v75
    v_cvt_pk_bf16_f32 v252, v76, v77
    v_cvt_pk_bf16_f32 v253, v78, v79
    v_cvt_pk_bf16_f32 v254, v80, v81
    v_cvt_pk_bf16_f32 v255, v82, v83
    buffer_store_dwordx4 v[246:249], v30, s[8:11], s66 offen offset:0 sc1
    buffer_store_dwordx4 v[250:253], v30, s[8:11], s66 offen offset:1024 sc1
    buffer_store_dwordx2 v[254:255], v2, s[8:11], s67 offen offset:0 sc1
    v_pk_mul_f32 v[24:25], v[64:65], v[64:65]
    v_pk_add_f32 v[22:23], v[64:65], v[66:67]
    v_pk_fma_f32 v[24:25], v[66:67], v[66:67], v[24:25]
    v_pk_add_f32 v[22:23], v[22:23], v[68:69]
    v_pk_fma_f32 v[24:25], v[68:69], v[68:69], v[24:25]
    v_pk_add_f32 v[22:23], v[22:23], v[70:71]
    v_pk_fma_f32 v[24:25], v[70:71], v[70:71], v[24:25]
    v_pk_add_f32 v[22:23], v[22:23], v[72:73]
    v_pk_fma_f32 v[24:25], v[72:73], v[72:73], v[24:25]
    v_pk_add_f32 v[22:23], v[22:23], v[74:75]
    v_pk_fma_f32 v[24:25], v[74:75], v[74:75], v[24:25]
    v_pk_add_f32 v[22:23], v[22:23], v[76:77]
    v_pk_fma_f32 v[24:25], v[76:77], v[76:77], v[24:25]
    v_pk_add_f32 v[22:23], v[22:23], v[78:79]
    v_pk_fma_f32 v[24:25], v[78:79], v[78:79], v[24:25]
    v_pk_add_f32 v[22:23], v[22:23], v[80:81]
    v_pk_fma_f32 v[24:25], v[80:81], v[80:81], v[24:25]
    v_pk_add_f32 v[22:23], v[22:23], v[82:83]
    v_pk_fma_f32 v[24:25], v[82:83], v[82:83], v[24:25]
    v_add_f32 v22, v22, v23
    v_add_f32 v23, v24, v25
    v_mov_b32 v24, v22
    v_mov_b32 v25, v23
    s_nop 1
    v_permlane32_swap_b32 v24, v22
    v_permlane32_swap_b32 v25, v23
    v_pk_add_f32 v[22:23], v[22:23], v[24:25]
    v_mov_b32 v24, v22
    v_mov_b32 v25, v23
    s_nop 1
    v_permlane16_swap_b32 v24, v22
    v_permlane16_swap_b32 v25, v23
    v_pk_add_f32 v[22:23], v[22:23], v[24:25]
    s_lshl_b32 s3, s65, 6
    s_lshl_b32 s29, s28, 7
    s_add_u32 s3, s3, s29
    s_add_u32 s3, s3, 0x1c10000
    v_lshlrev_b32 v6, 3, v4
    s_mov_b64 exec, 0xffff
    buffer_store_dwordx2 v[22:23], v6, s[8:11], s3 offen sc1
    s_mov_b64 exec, -1
    s_barrier
    v_lshlrev_b32 v26, 2, v5
    v_sub_u32 v26, v4, v26
    v_mov_b32 v92, 0xf149f2ca
    s_cmp_eq_u32 s65, 0
    s_cselect_b32 s3, 1024, 16
    v_add_u32 v27, s3, v26
    v_subrev_u32 v27, 0, v27
    v_and_b32 v27, 0xfffffff1, v27
    v_cmp_eq_u32 vcc, 0, v27
    s_nop 1
    v_cndmask_b32 v84, v92, 0, vcc
    v_add_u32 v27, s3, v26
    v_subrev_u32 v27, 1, v27
    v_and_b32 v27, 0xfffffff1, v27
    v_cmp_eq_u32 vcc, 0, v27
    s_nop 1
    v_cndmask_b32 v85, v92, 0, vcc
    v_add_u32 v27, s3, v26
    v_subrev_u32 v27, 2, v27
    v_and_b32 v27, 0xfffffff1, v27
    v_cmp_eq_u32 vcc, 0, v27
    s_nop 1
    v_cndmask_b32 v86, v92, 0, vcc
    v_add_u32 v27, s3, v26
    v_subrev_u32 v27, 3, v27
    v_and_b32 v27, 0xfffffff1, v27
    v_cmp_eq_u32 vcc, 0, v27
    s_nop 1
    v_cndmask_b32 v87, v92, 0, vcc
    v_subrev_u32 v27, 0, v26
    v_and_b32 v27, 0xfffffff1, v27
    v_cmp_eq_u32 vcc, 0, v27
    s_nop 1
    v_cndmask_b32 v88, v92, 0, vcc
    v_subrev_u32 v27, 1, v26
    v_and_b32 v27, 0xfffffff1, v27
    v_cmp_eq_u32 vcc, 0, v27
    s_nop 1
    v_cndmask_b32 v89, v92, 0, vcc
    v_subrev_u32 v27, 2, v26
    v_and_b32 v27, 0xfffffff1, v27
    v_cmp_eq_u32 vcc, 0, v27
    s_nop 1
    v_cndmask_b32 v90, v92, 0, vcc
    v_subrev_u32 v27, 3, v26
    v_and_b32 v27, 0xfffffff1, v27
    v_cmp_eq_u32 vcc, 0, v27
    s_nop 1
    v_cndmask_b32 v91, v92, 0, vcc
    s_waitcnt vmcnt(4)
    s_mov_b32 vcc_lo, 0xffff
    s_mov_b32 vcc_hi, 0x0
    s_nop 0
    v_cndmask_b32 v128, 0, v42, vcc
    v_cndmask_b32 v129, 0, v43, vcc
    s_mov_b32 vcc_lo, 0xffff0000
    s_mov_b32 vcc_hi, 0x0
    s_nop 0
    v_cndmask_b32 v130, 0, v42, vcc
    v_cndmask_b32 v131, 0, v43, vcc
    s_mov_b32 vcc_lo, 0x0
    s_mov_b32 vcc_hi, 0xffff
    s_nop 0
    v_cndmask_b32 v132, 0, v42, vcc
    v_cndmask_b32 v133, 0, v43, vcc
    s_mov_b32 vcc_lo, 0x0
    s_mov_b32 vcc_hi, 0xffff0000
    s_nop 0
    v_cndmask_b32 v134, 0, v42, vcc
    v_cndmask_b32 v135, 0, v43, vcc
    s_nop 1
    v_mfma_f32_16x16x16_bf16 v[96:99], v[54:55], v[34:35], v[84:87]
    v_mfma_f32_16x16x16_bf16 v[100:103], v[44:45], v[34:35], v[88:91]
    v_mfma_f32_16x16x16_bf16 v[104:107], v[56:57], v[36:37], v[84:87]
    v_mfma_f32_16x16x16_bf16 v[108:111], v[46:47], v[36:37], v[88:91]
    v_mfma_f32_16x16x16_bf16 v[112:115], v[58:59], v[38:39], v[84:87]
    v_mfma_f32_16x16x16_bf16 v[116:119], v[48:49], v[38:39], v[88:91]
    v_mfma_f32_16x16x16_bf16 v[120:123], v[60:61], v[40:41], v[84:87]
    v_mfma_f32_16x16x16_bf16 v[124:127], v[50:51], v[40:41], v[88:91]
    v_mfma_f32_16x16x16_bf16 v[96:99], v[62:63], v[128:129], v[96:99]
    v_mfma_f32_16x16x16_bf16 v[100:103], v[52:53], v[128:129], v[100:103]
    v_mfma_f32_16x16x16_bf16 v[104:107], v[62:63], v[130:131], v[104:107]
    v_mfma_f32_16x16x16_bf16 v[108:111], v[52:53], v[130:131], v[108:111]
    v_mfma_f32_16x16x16_bf16 v[112:115], v[62:63], v[132:133], v[112:115]
    v_mfma_f32_16x16x16_bf16 v[116:119], v[52:53], v[132:133], v[116:119]
    v_mfma_f32_16x16x16_bf16 v[120:123], v[62:63], v[134:135], v[120:123]
    v_mfma_f32_16x16x16_bf16 v[124:127], v[52:53], v[134:135], v[124:127]
    s_mov_b32 vcc_lo, 0xf000f
    s_mov_b32 vcc_hi, 0xf000f
    s_nop 0
    v_cndmask_b32 v152, 0, v16, vcc
    v_cndmask_b32 v153, 0, v17, vcc
    v_cndmask_b32 v154, 0, v232, vcc
    v_cndmask_b32 v155, 0, v233, vcc
    s_mov_b32 vcc_lo, 0xf000f0
    s_mov_b32 vcc_hi, 0xf000f0
    s_nop 0
    v_cndmask_b32 v156, 0, v16, vcc
    v_cndmask_b32 v157, 0, v17, vcc
    v_cndmask_b32 v158, 0, v232, vcc
    v_cndmask_b32 v159, 0, v233, vcc
    s_mov_b32 vcc_lo, 0xf000f00
    s_mov_b32 vcc_hi, 0xf000f00
    s_nop 0
    v_cndmask_b32 v160, 0, v16, vcc
    v_cndmask_b32 v161, 0, v17, vcc
    v_cndmask_b32 v162, 0, v232, vcc
    v_cndmask_b32 v163, 0, v233, vcc
    s_mov_b32 vcc_lo, 0xf000f000
    s_mov_b32 vcc_hi, 0xf000f000
    s_nop 0
    v_cndmask_b32 v164, 0, v16, vcc
    v_cndmask_b32 v165, 0, v17, vcc
    v_cndmask_b32 v166, 0, v232, vcc
    v_cndmask_b32 v167, 0, v233, vcc
    s_mov_b32 s66, 0x3ea52b5c
    v_max3_f32 v20, v96, v97, v98
    v_max3_f32 v20, v20, v99, v100
    v_max3_f32 v20, v20, v101, v102
    v_max_f32 v20, v20, v103
    v_max3_f32 v21, v104, v105, v106
    v_max3_f32 v21, v21, v107, v108
    v_max3_f32 v21, v21, v109, v110
    v_max_f32 v21, v21, v111
    v_max3_f32 v22, v112, v113, v114
    v_max3_f32 v22, v22, v115, v116
    v_max3_f32 v22, v22, v117, v118
    v_max_f32 v22, v22, v119
    v_max3_f32 v23, v120, v121, v122
    v_max3_f32 v23, v23, v123, v124
    v_max3_f32 v23, v23, v125, v126
    v_max_f32 v23, v23, v127
    v_mov_b32 v24, v20
    v_mov_b32 v25, v21
    v_mov_b32 v26, v22
    v_mov_b32 v27, v23
    s_nop 1
    v_permlane32_swap_b32 v24, v20
    v_permlane32_swap_b32 v25, v21
    v_permlane32_swap_b32 v26, v22
    v_permlane32_swap_b32 v27, v23
    v_max_f32 v20, v20, v24
    v_max_f32 v21, v21, v25
    v_max_f32 v22, v22, v26
    v_max_f32 v23, v23, v27
    v_mov_b32 v24, v20
    v_mov_b32 v25, v21
    v_mov_b32 v26, v22
    v_mov_b32 v27, v23
    s_nop 1
    v_permlane16_swap_b32 v24, v20
    v_permlane16_swap_b32 v25, v21
    v_permlane16_swap_b32 v26, v22
    v_permlane16_swap_b32 v27, v23
    v_max_f32 v20, v20, v24
    v_max_f32 v21, v21, v25
    v_max_f32 v22, v22, v26
    v_max_f32 v23, v23, v27
    v_mul_f32 v20, s66, v20
    v_mul_f32 v21, s66, v21
    v_mul_f32 v22, s66, v22
    v_mul_f32 v23, s66, v23
    v_fma_f32 v96, v96, s66, -v20
    v_fma_f32 v97, v97, s66, -v20
    v_fma_f32 v98, v98, s66, -v20
    v_fma_f32 v99, v99, s66, -v20
    v_fma_f32 v100, v100, s66, -v20
    v_fma_f32 v101, v101, s66, -v20
    v_fma_f32 v102, v102, s66, -v20
    v_fma_f32 v103, v103, s66, -v20
    v_fma_f32 v104, v104, s66, -v21
    v_fma_f32 v105, v105, s66, -v21
    v_fma_f32 v106, v106, s66, -v21
    v_fma_f32 v107, v107, s66, -v21
    v_fma_f32 v108, v108, s66, -v21
    v_fma_f32 v109, v109, s66, -v21
    v_fma_f32 v110, v110, s66, -v21
    v_fma_f32 v111, v111, s66, -v21
    v_fma_f32 v112, v112, s66, -v22
    v_fma_f32 v113, v113, s66, -v22
    v_fma_f32 v114, v114, s66, -v22
    v_fma_f32 v115, v115, s66, -v22
    v_fma_f32 v116, v116, s66, -v22
    v_fma_f32 v117, v117, s66, -v22
    v_fma_f32 v118, v118, s66, -v22
    v_fma_f32 v119, v119, s66, -v22
    v_fma_f32 v120, v120, s66, -v23
    v_fma_f32 v121, v121, s66, -v23
    v_fma_f32 v122, v122, s66, -v23
    v_fma_f32 v123, v123, s66, -v23
    v_fma_f32 v124, v124, s66, -v23
    v_fma_f32 v125, v125, s66, -v23
    v_fma_f32 v126, v126, s66, -v23
    v_fma_f32 v127, v127, s66, -v23
    v_exp_f32 v96, v96
    v_exp_f32 v97, v97
    v_exp_f32 v98, v98
    v_exp_f32 v99, v99
    v_exp_f32 v100, v100
    v_exp_f32 v101, v101
    v_exp_f32 v102, v102
    v_exp_f32 v103, v103
    v_exp_f32 v104, v104
    v_exp_f32 v105, v105
    v_exp_f32 v106, v106
    v_exp_f32 v107, v107
    v_exp_f32 v108, v108
    v_exp_f32 v109, v109
    v_exp_f32 v110, v110
    v_exp_f32 v111, v111
    v_exp_f32 v112, v112
    v_exp_f32 v113, v113
    v_exp_f32 v114, v114
    v_exp_f32 v115, v115
    v_exp_f32 v116, v116
    v_exp_f32 v117, v117
    v_exp_f32 v118, v118
    v_exp_f32 v119, v119
    v_exp_f32 v120, v120
    v_exp_f32 v121, v121
    v_exp_f32 v122, v122
    v_exp_f32 v123, v123
    v_exp_f32 v124, v124
    v_exp_f32 v125, v125
    v_exp_f32 v126, v126
    v_exp_f32 v127, v127
    s_nop 0
    v_pk_add_f32 v[24:25], v[96:97], v[98:99]
    v_pk_add_f32 v[26:27], v[100:101], v[102:103]
    v_pk_add_f32 v[24:25], v[24:25], v[26:27]
    v_add_f32 v20, v24, v25
    v_pk_add_f32 v[24:25], v[104:105], v[106:107]
    v_pk_add_f32 v[26:27], v[108:109], v[110:111]
    v_pk_add_f32 v[24:25], v[24:25], v[26:27]
    v_add_f32 v21, v24, v25
    v_pk_add_f32 v[24:25], v[112:113], v[114:115]
    v_pk_add_f32 v[26:27], v[116:117], v[118:119]
    v_pk_add_f32 v[24:25], v[24:25], v[26:27]
    v_add_f32 v22, v24, v25
    v_pk_add_f32 v[24:25], v[120:121], v[122:123]
    v_pk_add_f32 v[26:27], v[124:125], v[126:127]
    v_pk_add_f32 v[24:25], v[24:25], v[26:27]
    v_add_f32 v23, v24, v25
    v_mov_b32 v24, v20
    v_mov_b32 v25, v21
    v_mov_b32 v26, v22
    v_mov_b32 v27, v23
    s_nop 1
    v_permlane32_swap_b32 v24, v20
    v_permlane32_swap_b32 v25, v21
    v_permlane32_swap_b32 v26, v22
    v_permlane32_swap_b32 v27, v23
    v_add_f32 v20, v20, v24
    v_add_f32 v21, v21, v25
    v_add_f32 v22, v22, v26
    v_add_f32 v23, v23, v27
    v_mov_b32 v24, v20
    v_mov_b32 v25, v21
    v_mov_b32 v26, v22
    v_mov_b32 v27, v23
    s_nop 1
    v_permlane16_swap_b32 v24, v20
    v_permlane16_swap_b32 v25, v21
    v_permlane16_swap_b32 v26, v22
    v_permlane16_swap_b32 v27, v23
    v_add_f32 v20, v20, v24
    v_add_f32 v21, v21, v25
    v_add_f32 v22, v22, v26
    v_add_f32 v23, v23, v27
    s_waitcnt vmcnt(0)
    s_lshl_b32 s70, s25, 7
    s_lshl_b32 s3, s26, 2
    s_add_u32 s70, s70, s3
    s_add_u32 s70, s70, 0x1c44000
    s_mov_b64 exec, 1
    v_mov_b32 v7, 1
    v_mov_b32 v33, 150788
    ds_add_rtn_u32 v33, v33, v7
    s_waitcnt lgkmcnt(0)
    v_cmp_eq_u32 vcc, 3, v33
    s_cbranch_vccz Lws6
    buffer_store_dword v7, off, s[8:11], s70 sc1
Lws6:
    s_mov_b64 exec, -1
    v_rcp_f32 v20, v20
    v_rcp_f32 v21, v21
    v_rcp_f32 v22, v22
    v_rcp_f32 v23, v23
    s_nop 0
    v_mul_f32 v96, v96, v20
    v_mul_f32 v97, v97, v20
    v_mul_f32 v98, v98, v20
    v_mul_f32 v99, v99, v20
    v_mul_f32 v100, v100, v20
    v_mul_f32 v101, v101, v20
    v_mul_f32 v102, v102, v20
    v_mul_f32 v103, v103, v20
    v_cvt_pk_bf16_f32 v136, v96, v97
    v_cvt_pk_bf16_f32 v137, v98, v99
    v_cvt_pk_bf16_f32 v138, v100, v101
    v_cvt_pk_bf16_f32 v139, v102, v103
    v_mul_f32 v104, v104, v21
    v_mul_f32 v105, v105, v21
    v_mul_f32 v106, v106, v21
    v_mul_f32 v107, v107, v21
    v_mul_f32 v108, v108, v21
    v_mul_f32 v109, v109, v21
    v_mul_f32 v110, v110, v21
    v_mul_f32 v111, v111, v21
    v_cvt_pk_bf16_f32 v140, v104, v105
    v_cvt_pk_bf16_f32 v141, v106, v107
    v_cvt_pk_bf16_f32 v142, v108, v109
    v_cvt_pk_bf16_f32 v143, v110, v111
    v_mul_f32 v112, v112, v22
    v_mul_f32 v113, v113, v22
    v_mul_f32 v114, v114, v22
    v_mul_f32 v115, v115, v22
    v_mul_f32 v116, v116, v22
    v_mul_f32 v117, v117, v22
    v_mul_f32 v118, v118, v22
    v_mul_f32 v119, v119, v22
    v_cvt_pk_bf16_f32 v144, v112, v113
    v_cvt_pk_bf16_f32 v145, v114, v115
    v_cvt_pk_bf16_f32 v146, v116, v117
    v_cvt_pk_bf16_f32 v147, v118, v119
    v_mul_f32 v120, v120, v23
    v_mul_f32 v121, v121, v23
    v_mul_f32 v122, v122, v23
    v_mul_f32 v123, v123, v23
    v_mul_f32 v124, v124, v23
    v_mul_f32 v125, v125, v23
    v_mul_f32 v126, v126, v23
    v_mul_f32 v127, v127, v23
    v_cvt_pk_bf16_f32 v148, v120, v121
    v_cvt_pk_bf16_f32 v149, v122, v123
    v_cvt_pk_bf16_f32 v150, v124, v125
    v_cvt_pk_bf16_f32 v151, v126, v127
    s_nop 1
    v_mfma_f32_16x16x16_bf16 v[168:171], v[8:9], v[136:137], 0
    v_mfma_f32_16x16x16_bf16 v[172:175], v[10:11], v[140:141], 0
    v_mfma_f32_16x16x16_bf16 v[176:179], v[12:13], v[144:145], 0
    v_mfma_f32_16x16x16_bf16 v[180:183], v[14:15], v[148:149], 0
    v_mfma_f32_16x16x16_bf16 v[168:171], v[224:225], v[138:139], v[168:171]
    v_mfma_f32_16x16x16_bf16 v[172:175], v[226:227], v[142:143], v[172:175]
    v_mfma_f32_16x16x16_bf16 v[176:179], v[228:229], v[146:147], v[176:179]
    v_mfma_f32_16x16x16_bf16 v[180:183], v[230:231], v[150:151], v[180:183]
    v_mfma_f32_16x16x16_bf16 v[184:187], v[152:153], v[136:137], 0
    v_mfma_f32_16x16x16_bf16 v[184:187], v[154:155], v[138:139], v[184:187]
    v_mfma_f32_16x16x16_bf16 v[184:187], v[156:157], v[140:141], v[184:187]
    v_mfma_f32_16x16x16_bf16 v[184:187], v[158:159], v[142:143], v[184:187]
    v_mfma_f32_16x16x16_bf16 v[184:187], v[160:161], v[144:145], v[184:187]
    v_mfma_f32_16x16x16_bf16 v[184:187], v[162:163], v[146:147], v[184:187]
    v_mfma_f32_16x16x16_bf16 v[184:187], v[164:165], v[148:149], v[184:187]
    v_mfma_f32_16x16x16_bf16 v[184:187], v[166:167], v[150:151], v[184:187]
    s_add_u32 s66, s62, 0xc80000
    s_add_u32 s67, s63, 0xc80000
    s_nop 7
    v_cvt_pk_bf16_f32 v84, v168, v169
    v_cvt_pk_bf16_f32 v85, v170, v171
    v_cvt_pk_bf16_f32 v86, v172, v173
    v_cvt_pk_bf16_f32 v87, v174, v175
    v_cvt_pk_bf16_f32 v88, v176, v177
    v_cvt_pk_bf16_f32 v89, v178, v179
    v_cvt_pk_bf16_f32 v90, v180, v181
    v_cvt_pk_bf16_f32 v91, v182, v183
    v_cvt_pk_bf16_f32 v92, v184, v185
    v_cvt_pk_bf16_f32 v93, v186, v187
    buffer_store_dwordx4 v[84:87], v30, s[8:11], s66 offen offset:0 sc1
    buffer_store_dwordx4 v[88:91], v30, s[8:11], s66 offen offset:1024 sc1
    buffer_store_dwordx2 v[92:93], v2, s[8:11], s67 offen offset:0 sc1
    s_lshl_b32 s65, s38, 7
    s_lshl_b32 s3, s22, 5
    s_add_u32 s65, s65, s3
    s_lshl_b32 s68, s65, 6
    s_add_u32 s68, s68, 0x1c10000
    s_lshr_b32 s3, s65, 4
    s_mul_i32 s66, s3, 20480
    s_add_u32 s66, s66, 0xa00000
    s_mov_b32 s3, 0
    s_lshl_b32 s56, s3, 12
    s_mul_i32 s57, s3, 28672
    v_lshlrev_b32 v6, 3, v4
    v_lshl_add_u32 v6, v5, 8, v6
    s_barrier
    s_add_u32 s20, s66, s56
    s_add_u32 s21, s20, 20480
    buffer_load_dwordx4 v[120:123], v30, s[8:11], s20 offen offset:0 sc1
    buffer_load_dwordx4 v[124:127], v30, s[8:11], s21 offen offset:0 sc1
    buffer_load_dwordx4 v[128:131], v30, s[8:11], s20 offen offset:1024 sc1
    buffer_load_dwordx4 v[132:135], v30, s[8:11], s21 offen offset:1024 sc1
    buffer_load_dwordx4 v[136:139], v30, s[8:11], s20 offen offset:2048 sc1
    buffer_load_dwordx4 v[140:143], v30, s[8:11], s21 offen offset:2048 sc1
    buffer_load_dwordx2 v[12:13], v6, s[8:11], s68 offen offset:0 sc1
    buffer_load_dwordx2 v[14:15], v6, s[8:11], s68 offen offset:128 sc1
    buffer_load_dwordx2 v[16:17], v6, s[8:11], s68 offen offset:1024 sc1
    buffer_load_dwordx2 v[18:19], v6, s[8:11], s68 offen offset:1152 sc1
    v_add_u32 v33, s57, v30
    ds_read_b128 v[34:37], v33 offset:0
    ds_read_b128 v[38:41], v33 offset:1024
    ds_read_b128 v[42:45], v33 offset:2048
    ds_read_b128 v[46:49], v33 offset:3072
    ds_read_b128 v[50:53], v33 offset:4096
    ds_read_b128 v[54:57], v33 offset:5120
    ds_read_b128 v[58:61], v33 offset:6144
    ds_read_b128 v[208:211], v33 offset:7168
    ds_read_b128 v[212:215], v33 offset:8192
    ds_read_b128 v[216:219], v33 offset:9216
    ds_read_b128 v[220:223], v33 offset:10240
    ds_read_b128 v[224:227], v33 offset:11264
    ds_read_b128 v[228:231], v33 offset:12288
    ds_read_b128 v[232:235], v33 offset:13312
    s_waitcnt vmcnt(8)
    s_waitcnt lgkmcnt(7)
    v_mfma_f32_16x16x32_bf16 v[64:67], v[34:37], v[120:123], 0
    v_mfma_f32_16x16x32_bf16 v[92:95], v[34:37], v[124:127], 0
    ds_read_b128 v[34:37], v33 offset:14336
    buffer_load_dwordx4 v[144:147], v30, s[8:11], s20 offen offset:3072 sc1
    v_mfma_f32_16x16x32_bf16 v[68:71], v[38:41], v[120:123], 0
    v_mfma_f32_16x16x32_bf16 v[96:99], v[38:41], v[124:127], 0
    ds_read_b128 v[38:41], v33 offset:15360
    v_mfma_f32_16x16x32_bf16 v[72:75], v[42:45], v[120:123], 0
    v_mfma_f32_16x16x32_bf16 v[100:103], v[42:45], v[124:127], 0
    buffer_load_dwordx4 v[148:151], v30, s[8:11], s21 offen offset:3072 sc1
    ds_read_b128 v[42:45], v33 offset:16384
    v_mfma_f32_16x16x32_bf16 v[76:79], v[46:49], v[120:123], 0
    v_mfma_f32_16x16x32_bf16 v[104:107], v[46:49], v[124:127], 0
    ds_read_b128 v[46:49], v33 offset:17408
    v_mfma_f32_16x16x32_bf16 v[80:83], v[50:53], v[120:123], 0
    v_mfma_f32_16x16x32_bf16 v[108:111], v[50:53], v[124:127], 0
    s_add_u32 s56, s56, 4096
    s_cmp_ge_u32 s56, 20480
    s_cselect_b32 s56, 0, s56
    s_add_u32 s20, s66, s56
    s_add_u32 s21, s20, 20480
    buffer_load_dwordx4 v[152:155], v30, s[8:11], s20 offen offset:0 sc1
    ds_read_b128 v[50:53], v33 offset:18432
    v_mfma_f32_16x16x32_bf16 v[84:87], v[54:57], v[120:123], 0
    v_mfma_f32_16x16x32_bf16 v[112:115], v[54:57], v[124:127], 0
    ds_read_b128 v[54:57], v33 offset:19456
    v_mfma_f32_16x16x32_bf16 v[88:91], v[58:61], v[120:123], 0
    buffer_load_dwordx4 v[156:159], v30, s[8:11], s21 offen offset:0 sc1
    v_mfma_f32_16x16x32_bf16 v[116:119], v[58:61], v[124:127], 0
    ds_read_b128 v[58:61], v33 offset:20480
    s_lshl_b32 s71, s26, 2
    s_add_u32 s71, s71, s22
    s_lshl_b32 s70, s25, 8
    s_lshl_b32 s3, s71, 2
    s_add_u32 s70, s70, s3
    s_add_u32 s70, s70, 0x1c45000
    v_mov_b32 v7, 1
    s_mov_b64 exec, 1
    buffer_store_dword v7, off, s[8:11], s70 sc1
    s_mov_b64 exec, -1
    s_waitcnt vmcnt(11)
    s_waitcnt lgkmcnt(7)
    v_mfma_f32_16x16x32_bf16 v[64:67], v[208:211], v[128:131], v[64:67]
    v_mfma_f32_16x16x32_bf16 v[92:95], v[208:211], v[132:135], v[92:95]
    ds_read_b128 v[208:211], v33 offset:21504
    buffer_load_dwordx4 v[160:163], v30, s[8:11], s20 offen offset:1024 sc1
    v_mfma_f32_16x16x32_bf16 v[68:71], v[212:215], v[128:131], v[68:71]
    v_mfma_f32_16x16x32_bf16 v[96:99], v[212:215], v[132:135], v[96:99]
    ds_read_b128 v[212:215], v33 offset:22528
    v_mfma_f32_16x16x32_bf16 v[72:75], v[216:219], v[128:131], v[72:75]
    v_mfma_f32_16x16x32_bf16 v[100:103], v[216:219], v[132:135], v[100:103]
    buffer_load_dwordx4 v[164:167], v30, s[8:11], s21 offen offset:1024 sc1
    ds_read_b128 v[216:219], v33 offset:23552
    v_mfma_f32_16x16x32_bf16 v[76:79], v[220:223], v[128:131], v[76:79]
    v_mfma_f32_16x16x32_bf16 v[104:107], v[220:223], v[132:135], v[104:107]
    ds_read_b128 v[220:223], v33 offset:24576
    v_mfma_f32_16x16x32_bf16 v[80:83], v[224:227], v[128:131], v[80:83]
    v_mfma_f32_16x16x32_bf16 v[108:111], v[224:227], v[132:135], v[108:111]
    buffer_load_dwordx4 v[168:171], v30, s[8:11], s20 offen offset:2048 sc1
    ds_read_b128 v[224:227], v33 offset:25600
    v_mfma_f32_16x16x32_bf16 v[84:87], v[228:231], v[128:131], v[84:87]
    v_mfma_f32_16x16x32_bf16 v[112:115], v[228:231], v[132:135], v[112:115]
    ds_read_b128 v[228:231], v33 offset:26624
    v_mfma_f32_16x16x32_bf16 v[88:91], v[232:235], v[128:131], v[88:91]
    buffer_load_dwordx4 v[172:175], v30, s[8:11], s21 offen offset:2048 sc1
    v_mfma_f32_16x16x32_bf16 v[116:119], v[232:235], v[132:135], v[116:119]
    ds_read_b128 v[232:235], v33 offset:27648
    s_waitcnt vmcnt(13)
    s_waitcnt lgkmcnt(7)
    v_mfma_f32_16x16x32_bf16 v[64:67], v[34:37], v[136:139], v[64:67]
    v_mfma_f32_16x16x32_bf16 v[92:95], v[34:37], v[140:143], v[92:95]
    s_add_u32 s57, s57, 28672
    s_cmp_ge_u32 s57, 143360
    s_cselect_b32 s57, 0, s57
    v_add_u32 v33, s57, v30
    ds_read_b128 v[34:37], v33 offset:0
    buffer_load_dwordx4 v[176:179], v30, s[8:11], s20 offen offset:3072 sc1
    v_mfma_f32_16x16x32_bf16 v[68:71], v[38:41], v[136:139], v[68:71]
    v_mfma_f32_16x16x32_bf16 v[96:99], v[38:41], v[140:143], v[96:99]
    ds_read_b128 v[38:41], v33 offset:1024
    v_mfma_f32_16x16x32_bf16 v[72:75], v[42:45], v[136:139], v[72:75]
    v_mfma_f32_16x16x32_bf16 v[100:103], v[42:45], v[140:143], v[100:103]
    buffer_load_dwordx4 v[180:183], v30, s[8:11], s21 offen offset:3072 sc1
    ds_read_b128 v[42:45], v33 offset:2048
    v_mfma_f32_16x16x32_bf16 v[76:79], v[46:49], v[136:139], v[76:79]
    v_mfma_f32_16x16x32_bf16 v[104:107], v[46:49], v[140:143], v[104:107]
    ds_read_b128 v[46:49], v33 offset:3072
    v_mfma_f32_16x16x32_bf16 v[80:83], v[50:53], v[136:139], v[80:83]
    v_mfma_f32_16x16x32_bf16 v[108:111], v[50:53], v[140:143], v[108:111]
    s_add_u32 s56, s56, 4096
    s_cmp_ge_u32 s56, 20480
    s_cselect_b32 s56, 0, s56
    s_add_u32 s20, s66, s56
    s_add_u32 s21, s20, 20480
    buffer_load_dwordx4 v[184:187], v30, s[8:11], s20 offen offset:0 sc1
    ds_read_b128 v[50:53], v33 offset:4096
    v_mfma_f32_16x16x32_bf16 v[84:87], v[54:57], v[136:139], v[84:87]
    v_mfma_f32_16x16x32_bf16 v[112:115], v[54:57], v[140:143], v[112:115]
    ds_read_b128 v[54:57], v33 offset:5120
    v_mfma_f32_16x16x32_bf16 v[88:91], v[58:61], v[136:139], v[88:91]
    buffer_load_dwordx4 v[188:191], v30, s[8:11], s21 offen offset:0 sc1
    v_mfma_f32_16x16x32_bf16 v[116:119], v[58:61], v[140:143], v[116:119]
    ds_read_b128 v[58:61], v33 offset:6144
    s_waitcnt vmcnt(11)
    s_waitcnt lgkmcnt(7)
    v_mfma_f32_16x16x32_bf16 v[64:67], v[208:211], v[144:147], v[64:67]
    v_mfma_f32_16x16x32_bf16 v[92:95], v[208:211], v[148:151], v[92:95]
    ds_read_b128 v[208:211], v33 offset:7168
    buffer_load_dwordx4 v[192:195], v30, s[8:11], s20 offen offset:1024 sc1
    v_mfma_f32_16x16x32_bf16 v[68:71], v[212:215], v[144:147], v[68:71]
    v_mfma_f32_16x16x32_bf16 v[96:99], v[212:215], v[148:151], v[96:99]
    ds_read_b128 v[212:215], v33 offset:8192
    v_mfma_f32_16x16x32_bf16 v[72:75], v[216:219], v[144:147], v[72:75]
    v_mfma_f32_16x16x32_bf16 v[100:103], v[216:219], v[148:151], v[100:103]
    buffer_load_dwordx4 v[196:199], v30, s[8:11], s21 offen offset:1024 sc1
    ds_read_b128 v[216:219], v33 offset:9216
    v_mfma_f32_16x16x32_bf16 v[76:79], v[220:223], v[144:147], v[76:79]
    v_mfma_f32_16x16x32_bf16 v[104:107], v[220:223], v[148:151], v[104:107]
    ds_read_b128 v[220:223], v33 offset:10240
    v_mfma_f32_16x16x32_bf16 v[80:83], v[224:227], v[144:147], v[80:83]
    v_mfma_f32_16x16x32_bf16 v[108:111], v[224:227], v[148:151], v[108:111]
    buffer_load_dwordx4 v[200:203], v30, s[8:11], s20 offen offset:2048 sc1
    ds_read_b128 v[224:227], v33 offset:11264
    v_mfma_f32_16x16x32_bf16 v[84:87], v[228:231], v[144:147], v[84:87]
    v_mfma_f32_16x16x32_bf16 v[112:115], v[228:231], v[148:151], v[112:115]
    ds_read_b128 v[228:231], v33 offset:12288
    v_mfma_f32_16x16x32_bf16 v[88:91], v[232:235], v[144:147], v[88:91]
    buffer_load_dwordx4 v[204:207], v30, s[8:11], s21 offen offset:2048 sc1
    v_mfma_f32_16x16x32_bf16 v[116:119], v[232:235], v[148:151], v[116:119]
    ds_read_b128 v[232:235], v33 offset:13312
    s_waitcnt vmcnt(13)
    s_waitcnt lgkmcnt(7)
    v_mfma_f32_16x16x32_bf16 v[64:67], v[34:37], v[152:155], v[64:67]
    v_mfma_f32_16x16x32_bf16 v[92:95], v[34:37], v[156:159], v[92:95]
    ds_read_b128 v[34:37], v33 offset:14336
    buffer_load_dwordx4 v[120:123], v30, s[8:11], s20 offen offset:3072 sc1
    v_mfma_f32_16x16x32_bf16 v[68:71], v[38:41], v[152:155], v[68:71]
    v_mfma_f32_16x16x32_bf16 v[96:99], v[38:41], v[156:159], v[96:99]
    ds_read_b128 v[38:41], v33 offset:15360
    v_mfma_f32_16x16x32_bf16 v[72:75], v[42:45], v[152:155], v[72:75]
    v_mfma_f32_16x16x32_bf16 v[100:103], v[42:45], v[156:159], v[100:103]
    buffer_load_dwordx4 v[124:127], v30, s[8:11], s21 offen offset:3072 sc1
    ds_read_b128 v[42:45], v33 offset:16384
    v_mfma_f32_16x16x32_bf16 v[76:79], v[46:49], v[152:155], v[76:79]
    v_mfma_f32_16x16x32_bf16 v[104:107], v[46:49], v[156:159], v[104:107]
    ds_read_b128 v[46:49], v33 offset:17408
    v_mfma_f32_16x16x32_bf16 v[80:83], v[50:53], v[152:155], v[80:83]
    v_mfma_f32_16x16x32_bf16 v[108:111], v[50:53], v[156:159], v[108:111]
    s_add_u32 s56, s56, 4096
    s_cmp_ge_u32 s56, 20480
    s_cselect_b32 s56, 0, s56
    s_add_u32 s20, s66, s56
    s_add_u32 s21, s20, 20480
    buffer_load_dwordx4 v[128:131], v30, s[8:11], s20 offen offset:0 sc1
    ds_read_b128 v[50:53], v33 offset:18432
    v_mfma_f32_16x16x32_bf16 v[84:87], v[54:57], v[152:155], v[84:87]
    v_mfma_f32_16x16x32_bf16 v[112:115], v[54:57], v[156:159], v[112:115]
    ds_read_b128 v[54:57], v33 offset:19456
    v_mfma_f32_16x16x32_bf16 v[88:91], v[58:61], v[152:155], v[88:91]
    buffer_load_dwordx4 v[132:135], v30, s[8:11], s21 offen offset:0 sc1
    v_mfma_f32_16x16x32_bf16 v[116:119], v[58:61], v[156:159], v[116:119]
    ds_read_b128 v[58:61], v33 offset:20480
    s_waitcnt vmcnt(14)
    s_waitcnt lgkmcnt(7)
    v_mfma_f32_16x16x32_bf16 v[64:67], v[208:211], v[160:163], v[64:67]
    v_mfma_f32_16x16x32_bf16 v[92:95], v[208:211], v[164:167], v[92:95]
    ds_read_b128 v[208:211], v33 offset:21504
    buffer_load_dwordx4 v[136:139], v30, s[8:11], s20 offen offset:1024 sc1
    v_mfma_f32_16x16x32_bf16 v[68:71], v[212:215], v[160:163], v[68:71]
    v_mfma_f32_16x16x32_bf16 v[96:99], v[212:215], v[164:167], v[96:99]
    ds_read_b128 v[212:215], v33 offset:22528
    v_mfma_f32_16x16x32_bf16 v[72:75], v[216:219], v[160:163], v[72:75]
    v_mfma_f32_16x16x32_bf16 v[100:103], v[216:219], v[164:167], v[100:103]
    buffer_load_dwordx4 v[140:143], v30, s[8:11], s21 offen offset:1024 sc1
    ds_read_b128 v[216:219], v33 offset:23552
    v_mfma_f32_16x16x32_bf16 v[76:79], v[220:223], v[160:163], v[76:79]
    v_mfma_f32_16x16x32_bf16 v[104:107], v[220:223], v[164:167], v[104:107]
    ds_read_b128 v[220:223], v33 offset:24576
    v_mfma_f32_16x16x32_bf16 v[80:83], v[224:227], v[160:163], v[80:83]
    v_mfma_f32_16x16x32_bf16 v[108:111], v[224:227], v[164:167], v[108:111]
    buffer_load_dwordx4 v[144:147], v30, s[8:11], s20 offen offset:2048 sc1
    ds_read_b128 v[224:227], v33 offset:25600
    v_mfma_f32_16x16x32_bf16 v[84:87], v[228:231], v[160:163], v[84:87]
    v_mfma_f32_16x16x32_bf16 v[112:115], v[228:231], v[164:167], v[112:115]
    ds_read_b128 v[228:231], v33 offset:26624
    v_mfma_f32_16x16x32_bf16 v[88:91], v[232:235], v[160:163], v[88:91]
    buffer_load_dwordx4 v[148:151], v30, s[8:11], s21 offen offset:2048 sc1
    v_mfma_f32_16x16x32_bf16 v[116:119], v[232:235], v[164:167], v[116:119]
    ds_read_b128 v[232:235], v33 offset:27648
    s_waitcnt vmcnt(16)
    s_waitcnt lgkmcnt(7)
    v_mfma_f32_16x16x32_bf16 v[64:67], v[34:37], v[168:171], v[64:67]
    v_mfma_f32_16x16x32_bf16 v[92:95], v[34:37], v[172:175], v[92:95]
    s_add_u32 s57, s57, 28672
    s_cmp_ge_u32 s57, 143360
    s_cselect_b32 s57, 0, s57
    v_add_u32 v33, s57, v30
    ds_read_b128 v[34:37], v33 offset:0
    buffer_load_dwordx4 v[152:155], v30, s[8:11], s20 offen offset:3072 sc1
    v_mfma_f32_16x16x32_bf16 v[68:71], v[38:41], v[168:171], v[68:71]
    v_mfma_f32_16x16x32_bf16 v[96:99], v[38:41], v[172:175], v[96:99]
    ds_read_b128 v[38:41], v33 offset:1024
    v_mfma_f32_16x16x32_bf16 v[72:75], v[42:45], v[168:171], v[72:75]
    v_mfma_f32_16x16x32_bf16 v[100:103], v[42:45], v[172:175], v[100:103]
    buffer_load_dwordx4 v[156:159], v30, s[8:11], s21 offen offset:3072 sc1
    ds_read_b128 v[42:45], v33 offset:2048
    v_mfma_f32_16x16x32_bf16 v[76:79], v[46:49], v[168:171], v[76:79]
    v_mfma_f32_16x16x32_bf16 v[104:107], v[46:49], v[172:175], v[104:107]
    ds_read_b128 v[46:49], v33 offset:3072
    v_mfma_f32_16x16x32_bf16 v[80:83], v[50:53], v[168:171], v[80:83]
    v_mfma_f32_16x16x32_bf16 v[108:111], v[50:53], v[172:175], v[108:111]
    s_add_u32 s56, s56, 4096
    s_cmp_ge_u32 s56, 20480
    s_cselect_b32 s56, 0, s56
    s_add_u32 s20, s66, s56
    s_add_u32 s21, s20, 20480
    buffer_load_dwordx4 v[160:163], v30, s[8:11], s20 offen offset:0 sc1
    ds_read_b128 v[50:53], v33 offset:4096
    v_mfma_f32_16x16x32_bf16 v[84:87], v[54:57], v[168:171], v[84:87]
    v_mfma_f32_16x16x32_bf16 v[112:115], v[54:57], v[172:175], v[112:115]
    ds_read_b128 v[54:57], v33 offset:5120
    v_mfma_f32_16x16x32_bf16 v[88:91], v[58:61], v[168:171], v[88:91]
    buffer_load_dwordx4 v[164:167], v30, s[8:11], s21 offen offset:0 sc1
    v_mfma_f32_16x16x32_bf16 v[116:119], v[58:61], v[172:175], v[116:119]
    ds_read_b128 v[58:61], v33 offset:6144
    s_waitcnt vmcnt(18)
    s_waitcnt lgkmcnt(7)
    v_mfma_f32_16x16x32_bf16 v[64:67], v[208:211], v[176:179], v[64:67]
    v_mfma_f32_16x16x32_bf16 v[92:95], v[208:211], v[180:183], v[92:95]
    ds_read_b128 v[208:211], v33 offset:7168
    v_mfma_f32_16x16x32_bf16 v[68:71], v[212:215], v[176:179], v[68:71]
    v_mfma_f32_16x16x32_bf16 v[96:99], v[212:215], v[180:183], v[96:99]
    ds_read_b128 v[212:215], v33 offset:8192
    buffer_load_dwordx4 v[168:171], v30, s[8:11], s20 offen offset:1024 sc1
    v_mfma_f32_16x16x32_bf16 v[72:75], v[216:219], v[176:179], v[72:75]
    v_mfma_f32_16x16x32_bf16 v[100:103], v[216:219], v[180:183], v[100:103]
    ds_read_b128 v[216:219], v33 offset:9216
    v_mfma_f32_16x16x32_bf16 v[76:79], v[220:223], v[176:179], v[76:79]
    v_mfma_f32_16x16x32_bf16 v[104:107], v[220:223], v[180:183], v[104:107]
    ds_read_b128 v[220:223], v33 offset:10240
    v_mfma_f32_16x16x32_bf16 v[80:83], v[224:227], v[176:179], v[80:83]
    v_mfma_f32_16x16x32_bf16 v[108:111], v[224:227], v[180:183], v[108:111]
    ds_read_b128 v[224:227], v33 offset:11264
    v_mfma_f32_16x16x32_bf16 v[84:87], v[228:231], v[176:179], v[84:87]
    buffer_load_dwordx4 v[172:175], v30, s[8:11], s21 offen offset:1024 sc1
    v_mfma_f32_16x16x32_bf16 v[112:115], v[228:231], v[180:183], v[112:115]
    ds_read_b128 v[228:231], v33 offset:12288
    v_mfma_f32_16x16x32_bf16 v[88:91], v[232:235], v[176:179], v[88:91]
    v_mfma_f32_16x16x32_bf16 v[116:119], v[232:235], v[180:183], v[116:119]
    ds_read_b128 v[232:235], v33 offset:13312
    s_waitcnt vmcnt(18)
    s_waitcnt lgkmcnt(7)
    s_barrier
    v_mfma_f32_16x16x32_bf16 v[64:67], v[34:37], v[184:187], v[64:67]
    v_mfma_f32_16x16x32_bf16 v[92:95], v[34:37], v[188:191], v[92:95]
    ds_read_b128 v[34:37], v33 offset:14336
    v_mfma_f32_16x16x32_bf16 v[68:71], v[38:41], v[184:187], v[68:71]
    v_mfma_f32_16x16x32_bf16 v[96:99], v[38:41], v[188:191], v[96:99]
    buffer_load_dwordx4 v[176:179], v30, s[8:11], s20 offen offset:2048 sc1
    ds_read_b128 v[38:41], v33 offset:15360
    v_mfma_f32_16x16x32_bf16 v[72:75], v[42:45], v[184:187], v[72:75]
    v_mfma_f32_16x16x32_bf16 v[100:103], v[42:45], v[188:191], v[100:103]
    ds_read_b128 v[42:45], v33 offset:16384
    v_mfma_f32_16x16x32_bf16 v[76:79], v[46:49], v[184:187], v[76:79]
    v_mfma_f32_16x16x32_bf16 v[104:107], v[46:49], v[188:191], v[104:107]
    ds_read_b128 v[46:49], v33 offset:17408
    v_mfma_f32_16x16x32_bf16 v[80:83], v[50:53], v[184:187], v[80:83]
    v_mfma_f32_16x16x32_bf16 v[108:111], v[50:53], v[188:191], v[108:111]
    ds_read_b128 v[50:53], v33 offset:18432
    v_mfma_f32_16x16x32_bf16 v[84:87], v[54:57], v[184:187], v[84:87]
    buffer_load_dwordx4 v[180:183], v30, s[8:11], s21 offen offset:2048 sc1
    v_mfma_f32_16x16x32_bf16 v[112:115], v[54:57], v[188:191], v[112:115]
    ds_read_b128 v[54:57], v33 offset:19456
    v_mfma_f32_16x16x32_bf16 v[88:91], v[58:61], v[184:187], v[88:91]
    v_mfma_f32_16x16x32_bf16 v[116:119], v[58:61], v[188:191], v[116:119]
    ds_read_b128 v[58:61], v33 offset:20480
    s_waitcnt vmcnt(18)
    s_waitcnt lgkmcnt(7)
    v_mfma_f32_16x16x32_bf16 v[64:67], v[208:211], v[192:195], v[64:67]
    v_mfma_f32_16x16x32_bf16 v[92:95], v[208:211], v[196:199], v[92:95]
    ds_read_b128 v[208:211], v33 offset:21504
    v_mfma_f32_16x16x32_bf16 v[68:71], v[212:215], v[192:195], v[68:71]
    v_mfma_f32_16x16x32_bf16 v[96:99], v[212:215], v[196:199], v[96:99]
    ds_read_b128 v[212:215], v33 offset:22528
    buffer_load_dwordx4 v[184:187], v30, s[8:11], s20 offen offset:3072 sc1
    v_mfma_f32_16x16x32_bf16 v[72:75], v[216:219], v[192:195], v[72:75]
    v_mfma_f32_16x16x32_bf16 v[100:103], v[216:219], v[196:199], v[100:103]
    ds_read_b128 v[216:219], v33 offset:23552
    v_mfma_f32_16x16x32_bf16 v[76:79], v[220:223], v[192:195], v[76:79]
    v_mfma_f32_16x16x32_bf16 v[104:107], v[220:223], v[196:199], v[104:107]
    ds_read_b128 v[220:223], v33 offset:24576
    v_mfma_f32_16x16x32_bf16 v[80:83], v[224:227], v[192:195], v[80:83]
    v_mfma_f32_16x16x32_bf16 v[108:111], v[224:227], v[196:199], v[108:111]
    ds_read_b128 v[224:227], v33 offset:25600
    v_mfma_f32_16x16x32_bf16 v[84:87], v[228:231], v[192:195], v[84:87]
    buffer_load_dwordx4 v[188:191], v30, s[8:11], s21 offen offset:3072 sc1
    v_mfma_f32_16x16x32_bf16 v[112:115], v[228:231], v[196:199], v[112:115]
    ds_read_b128 v[228:231], v33 offset:26624
    v_mfma_f32_16x16x32_bf16 v[88:91], v[232:235], v[192:195], v[88:91]
    v_mfma_f32_16x16x32_bf16 v[116:119], v[232:235], v[196:199], v[116:119]
    ds_read_b128 v[232:235], v33 offset:27648
    s_waitcnt vmcnt(18)
    s_waitcnt lgkmcnt(7)
    v_mfma_f32_16x16x32_bf16 v[64:67], v[34:37], v[200:203], v[64:67]
    v_mfma_f32_16x16x32_bf16 v[92:95], v[34:37], v[204:207], v[92:95]
    s_add_u32 s57, s57, 28672
    s_cmp_ge_u32 s57, 143360
    s_cselect_b32 s57, 0, s57
    v_add_u32 v33, s57, v30
    ds_read_b128 v[34:37], v33 offset:0
    v_mfma_f32_16x16x32_bf16 v[68:71], v[38:41], v[200:203], v[68:71]
    v_mfma_f32_16x16x32_bf16 v[96:99], v[38:41], v[204:207], v[96:99]
    ds_read_b128 v[38:41], v33 offset:1024
    v_mfma_f32_16x16x32_bf16 v[72:75], v[42:45], v[200:203], v[72:75]
    v_mfma_f32_16x16x32_bf16 v[100:103], v[42:45], v[204:207], v[100:103]
    ds_read_b128 v[42:45], v33 offset:2048
    v_mfma_f32_16x16x32_bf16 v[76:79], v[46:49], v[200:203], v[76:79]
    v_mfma_f32_16x16x32_bf16 v[104:107], v[46:49], v[204:207], v[104:107]
    ds_read_b128 v[46:49], v33 offset:3072
    v_mfma_f32_16x16x32_bf16 v[80:83], v[50:53], v[200:203], v[80:83]
    v_mfma_f32_16x16x32_bf16 v[108:111], v[50:53], v[204:207], v[108:111]
    ds_read_b128 v[50:53], v33 offset:4096
    v_mfma_f32_16x16x32_bf16 v[84:87], v[54:57], v[200:203], v[84:87]
    v_mfma_f32_16x16x32_bf16 v[112:115], v[54:57], v[204:207], v[112:115]
    ds_read_b128 v[54:57], v33 offset:5120
    v_mfma_f32_16x16x32_bf16 v[88:91], v[58:61], v[200:203], v[88:91]
    v_mfma_f32_16x16x32_bf16 v[116:119], v[58:61], v[204:207], v[116:119]
    ds_read_b128 v[58:61], v33 offset:6144
    s_waitcnt vmcnt(16)
    s_waitcnt lgkmcnt(7)
    v_mfma_f32_16x16x32_bf16 v[64:67], v[208:211], v[120:123], v[64:67]
    v_mfma_f32_16x16x32_bf16 v[92:95], v[208:211], v[124:127], v[92:95]
    ds_read_b128 v[208:211], v33 offset:7168
    v_mfma_f32_16x16x32_bf16 v[68:71], v[212:215], v[120:123], v[68:71]
    v_mfma_f32_16x16x32_bf16 v[96:99], v[212:215], v[124:127], v[96:99]
    ds_read_b128 v[212:215], v33 offset:8192
    v_mfma_f32_16x16x32_bf16 v[72:75], v[216:219], v[120:123], v[72:75]
    v_mfma_f32_16x16x32_bf16 v[100:103], v[216:219], v[124:127], v[100:103]
    ds_read_b128 v[216:219], v33 offset:9216
    v_mfma_f32_16x16x32_bf16 v[76:79], v[220:223], v[120:123], v[76:79]
    v_mfma_f32_16x16x32_bf16 v[104:107], v[220:223], v[124:127], v[104:107]
    ds_read_b128 v[220:223], v33 offset:10240
    v_mfma_f32_16x16x32_bf16 v[80:83], v[224:227], v[120:123], v[80:83]
    v_mfma_f32_16x16x32_bf16 v[108:111], v[224:227], v[124:127], v[108:111]
    ds_read_b128 v[224:227], v33 offset:11264
    v_mfma_f32_16x16x32_bf16 v[84:87], v[228:231], v[120:123], v[84:87]
    v_mfma_f32_16x16x32_bf16 v[112:115], v[228:231], v[124:127], v[112:115]
    ds_read_b128 v[228:231], v33 offset:12288
    v_mfma_f32_16x16x32_bf16 v[88:91], v[232:235], v[120:123], v[88:91]
    v_mfma_f32_16x16x32_bf16 v[116:119], v[232:235], v[124:127], v[116:119]
    ds_read_b128 v[232:235], v33 offset:13312
    s_waitcnt vmcnt(14)
    s_waitcnt lgkmcnt(7)
    v_mfma_f32_16x16x32_bf16 v[64:67], v[34:37], v[128:131], v[64:67]
    v_mfma_f32_16x16x32_bf16 v[92:95], v[34:37], v[132:135], v[92:95]
    ds_read_b128 v[34:37], v33 offset:14336
    v_mfma_f32_16x16x32_bf16 v[68:71], v[38:41], v[128:131], v[68:71]
    v_mfma_f32_16x16x32_bf16 v[96:99], v[38:41], v[132:135], v[96:99]
    ds_read_b128 v[38:41], v33 offset:15360
    v_mfma_f32_16x16x32_bf16 v[72:75], v[42:45], v[128:131], v[72:75]
    v_mfma_f32_16x16x32_bf16 v[100:103], v[42:45], v[132:135], v[100:103]
    ds_read_b128 v[42:45], v33 offset:16384
    v_mfma_f32_16x16x32_bf16 v[76:79], v[46:49], v[128:131], v[76:79]
    v_mfma_f32_16x16x32_bf16 v[104:107], v[46:49], v[132:135], v[104:107]
    ds_read_b128 v[46:49], v33 offset:17408
    v_mfma_f32_16x16x32_bf16 v[80:83], v[50:53], v[128:131], v[80:83]
    v_mfma_f32_16x16x32_bf16 v[108:111], v[50:53], v[132:135], v[108:111]
    ds_read_b128 v[50:53], v33 offset:18432
    v_mfma_f32_16x16x32_bf16 v[84:87], v[54:57], v[128:131], v[84:87]
    v_mfma_f32_16x16x32_bf16 v[112:115], v[54:57], v[132:135], v[112:115]
    ds_read_b128 v[54:57], v33 offset:19456
    v_mfma_f32_16x16x32_bf16 v[88:91], v[58:61], v[128:131], v[88:91]
    v_mfma_f32_16x16x32_bf16 v[116:119], v[58:61], v[132:135], v[116:119]
    ds_read_b128 v[58:61], v33 offset:20480
    v_pk_add_f32 v[12:13], v[12:13], v[14:15]
    v_mov_b32 v14, v12
    v_mov_b32 v15, v13
    s_nop 1
    v_permlane32_swap_b32 v14, v12
    v_permlane32_swap_b32 v15, v13
    v_pk_add_f32 v[12:13], v[12:13], v[14:15]
    v_mov_b32 v14, v12
    v_mov_b32 v15, v13
    s_nop 1
    v_permlane16_swap_b32 v14, v12
    v_permlane16_swap_b32 v15, v13
    v_pk_add_f32 v[12:13], v[12:13], v[14:15]
    v_pk_add_f32 v[16:17], v[16:17], v[18:19]
    v_mov_b32 v18, v16
    v_mov_b32 v19, v17
    s_nop 1
    v_permlane32_swap_b32 v18, v16
    v_permlane32_swap_b32 v19, v17
    v_pk_add_f32 v[16:17], v[16:17], v[18:19]
    v_mov_b32 v18, v16
    v_mov_b32 v19, v17
    s_nop 1
    v_permlane16_swap_b32 v18, v16
    v_permlane16_swap_b32 v19, v17
    v_pk_add_f32 v[16:17], v[16:17], v[18:19]
    s_mov_b32 s70, 0x3acccccd
    s_mov_b32 s71, 0x3727c5ac
    v_mul_f32 v12, s70, v12
    v_mul_f32 v13, s70, v13
    v_fma_f32 v13, -v12, v12, v13
    v_max_f32 v13, 0, v13
    v_add_f32 v13, s71, v13
    v_rsq_f32 v13, v13
    v_mul_f32 v16, s70, v16
    v_mul_f32 v17, s70, v17
    v_fma_f32 v17, -v16, v16, v17
    v_max_f32 v17, 0, v17
    v_add_f32 v17, s71, v17
    v_rsq_f32 v17, v17
    s_waitcnt vmcnt(12)
    s_waitcnt lgkmcnt(7)
    v_mfma_f32_16x16x32_bf16 v[64:67], v[208:211], v[136:139], v[64:67]
    v_mfma_f32_16x16x32_bf16 v[92:95], v[208:211], v[140:143], v[92:95]
    ds_read_b128 v[208:211], v33 offset:21504
    v_mfma_f32_16x16x32_bf16 v[68:71], v[212:215], v[136:139], v[68:71]
    v_mfma_f32_16x16x32_bf16 v[96:99], v[212:215], v[140:143], v[96:99]
    ds_read_b128 v[212:215], v33 offset:22528
    v_mfma_f32_16x16x32_bf16 v[72:75], v[216:219], v[136:139], v[72:75]
    v_mfma_f32_16x16x32_bf16 v[100:103], v[216:219], v[140:143], v[100:103]
    ds_read_b128 v[216:219], v33 offset:23552
    v_mfma_f32_16x16x32_bf16 v[76:79], v[220:223], v[136:139], v[76:79]
    v_mfma_f32_16x16x32_bf16 v[104:107], v[220:223], v[140:143], v[104:107]
    ds_read_b128 v[220:223], v33 offset:24576
    v_mfma_f32_16x16x32_bf16 v[80:83], v[224:227], v[136:139], v[80:83]
    v_mfma_f32_16x16x32_bf16 v[108:111], v[224:227], v[140:143], v[108:111]
    ds_read_b128 v[224:227], v33 offset:25600
    v_mfma_f32_16x16x32_bf16 v[84:87], v[228:231], v[136:139], v[84:87]
    v_mfma_f32_16x16x32_bf16 v[112:115], v[228:231], v[140:143], v[112:115]
    ds_read_b128 v[228:231], v33 offset:26624
    v_mfma_f32_16x16x32_bf16 v[88:91], v[232:235], v[136:139], v[88:91]
    v_mfma_f32_16x16x32_bf16 v[116:119], v[232:235], v[140:143], v[116:119]
    ds_read_b128 v[232:235], v33 offset:27648
    s_waitcnt vmcnt(10)
    s_waitcnt lgkmcnt(7)
    v_mfma_f32_16x16x32_bf16 v[64:67], v[34:37], v[144:147], v[64:67]
    v_mfma_f32_16x16x32_bf16 v[92:95], v[34:37], v[148:151], v[92:95]
    s_add_u32 s57, s57, 28672
    s_cmp_ge_u32 s57, 143360
    s_cselect_b32 s57, 0, s57
    v_add_u32 v33, s57, v30
    ds_read_b128 v[34:37], v33 offset:0
    v_mfma_f32_16x16x32_bf16 v[68:71], v[38:41], v[144:147], v[68:71]
    v_mfma_f32_16x16x32_bf16 v[96:99], v[38:41], v[148:151], v[96:99]
    ds_read_b128 v[38:41], v33 offset:1024
    v_mfma_f32_16x16x32_bf16 v[72:75], v[42:45], v[144:147], v[72:75]
    v_mfma_f32_16x16x32_bf16 v[100:103], v[42:45], v[148:151], v[100:103]
    ds_read_b128 v[42:45], v33 offset:2048
    v_mfma_f32_16x16x32_bf16 v[76:79], v[46:49], v[144:147], v[76:79]
    v_mfma_f32_16x16x32_bf16 v[104:107], v[46:49], v[148:151], v[104:107]
    ds_read_b128 v[46:49], v33 offset:3072
    v_mfma_f32_16x16x32_bf16 v[80:83], v[50:53], v[144:147], v[80:83]
    v_mfma_f32_16x16x32_bf16 v[108:111], v[50:53], v[148:151], v[108:111]
    ds_read_b128 v[50:53], v33 offset:4096
    v_mfma_f32_16x16x32_bf16 v[84:87], v[54:57], v[144:147], v[84:87]
    v_mfma_f32_16x16x32_bf16 v[112:115], v[54:57], v[148:151], v[112:115]
    ds_read_b128 v[54:57], v33 offset:5120
    v_mfma_f32_16x16x32_bf16 v[88:91], v[58:61], v[144:147], v[88:91]
    v_mfma_f32_16x16x32_bf16 v[116:119], v[58:61], v[148:151], v[116:119]
    ds_read_b128 v[58:61], v33 offset:6144
    s_waitcnt vmcnt(8)
    s_waitcnt lgkmcnt(7)
    v_mfma_f32_16x16x32_bf16 v[64:67], v[208:211], v[152:155], v[64:67]
    v_mfma_f32_16x16x32_bf16 v[92:95], v[208:211], v[156:159], v[92:95]
    ds_read_b128 v[208:211], v33 offset:7168
    v_mfma_f32_16x16x32_bf16 v[68:71], v[212:215], v[152:155], v[68:71]
    v_mfma_f32_16x16x32_bf16 v[96:99], v[212:215], v[156:159], v[96:99]
    ds_read_b128 v[212:215], v33 offset:8192
    v_mfma_f32_16x16x32_bf16 v[72:75], v[216:219], v[152:155], v[72:75]
    v_mfma_f32_16x16x32_bf16 v[100:103], v[216:219], v[156:159], v[100:103]
    ds_read_b128 v[216:219], v33 offset:9216
    v_mfma_f32_16x16x32_bf16 v[76:79], v[220:223], v[152:155], v[76:79]
    v_mfma_f32_16x16x32_bf16 v[104:107], v[220:223], v[156:159], v[104:107]
    ds_read_b128 v[220:223], v33 offset:10240
    v_mfma_f32_16x16x32_bf16 v[80:83], v[224:227], v[152:155], v[80:83]
    v_mfma_f32_16x16x32_bf16 v[108:111], v[224:227], v[156:159], v[108:111]
    ds_read_b128 v[224:227], v33 offset:11264
    v_mfma_f32_16x16x32_bf16 v[84:87], v[228:231], v[152:155], v[84:87]
    v_mfma_f32_16x16x32_bf16 v[112:115], v[228:231], v[156:159], v[112:115]
    ds_read_b128 v[228:231], v33 offset:12288
    v_mfma_f32_16x16x32_bf16 v[88:91], v[232:235], v[152:155], v[88:91]
    v_mfma_f32_16x16x32_bf16 v[116:119], v[232:235], v[156:159], v[116:119]
    ds_read_b128 v[232:235], v33 offset:13312
    s_waitcnt vmcnt(6)
    s_waitcnt lgkmcnt(7)
    v_mfma_f32_16x16x32_bf16 v[64:67], v[34:37], v[160:163], v[64:67]
    v_mfma_f32_16x16x32_bf16 v[92:95], v[34:37], v[164:167], v[92:95]
    ds_read_b128 v[34:37], v33 offset:14336
    v_mfma_f32_16x16x32_bf16 v[68:71], v[38:41], v[160:163], v[68:71]
    v_mfma_f32_16x16x32_bf16 v[96:99], v[38:41], v[164:167], v[96:99]
    ds_read_b128 v[38:41], v33 offset:15360
    v_mfma_f32_16x16x32_bf16 v[72:75], v[42:45], v[160:163], v[72:75]
    v_mfma_f32_16x16x32_bf16 v[100:103], v[42:45], v[164:167], v[100:103]
    ds_read_b128 v[42:45], v33 offset:16384
    v_mfma_f32_16x16x32_bf16 v[76:79], v[46:49], v[160:163], v[76:79]
    v_mfma_f32_16x16x32_bf16 v[104:107], v[46:49], v[164:167], v[104:107]
    ds_read_b128 v[46:49], v33 offset:17408
    v_mfma_f32_16x16x32_bf16 v[80:83], v[50:53], v[160:163], v[80:83]
    v_mfma_f32_16x16x32_bf16 v[108:111], v[50:53], v[164:167], v[108:111]
    ds_read_b128 v[50:53], v33 offset:18432
    v_mfma_f32_16x16x32_bf16 v[84:87], v[54:57], v[160:163], v[84:87]
    v_mfma_f32_16x16x32_bf16 v[112:115], v[54:57], v[164:167], v[112:115]
    ds_read_b128 v[54:57], v33 offset:19456
    v_mfma_f32_16x16x32_bf16 v[88:91], v[58:61], v[160:163], v[88:91]
    v_mfma_f32_16x16x32_bf16 v[116:119], v[58:61], v[164:167], v[116:119]
    ds_read_b128 v[58:61], v33 offset:20480
    s_waitcnt vmcnt(4)
    s_waitcnt lgkmcnt(7)
    v_mfma_f32_16x16x32_bf16 v[64:67], v[208:211], v[168:171], v[64:67]
    v_mfma_f32_16x16x32_bf16 v[92:95], v[208:211], v[172:175], v[92:95]
    ds_read_b128 v[208:211], v33 offset:21504
    v_mfma_f32_16x16x32_bf16 v[68:71], v[212:215], v[168:171], v[68:71]
    v_mfma_f32_16x16x32_bf16 v[96:99], v[212:215], v[172:175], v[96:99]
    ds_read_b128 v[212:215], v33 offset:22528
    v_mfma_f32_16x16x32_bf16 v[72:75], v[216:219], v[168:171], v[72:75]
    v_mfma_f32_16x16x32_bf16 v[100:103], v[216:219], v[172:175], v[100:103]
    ds_read_b128 v[216:219], v33 offset:23552
    v_mfma_f32_16x16x32_bf16 v[76:79], v[220:223], v[168:171], v[76:79]
    v_mfma_f32_16x16x32_bf16 v[104:107], v[220:223], v[172:175], v[104:107]
    ds_read_b128 v[220:223], v33 offset:24576
    v_mfma_f32_16x16x32_bf16 v[80:83], v[224:227], v[168:171], v[80:83]
    v_mfma_f32_16x16x32_bf16 v[108:111], v[224:227], v[172:175], v[108:111]
    ds_read_b128 v[224:227], v33 offset:25600
    v_mfma_f32_16x16x32_bf16 v[84:87], v[228:231], v[168:171], v[84:87]
    v_mfma_f32_16x16x32_bf16 v[112:115], v[228:231], v[172:175], v[112:115]
    ds_read_b128 v[228:231], v33 offset:26624
    v_mfma_f32_16x16x32_bf16 v[88:91], v[232:235], v[168:171], v[88:91]
    v_mfma_f32_16x16x32_bf16 v[116:119], v[232:235], v[172:175], v[116:119]
    ds_read_b128 v[232:235], v33 offset:27648
    s_waitcnt vmcnt(2)
    s_waitcnt lgkmcnt(7)
    v_mfma_f32_16x16x32_bf16 v[64:67], v[34:37], v[176:179], v[64:67]
    v_mfma_f32_16x16x32_bf16 v[92:95], v[34:37], v[180:183], v[92:95]
    v_mfma_f32_16x16x32_bf16 v[68:71], v[38:41], v[176:179], v[68:71]
    v_mfma_f32_16x16x32_bf16 v[96:99], v[38:41], v[180:183], v[96:99]
    v_mfma_f32_16x16x32_bf16 v[72:75], v[42:45], v[176:179], v[72:75]
    v_mfma_f32_16x16x32_bf16 v[100:103], v[42:45], v[180:183], v[100:103]
    v_mfma_f32_16x16x32_bf16 v[76:79], v[46:49], v[176:179], v[76:79]
    v_mfma_f32_16x16x32_bf16 v[104:107], v[46:49], v[180:183], v[104:107]
    v_mfma_f32_16x16x32_bf16 v[80:83], v[50:53], v[176:179], v[80:83]
    v_mfma_f32_16x16x32_bf16 v[108:111], v[50:53], v[180:183], v[108:111]
    v_mfma_f32_16x16x32_bf16 v[84:87], v[54:57], v[176:179], v[84:87]
    v_mfma_f32_16x16x32_bf16 v[112:115], v[54:57], v[180:183], v[112:115]
    v_mfma_f32_16x16x32_bf16 v[88:91], v[58:61], v[176:179], v[88:91]
    v_mfma_f32_16x16x32_bf16 v[116:119], v[58:61], v[180:183], v[116:119]
    s_waitcnt vmcnt(0)
    s_waitcnt lgkmcnt(0)
    v_mfma_f32_16x16x32_bf16 v[64:67], v[208:211], v[184:187], v[64:67]
    v_mfma_f32_16x16x32_bf16 v[92:95], v[208:211], v[188:191], v[92:95]
    v_mfma_f32_16x16x32_bf16 v[68:71], v[212:215], v[184:187], v[68:71]
    v_mfma_f32_16x16x32_bf16 v[96:99], v[212:215], v[188:191], v[96:99]
    v_mfma_f32_16x16x32_bf16 v[72:75], v[216:219], v[184:187], v[72:75]
    v_mfma_f32_16x16x32_bf16 v[100:103], v[216:219], v[188:191], v[100:103]
    v_mfma_f32_16x16x32_bf16 v[76:79], v[220:223], v[184:187], v[76:79]
    v_mfma_f32_16x16x32_bf16 v[104:107], v[220:223], v[188:191], v[104:107]
    v_mfma_f32_16x16x32_bf16 v[80:83], v[224:227], v[184:187], v[80:83]
    v_mfma_f32_16x16x32_bf16 v[108:111], v[224:227], v[188:191], v[108:111]
    v_mfma_f32_16x16x32_bf16 v[84:87], v[228:231], v[184:187], v[84:87]
    v_mfma_f32_16x16x32_bf16 v[112:115], v[228:231], v[188:191], v[112:115]
    v_mfma_f32_16x16x32_bf16 v[88:91], v[232:235], v[184:187], v[88:91]
    v_mfma_f32_16x16x32_bf16 v[116:119], v[232:235], v[188:191], v[116:119]
    v_lshlrev_b32 v6, 4, v5
    v_add_u32 v6, 151040, v6
    ds_read_b128 v[208:211], v6 offset:0
    ds_read_b128 v[212:215], v6 offset:64
    ds_read_b128 v[216:219], v6 offset:128
    ds_read_b128 v[220:223], v6 offset:192
    ds_read_b128 v[224:227], v6 offset:256
    ds_read_b128 v[228:231], v6 offset:320
    ds_read_b128 v[232:235], v6 offset:384
    s_barrier
    s_add_u32 s68, s64, 0xc80000
    s_mov_b32 s3, 0
    s_lshl_b32 s56, s3, 12
    s_mul_i32 s57, s3, 20480
    s_lshr_b32 s58, s39, 1
    s_and_b32 s59, s39, 1
    s_lshr_b32 s3, s65, 4
    s_mul_i32 s66, s3, 57344
    s_mul_i32 s3, s58, 7168
    s_add_u32 s66, s66, s3
    s_add_u32 s66, s66, 0xf00000
    s_lshl_b32 s3, s59, 9
    s_add_u32 s67, s66, s3
    s_add_u32 s67, s67, 3072
    s_lshl_b32 s3, s59, 12
    s_add_u32 s66, s66, s3
    v_mov_b32 v44, 0xc0135761
    v_mov_b32 v45, v44
    s_mov_b32 s54, 0xbdd2d3e8
    s_mov_b32 s55, s54
    s_waitcnt lgkmcnt(0)
    v_pk_fma_f32 v[64:65], v[208:209], v[12:13], v[64:65] op_sel_hi:[1,0,1] neg_lo:[1,0,0] neg_hi:[1,0,0]
    v_pk_fma_f32 v[66:67], v[210:211], v[12:13], v[66:67] op_sel_hi:[1,0,1] neg_lo:[1,0,0] neg_hi:[1,0,0]
    v_pk_fma_f32 v[68:69], v[212:213], v[12:13], v[68:69] op_sel_hi:[1,0,1] neg_lo:[1,0,0] neg_hi:[1,0,0]
    v_pk_fma_f32 v[70:71], v[214:215], v[12:13], v[70:71] op_sel_hi:[1,0,1] neg_lo:[1,0,0] neg_hi:[1,0,0]
    v_pk_fma_f32 v[72:73], v[216:217], v[12:13], v[72:73] op_sel_hi:[1,0,1] neg_lo:[1,0,0] neg_hi:[1,0,0]
    v_pk_fma_f32 v[74:75], v[218:219], v[12:13], v[74:75] op_sel_hi:[1,0,1] neg_lo:[1,0,0] neg_hi:[1,0,0]
    v_pk_fma_f32 v[76:77], v[220:221], v[12:13], v[76:77] op_sel_hi:[1,0,1] neg_lo:[1,0,0] neg_hi:[1,0,0]
    v_pk_fma_f32 v[78:79], v[222:223], v[12:13], v[78:79] op_sel_hi:[1,0,1] neg_lo:[1,0,0] neg_hi:[1,0,0]
    v_pk_fma_f32 v[80:81], v[224:225], v[12:13], v[80:81] op_sel_hi:[1,0,1] neg_lo:[1,0,0] neg_hi:[1,0,0]
    v_pk_fma_f32 v[82:83], v[226:227], v[12:13], v[82:83] op_sel_hi:[1,0,1] neg_lo:[1,0,0] neg_hi:[1,0,0]
    v_pk_fma_f32 v[84:85], v[228:229], v[12:13], v[84:85] op_sel_hi:[1,0,1] neg_lo:[1,0,0] neg_hi:[1,0,0]
    v_pk_fma_f32 v[86:87], v[230:231], v[12:13], v[86:87] op_sel_hi:[1,0,1] neg_lo:[1,0,0] neg_hi:[1,0,0]
    v_pk_fma_f32 v[88:89], v[232:233], v[12:13], v[88:89] op_sel_hi:[1,0,1] neg_lo:[1,0,0] neg_hi:[1,0,0]
    v_pk_fma_f32 v[90:91], v[234:235], v[12:13], v[90:91] op_sel_hi:[1,0,1] neg_lo:[1,0,0] neg_hi:[1,0,0]
    v_pk_mul_f32 v[64:65], v[64:65], v[12:13] op_sel:[0,1] op_sel_hi:[1,1]
    v_pk_mul_f32 v[66:67], v[66:67], v[12:13] op_sel:[0,1] op_sel_hi:[1,1]
    v_pk_mul_f32 v[68:69], v[68:69], v[12:13] op_sel:[0,1] op_sel_hi:[1,1]
    v_pk_mul_f32 v[70:71], v[70:71], v[12:13] op_sel:[0,1] op_sel_hi:[1,1]
    v_pk_mul_f32 v[72:73], v[72:73], v[12:13] op_sel:[0,1] op_sel_hi:[1,1]
    v_pk_mul_f32 v[74:75], v[74:75], v[12:13] op_sel:[0,1] op_sel_hi:[1,1]
    v_pk_mul_f32 v[76:77], v[76:77], v[12:13] op_sel:[0,1] op_sel_hi:[1,1]
    v_pk_mul_f32 v[78:79], v[78:79], v[12:13] op_sel:[0,1] op_sel_hi:[1,1]
    v_pk_mul_f32 v[80:81], v[80:81], v[12:13] op_sel:[0,1] op_sel_hi:[1,1]
    v_pk_mul_f32 v[82:83], v[82:83], v[12:13] op_sel:[0,1] op_sel_hi:[1,1]
    v_pk_mul_f32 v[84:85], v[84:85], v[12:13] op_sel:[0,1] op_sel_hi:[1,1]
    v_pk_mul_f32 v[86:87], v[86:87], v[12:13] op_sel:[0,1] op_sel_hi:[1,1]
    v_pk_mul_f32 v[88:89], v[88:89], v[12:13] op_sel:[0,1] op_sel_hi:[1,1]
    v_pk_mul_f32 v[90:91], v[90:91], v[12:13] op_sel:[0,1] op_sel_hi:[1,1]
    v_pk_mul_f32 v[36:37], v[64:65], v[64:65]
    v_pk_mul_f32 v[38:39], v[66:67], v[66:67]
    v_pk_mul_f32 v[40:41], v[68:69], v[68:69]
    v_pk_mul_f32 v[42:43], v[70:71], v[70:71]
    v_pk_fma_f32 v[36:37], v[36:37], s[54:55], v[44:45]
    v_pk_fma_f32 v[38:39], v[38:39], s[54:55], v[44:45]
    v_pk_fma_f32 v[40:41], v[40:41], s[54:55], v[44:45]
    v_pk_fma_f32 v[42:43], v[42:43], s[54:55], v[44:45]
    v_pk_mul_f32 v[36:37], v[36:37], v[64:65]
    v_pk_mul_f32 v[38:39], v[38:39], v[66:67]
    v_pk_mul_f32 v[40:41], v[40:41], v[68:69]
    v_pk_mul_f32 v[42:43], v[42:43], v[70:71]
    v_exp_f32 v36, v36
    v_exp_f32 v37, v37
    v_exp_f32 v38, v38
    v_exp_f32 v39, v39
    v_exp_f32 v40, v40
    v_exp_f32 v41, v41
    v_exp_f32 v42, v42
    v_exp_f32 v43, v43
    v_pk_add_f32 v[36:37], v[36:37], 1.0 op_sel_hi:[1,0]
    v_pk_add_f32 v[38:39], v[38:39], 1.0 op_sel_hi:[1,0]
    v_pk_add_f32 v[40:41], v[40:41], 1.0 op_sel_hi:[1,0]
    v_pk_add_f32 v[42:43], v[42:43], 1.0 op_sel_hi:[1,0]
    v_rcp_f32 v36, v36
    v_rcp_f32 v37, v37
    v_rcp_f32 v38, v38
    v_rcp_f32 v39, v39
    v_rcp_f32 v40, v40
    v_rcp_f32 v41, v41
    v_rcp_f32 v42, v42
    v_rcp_f32 v43, v43
    v_pk_mul_f32 v[64:65], v[64:65], v[36:37]
    v_pk_mul_f32 v[66:67], v[66:67], v[38:39]
    v_pk_mul_f32 v[68:69], v[68:69], v[40:41]
    v_pk_mul_f32 v[70:71], v[70:71], v[42:43]
    v_cvt_pk_bf16_f32 v64, v64, v65
    v_cvt_pk_bf16_f32 v65, v66, v67
    v_cvt_pk_bf16_f32 v66, v68, v69
    v_cvt_pk_bf16_f32 v67, v70, v71
    buffer_store_dwordx4 v[64:67], v30, s[8:11], s66 offen offset:0 sc1
    v_pk_mul_f32 v[36:37], v[72:73], v[72:73]
    v_pk_mul_f32 v[38:39], v[74:75], v[74:75]
    v_pk_mul_f32 v[40:41], v[76:77], v[76:77]
    v_pk_mul_f32 v[42:43], v[78:79], v[78:79]
    v_pk_fma_f32 v[36:37], v[36:37], s[54:55], v[44:45]
    v_pk_fma_f32 v[38:39], v[38:39], s[54:55], v[44:45]
    v_pk_fma_f32 v[40:41], v[40:41], s[54:55], v[44:45]
    v_pk_fma_f32 v[42:43], v[42:43], s[54:55], v[44:45]
    v_pk_mul_f32 v[36:37], v[36:37], v[72:73]
    v_pk_mul_f32 v[38:39], v[38:39], v[74:75]
    v_pk_mul_f32 v[40:41], v[40:41], v[76:77]
    v_pk_mul_f32 v[42:43], v[42:43], v[78:79]
    v_exp_f32 v36, v36
    v_exp_f32 v37, v37
    v_exp_f32 v38, v38
    v_exp_f32 v39, v39
    v_exp_f32 v40, v40
    v_exp_f32 v41, v41
    v_exp_f32 v42, v42
    v_exp_f32 v43, v43
    v_pk_add_f32 v[36:37], v[36:37], 1.0 op_sel_hi:[1,0]
    v_pk_add_f32 v[38:39], v[38:39], 1.0 op_sel_hi:[1,0]
    v_pk_add_f32 v[40:41], v[40:41], 1.0 op_sel_hi:[1,0]
    v_pk_add_f32 v[42:43], v[42:43], 1.0 op_sel_hi:[1,0]
    v_rcp_f32 v36, v36
    v_rcp_f32 v37, v37
    v_rcp_f32 v38, v38
    v_rcp_f32 v39, v39
    v_rcp_f32 v40, v40
    v_rcp_f32 v41, v41
    v_rcp_f32 v42, v42
    v_rcp_f32 v43, v43
    v_pk_mul_f32 v[72:73], v[72:73], v[36:37]
    v_pk_mul_f32 v[74:75], v[74:75], v[38:39]
    v_pk_mul_f32 v[76:77], v[76:77], v[40:41]
    v_pk_mul_f32 v[78:79], v[78:79], v[42:43]
    v_cvt_pk_bf16_f32 v72, v72, v73
    v_cvt_pk_bf16_f32 v73, v74, v75
    v_cvt_pk_bf16_f32 v74, v76, v77
    v_cvt_pk_bf16_f32 v75, v78, v79
    buffer_store_dwordx4 v[72:75], v30, s[8:11], s66 offen offset:1024 sc1
    v_pk_mul_f32 v[36:37], v[80:81], v[80:81]
    v_pk_mul_f32 v[38:39], v[82:83], v[82:83]
    v_pk_mul_f32 v[40:41], v[84:85], v[84:85]
    v_pk_mul_f32 v[42:43], v[86:87], v[86:87]
    v_pk_fma_f32 v[36:37], v[36:37], s[54:55], v[44:45]
    v_pk_fma_f32 v[38:39], v[38:39], s[54:55], v[44:45]
    v_pk_fma_f32 v[40:41], v[40:41], s[54:55], v[44:45]
    v_pk_fma_f32 v[42:43], v[42:43], s[54:55], v[44:45]
    v_pk_mul_f32 v[36:37], v[36:37], v[80:81]
    v_pk_mul_f32 v[38:39], v[38:39], v[82:83]
    v_pk_mul_f32 v[40:41], v[40:41], v[84:85]
    v_pk_mul_f32 v[42:43], v[42:43], v[86:87]
    v_exp_f32 v36, v36
    v_exp_f32 v37, v37
    v_exp_f32 v38, v38
    v_exp_f32 v39, v39
    v_exp_f32 v40, v40
    v_exp_f32 v41, v41
    v_exp_f32 v42, v42
    v_exp_f32 v43, v43
    v_pk_add_f32 v[36:37], v[36:37], 1.0 op_sel_hi:[1,0]
    v_pk_add_f32 v[38:39], v[38:39], 1.0 op_sel_hi:[1,0]
    v_pk_add_f32 v[40:41], v[40:41], 1.0 op_sel_hi:[1,0]
    v_pk_add_f32 v[42:43], v[42:43], 1.0 op_sel_hi:[1,0]
    v_rcp_f32 v36, v36
    v_rcp_f32 v37, v37
    v_rcp_f32 v38, v38
    v_rcp_f32 v39, v39
    v_rcp_f32 v40, v40
    v_rcp_f32 v41, v41
    v_rcp_f32 v42, v42
    v_rcp_f32 v43, v43
    v_pk_mul_f32 v[80:81], v[80:81], v[36:37]
    v_pk_mul_f32 v[82:83], v[82:83], v[38:39]
    v_pk_mul_f32 v[84:85], v[84:85], v[40:41]
    v_pk_mul_f32 v[86:87], v[86:87], v[42:43]
    v_cvt_pk_bf16_f32 v80, v80, v81
    v_cvt_pk_bf16_f32 v81, v82, v83
    v_cvt_pk_bf16_f32 v82, v84, v85
    v_cvt_pk_bf16_f32 v83, v86, v87
    buffer_store_dwordx4 v[80:83], v30, s[8:11], s66 offen offset:2048 sc1
    v_pk_mul_f32 v[36:37], v[88:89], v[88:89]
    v_pk_mul_f32 v[38:39], v[90:91], v[90:91]
    v_pk_fma_f32 v[36:37], v[36:37], s[54:55], v[44:45]
    v_pk_fma_f32 v[38:39], v[38:39], s[54:55], v[44:45]
    v_pk_mul_f32 v[36:37], v[36:37], v[88:89]
    v_pk_mul_f32 v[38:39], v[38:39], v[90:91]
    v_exp_f32 v36, v36
    v_exp_f32 v37, v37
    v_exp_f32 v38, v38
    v_exp_f32 v39, v39
    v_pk_add_f32 v[36:37], v[36:37], 1.0 op_sel_hi:[1,0]
    v_pk_add_f32 v[38:39], v[38:39], 1.0 op_sel_hi:[1,0]
    v_rcp_f32 v36, v36
    v_rcp_f32 v37, v37
    v_rcp_f32 v38, v38
    v_rcp_f32 v39, v39
    v_pk_mul_f32 v[88:89], v[88:89], v[36:37]
    v_pk_mul_f32 v[90:91], v[90:91], v[38:39]
    v_cvt_pk_bf16_f32 v88, v88, v89
    v_cvt_pk_bf16_f32 v89, v90, v91
    buffer_store_dwordx2 v[88:89], v2, s[8:11], s67 offen sc1
    s_add_u32 s66, s66, 57344
    s_add_u32 s67, s67, 57344
    v_pk_fma_f32 v[92:93], v[208:209], v[16:17], v[92:93] op_sel_hi:[1,0,1] neg_lo:[1,0,0] neg_hi:[1,0,0]
    v_pk_fma_f32 v[94:95], v[210:211], v[16:17], v[94:95] op_sel_hi:[1,0,1] neg_lo:[1,0,0] neg_hi:[1,0,0]
    v_pk_fma_f32 v[96:97], v[212:213], v[16:17], v[96:97] op_sel_hi:[1,0,1] neg_lo:[1,0,0] neg_hi:[1,0,0]
    v_pk_fma_f32 v[98:99], v[214:215], v[16:17], v[98:99] op_sel_hi:[1,0,1] neg_lo:[1,0,0] neg_hi:[1,0,0]
    v_pk_fma_f32 v[100:101], v[216:217], v[16:17], v[100:101] op_sel_hi:[1,0,1] neg_lo:[1,0,0] neg_hi:[1,0,0]
    v_pk_fma_f32 v[102:103], v[218:219], v[16:17], v[102:103] op_sel_hi:[1,0,1] neg_lo:[1,0,0] neg_hi:[1,0,0]
    v_pk_fma_f32 v[104:105], v[220:221], v[16:17], v[104:105] op_sel_hi:[1,0,1] neg_lo:[1,0,0] neg_hi:[1,0,0]
    v_pk_fma_f32 v[106:107], v[222:223], v[16:17], v[106:107] op_sel_hi:[1,0,1] neg_lo:[1,0,0] neg_hi:[1,0,0]
    v_pk_fma_f32 v[108:109], v[224:225], v[16:17], v[108:109] op_sel_hi:[1,0,1] neg_lo:[1,0,0] neg_hi:[1,0,0]
    v_pk_fma_f32 v[110:111], v[226:227], v[16:17], v[110:111] op_sel_hi:[1,0,1] neg_lo:[1,0,0] neg_hi:[1,0,0]
    v_pk_fma_f32 v[112:113], v[228:229], v[16:17], v[112:113] op_sel_hi:[1,0,1] neg_lo:[1,0,0] neg_hi:[1,0,0]
    v_pk_fma_f32 v[114:115], v[230:231], v[16:17], v[114:115] op_sel_hi:[1,0,1] neg_lo:[1,0,0] neg_hi:[1,0,0]
    v_pk_fma_f32 v[116:117], v[232:233], v[16:17], v[116:117] op_sel_hi:[1,0,1] neg_lo:[1,0,0] neg_hi:[1,0,0]
    v_pk_fma_f32 v[118:119], v[234:235], v[16:17], v[118:119] op_sel_hi:[1,0,1] neg_lo:[1,0,0] neg_hi:[1,0,0]
    v_pk_mul_f32 v[92:93], v[92:93], v[16:17] op_sel:[0,1] op_sel_hi:[1,1]
    v_pk_mul_f32 v[94:95], v[94:95], v[16:17] op_sel:[0,1] op_sel_hi:[1,1]
    v_pk_mul_f32 v[96:97], v[96:97], v[16:17] op_sel:[0,1] op_sel_hi:[1,1]
    v_pk_mul_f32 v[98:99], v[98:99], v[16:17] op_sel:[0,1] op_sel_hi:[1,1]
    v_pk_mul_f32 v[100:101], v[100:101], v[16:17] op_sel:[0,1] op_sel_hi:[1,1]
    v_pk_mul_f32 v[102:103], v[102:103], v[16:17] op_sel:[0,1] op_sel_hi:[1,1]
    v_pk_mul_f32 v[104:105], v[104:105], v[16:17] op_sel:[0,1] op_sel_hi:[1,1]
    v_pk_mul_f32 v[106:107], v[106:107], v[16:17] op_sel:[0,1] op_sel_hi:[1,1]
    v_pk_mul_f32 v[108:109], v[108:109], v[16:17] op_sel:[0,1] op_sel_hi:[1,1]
    v_pk_mul_f32 v[110:111], v[110:111], v[16:17] op_sel:[0,1] op_sel_hi:[1,1]
    v_pk_mul_f32 v[112:113], v[112:113], v[16:17] op_sel:[0,1] op_sel_hi:[1,1]
    v_pk_mul_f32 v[114:115], v[114:115], v[16:17] op_sel:[0,1] op_sel_hi:[1,1]
    v_pk_mul_f32 v[116:117], v[116:117], v[16:17] op_sel:[0,1] op_sel_hi:[1,1]
    v_pk_mul_f32 v[118:119], v[118:119], v[16:17] op_sel:[0,1] op_sel_hi:[1,1]
    v_pk_mul_f32 v[36:37], v[92:93], v[92:93]
    v_pk_mul_f32 v[38:39], v[94:95], v[94:95]
    v_pk_mul_f32 v[40:41], v[96:97], v[96:97]
    v_pk_mul_f32 v[42:43], v[98:99], v[98:99]
    v_pk_fma_f32 v[36:37], v[36:37], s[54:55], v[44:45]
    v_pk_fma_f32 v[38:39], v[38:39], s[54:55], v[44:45]
    v_pk_fma_f32 v[40:41], v[40:41], s[54:55], v[44:45]
    v_pk_fma_f32 v[42:43], v[42:43], s[54:55], v[44:45]
    v_pk_mul_f32 v[36:37], v[36:37], v[92:93]
    v_pk_mul_f32 v[38:39], v[38:39], v[94:95]
    v_pk_mul_f32 v[40:41], v[40:41], v[96:97]
    v_pk_mul_f32 v[42:43], v[42:43], v[98:99]
    v_exp_f32 v36, v36
    v_exp_f32 v37, v37
    v_exp_f32 v38, v38
    v_exp_f32 v39, v39
    v_exp_f32 v40, v40
    v_exp_f32 v41, v41
    v_exp_f32 v42, v42
    v_exp_f32 v43, v43
    v_pk_add_f32 v[36:37], v[36:37], 1.0 op_sel_hi:[1,0]
    v_pk_add_f32 v[38:39], v[38:39], 1.0 op_sel_hi:[1,0]
    v_pk_add_f32 v[40:41], v[40:41], 1.0 op_sel_hi:[1,0]
    v_pk_add_f32 v[42:43], v[42:43], 1.0 op_sel_hi:[1,0]
    v_rcp_f32 v36, v36
    v_rcp_f32 v37, v37
    v_rcp_f32 v38, v38
    v_rcp_f32 v39, v39
    v_rcp_f32 v40, v40
    v_rcp_f32 v41, v41
    v_rcp_f32 v42, v42
    v_rcp_f32 v43, v43
    v_pk_mul_f32 v[92:93], v[92:93], v[36:37]
    v_pk_mul_f32 v[94:95], v[94:95], v[38:39]
    v_pk_mul_f32 v[96:97], v[96:97], v[40:41]
    v_pk_mul_f32 v[98:99], v[98:99], v[42:43]
    v_cvt_pk_bf16_f32 v92, v92, v93
    v_cvt_pk_bf16_f32 v93, v94, v95
    v_cvt_pk_bf16_f32 v94, v96, v97
    v_cvt_pk_bf16_f32 v95, v98, v99
    buffer_store_dwordx4 v[92:95], v30, s[8:11], s66 offen offset:0 sc1
    v_pk_mul_f32 v[36:37], v[100:101], v[100:101]
    v_pk_mul_f32 v[38:39], v[102:103], v[102:103]
    v_pk_mul_f32 v[40:41], v[104:105], v[104:105]
    v_pk_mul_f32 v[42:43], v[106:107], v[106:107]
    v_pk_fma_f32 v[36:37], v[36:37], s[54:55], v[44:45]
    v_pk_fma_f32 v[38:39], v[38:39], s[54:55], v[44:45]
    v_pk_fma_f32 v[40:41], v[40:41], s[54:55], v[44:45]
    v_pk_fma_f32 v[42:43], v[42:43], s[54:55], v[44:45]
    v_pk_mul_f32 v[36:37], v[36:37], v[100:101]
    v_pk_mul_f32 v[38:39], v[38:39], v[102:103]
    v_pk_mul_f32 v[40:41], v[40:41], v[104:105]
    v_pk_mul_f32 v[42:43], v[42:43], v[106:107]
    v_exp_f32 v36, v36
    v_exp_f32 v37, v37
    v_exp_f32 v38, v38
    v_exp_f32 v39, v39
    v_exp_f32 v40, v40
    v_exp_f32 v41, v41
    v_exp_f32 v42, v42
    v_exp_f32 v43, v43
    v_pk_add_f32 v[36:37], v[36:37], 1.0 op_sel_hi:[1,0]
    v_pk_add_f32 v[38:39], v[38:39], 1.0 op_sel_hi:[1,0]
    v_pk_add_f32 v[40:41], v[40:41], 1.0 op_sel_hi:[1,0]
    v_pk_add_f32 v[42:43], v[42:43], 1.0 op_sel_hi:[1,0]
    v_rcp_f32 v36, v36
    v_rcp_f32 v37, v37
    v_rcp_f32 v38, v38
    v_rcp_f32 v39, v39
    v_rcp_f32 v40, v40
    v_rcp_f32 v41, v41
    v_rcp_f32 v42, v42
    v_rcp_f32 v43, v43
    v_pk_mul_f32 v[100:101], v[100:101], v[36:37]
    v_pk_mul_f32 v[102:103], v[102:103], v[38:39]
    v_pk_mul_f32 v[104:105], v[104:105], v[40:41]
    v_pk_mul_f32 v[106:107], v[106:107], v[42:43]
    v_cvt_pk_bf16_f32 v100, v100, v101
    v_cvt_pk_bf16_f32 v101, v102, v103
    v_cvt_pk_bf16_f32 v102, v104, v105
    v_cvt_pk_bf16_f32 v103, v106, v107
    buffer_store_dwordx4 v[100:103], v30, s[8:11], s66 offen offset:1024 sc1
    v_pk_mul_f32 v[36:37], v[108:109], v[108:109]
    v_pk_mul_f32 v[38:39], v[110:111], v[110:111]
    v_pk_mul_f32 v[40:41], v[112:113], v[112:113]
    v_pk_mul_f32 v[42:43], v[114:115], v[114:115]
    v_pk_fma_f32 v[36:37], v[36:37], s[54:55], v[44:45]
    v_pk_fma_f32 v[38:39], v[38:39], s[54:55], v[44:45]
    v_pk_fma_f32 v[40:41], v[40:41], s[54:55], v[44:45]
    v_pk_fma_f32 v[42:43], v[42:43], s[54:55], v[44:45]
    v_pk_mul_f32 v[36:37], v[36:37], v[108:109]
    v_pk_mul_f32 v[38:39], v[38:39], v[110:111]
    v_pk_mul_f32 v[40:41], v[40:41], v[112:113]
    v_pk_mul_f32 v[42:43], v[42:43], v[114:115]
    v_exp_f32 v36, v36
    v_exp_f32 v37, v37
    v_exp_f32 v38, v38
    v_exp_f32 v39, v39
    v_exp_f32 v40, v40
    v_exp_f32 v41, v41
    v_exp_f32 v42, v42
    v_exp_f32 v43, v43
    v_pk_add_f32 v[36:37], v[36:37], 1.0 op_sel_hi:[1,0]
    v_pk_add_f32 v[38:39], v[38:39], 1.0 op_sel_hi:[1,0]
    v_pk_add_f32 v[40:41], v[40:41], 1.0 op_sel_hi:[1,0]
    v_pk_add_f32 v[42:43], v[42:43], 1.0 op_sel_hi:[1,0]
    v_rcp_f32 v36, v36
    v_rcp_f32 v37, v37
    v_rcp_f32 v38, v38
    v_rcp_f32 v39, v39
    v_rcp_f32 v40, v40
    v_rcp_f32 v41, v41
    v_rcp_f32 v42, v42
    v_rcp_f32 v43, v43
    v_pk_mul_f32 v[108:109], v[108:109], v[36:37]
    v_pk_mul_f32 v[110:111], v[110:111], v[38:39]
    v_pk_mul_f32 v[112:113], v[112:113], v[40:41]
    v_pk_mul_f32 v[114:115], v[114:115], v[42:43]
    v_cvt_pk_bf16_f32 v108, v108, v109
    v_cvt_pk_bf16_f32 v109, v110, v111
    v_cvt_pk_bf16_f32 v110, v112, v113
    v_cvt_pk_bf16_f32 v111, v114, v115
    buffer_store_dwordx4 v[108:111], v30, s[8:11], s66 offen offset:2048 sc1
    v_pk_mul_f32 v[36:37], v[116:117], v[116:117]
    v_pk_mul_f32 v[38:39], v[118:119], v[118:119]
    v_pk_fma_f32 v[36:37], v[36:37], s[54:55], v[44:45]
    v_pk_fma_f32 v[38:39], v[38:39], s[54:55], v[44:45]
    v_pk_mul_f32 v[36:37], v[36:37], v[116:117]
    v_pk_mul_f32 v[38:39], v[38:39], v[118:119]
    v_exp_f32 v36, v36
    v_exp_f32 v37, v37
    v_exp_f32 v38, v38
    v_exp_f32 v39, v39
    v_pk_add_f32 v[36:37], v[36:37], 1.0 op_sel_hi:[1,0]
    v_pk_add_f32 v[38:39], v[38:39], 1.0 op_sel_hi:[1,0]
    v_rcp_f32 v36, v36
    v_rcp_f32 v37, v37
    v_rcp_f32 v38, v38
    v_rcp_f32 v39, v39
    v_pk_mul_f32 v[116:117], v[116:117], v[36:37]
    v_pk_mul_f32 v[118:119], v[118:119], v[38:39]
    v_cvt_pk_bf16_f32 v116, v116, v117
    v_cvt_pk_bf16_f32 v117, v118, v119
    buffer_store_dwordx2 v[116:117], v2, s[8:11], s67 offen sc1
    s_add_u32 s20, s68, s56
    buffer_load_dwordx4 v[120:123], v30, s[8:11], s20 offen offset:0 sc1
    buffer_load_dwordx4 v[124:127], v30, s[8:11], s20 offen offset:1024 sc1
    buffer_load_dwordx4 v[128:131], v30, s[8:11], s20 offen offset:2048 sc1
    buffer_load_dwordx4 v[132:135], v30, s[8:11], s20 offen offset:3072 sc1
    s_add_u32 s56, s56, 4096
    s_cmp_ge_u32 s56, 20480
    s_cselect_b32 s56, 0, s56
    s_add_u32 s20, s68, s56
    buffer_load_dwordx4 v[136:139], v30, s[8:11], s20 offen offset:0 sc1
    buffer_load_dwordx4 v[140:143], v30, s[8:11], s20 offen offset:1024 sc1
    buffer_load_dwordx4 v[144:147], v30, s[8:11], s20 offen offset:2048 sc1
    buffer_load_dwordx4 v[148:151], v30, s[8:11], s20 offen offset:3072 sc1
    s_add_u32 s56, s56, 4096
    s_cmp_ge_u32 s56, 20480
    s_cselect_b32 s56, 0, s56
    s_add_u32 s20, s68, s56
    buffer_load_dwordx4 v[152:155], v30, s[8:11], s20 offen offset:0 sc1
    buffer_load_dwordx4 v[156:159], v30, s[8:11], s20 offen offset:1024 sc1
    buffer_load_dwordx4 v[160:163], v30, s[8:11], s20 offen offset:2048 sc1
    buffer_load_dwordx4 v[164:167], v30, s[8:11], s20 offen offset:3072 sc1
    s_add_u32 s56, s56, 4096
    s_cmp_ge_u32 s56, 20480
    s_cselect_b32 s56, 0, s56
    s_add_u32 s20, s68, s56
    buffer_load_dwordx4 v[168:171], v30, s[8:11], s20 offen offset:0 sc1
    buffer_load_dwordx4 v[172:175], v30, s[8:11], s20 offen offset:1024 sc1
    buffer_load_dwordx4 v[176:179], v30, s[8:11], s20 offen offset:2048 sc1
    buffer_load_dwordx4 v[180:183], v30, s[8:11], s20 offen offset:3072 sc1
    s_add_u32 s56, s56, 4096
    s_cmp_ge_u32 s56, 20480
    s_cselect_b32 s56, 0, s56
    s_add_u32 s20, s68, s56
    buffer_load_dwordx4 v[184:187], v30, s[8:11], s20 offen offset:0 sc1
    buffer_load_dwordx4 v[188:191], v30, s[8:11], s20 offen offset:1024 sc1
    buffer_load_dwordx4 v[192:195], v30, s[8:11], s20 offen offset:2048 sc1
    buffer_load_dwordx4 v[196:199], v30, s[8:11], s20 offen offset:3072 sc1
    s_waitcnt vmcnt(20)
    s_lshl_b32 s70, s38, 7
    s_lshl_b32 s3, s39, 2
    s_add_u32 s70, s70, s3
    s_add_u32 s70, s70, 0x1c44800
    s_mov_b64 exec, 1
    v_mov_b32 v7, 1
    v_mov_b32 v33, 150792
    ds_add_rtn_u32 v33, v33, v7
    s_waitcnt lgkmcnt(0)
    v_cmp_eq_u32 vcc, 3, v33
    s_cbranch_vccz Lws7
    buffer_store_dword v7, off, s[8:11], s70 sc1
Lws7:
    s_mov_b64 exec, -1
    s_barrier
    v_add_u32 v33, s57, v30
    ds_read_b128 v[64:67], v33 offset:0
    ds_read_b128 v[68:71], v33 offset:1024
    ds_read_b128 v[72:75], v33 offset:2048
    ds_read_b128 v[76:79], v33 offset:3072
    ds_read_b128 v[80:83], v33 offset:4096
    ds_read_b128 v[84:87], v33 offset:5120
    ds_read_b128 v[88:91], v33 offset:6144
    ds_read_b128 v[92:95], v33 offset:7168
    ds_read_b128 v[96:99], v33 offset:8192
    ds_read_b128 v[100:103], v33 offset:9216
    s_waitcnt vmcnt(19)
    s_waitcnt lgkmcnt(5)
    v_mfma_f32_16x16x32_bf16 v[44:47], v[64:67], v[120:123], 0
    ds_read_b128 v[200:203], v33 offset:10240
    v_mfma_f32_16x16x32_bf16 v[48:51], v[68:71], v[120:123], 0
    ds_read_b128 v[204:207], v33 offset:11264
    ds_read_b128 v[208:211], v33 offset:12288
    v_mfma_f32_16x16x32_bf16 v[52:55], v[72:75], v[120:123], 0
    ds_read_b128 v[212:215], v33 offset:13312
    ds_read_b128 v[216:219], v33 offset:14336
    v_mfma_f32_16x16x32_bf16 v[56:59], v[76:79], v[120:123], 0
    v_mfma_f32_16x16x32_bf16 v[60:63], v[80:83], v[120:123], 0
    s_waitcnt vmcnt(18)
    s_waitcnt lgkmcnt(5)
    v_mfma_f32_16x16x32_bf16 v[44:47], v[84:87], v[124:127], v[44:47]
    ds_read_b128 v[64:67], v33 offset:15360
    v_mfma_f32_16x16x32_bf16 v[48:51], v[88:91], v[124:127], v[48:51]
    ds_read_b128 v[68:71], v33 offset:16384
    ds_read_b128 v[72:75], v33 offset:17408
    v_mfma_f32_16x16x32_bf16 v[52:55], v[92:95], v[124:127], v[52:55]
    ds_read_b128 v[76:79], v33 offset:18432
    ds_read_b128 v[80:83], v33 offset:19456
    v_mfma_f32_16x16x32_bf16 v[56:59], v[96:99], v[124:127], v[56:59]
    v_mfma_f32_16x16x32_bf16 v[60:63], v[100:103], v[124:127], v[60:63]
    s_waitcnt vmcnt(17)
    s_waitcnt lgkmcnt(5)
    v_mfma_f32_16x16x32_bf16 v[44:47], v[200:203], v[128:131], v[44:47]
    s_add_u32 s57, s57, 20480
    s_cmp_ge_u32 s57, 102400
    s_cselect_b32 s57, 0, s57
    v_add_u32 v33, s57, v30
    ds_read_b128 v[84:87], v33 offset:0
    v_mfma_f32_16x16x32_bf16 v[48:51], v[204:207], v[128:131], v[48:51]
    ds_read_b128 v[88:91], v33 offset:1024
    ds_read_b128 v[92:95], v33 offset:2048
    v_mfma_f32_16x16x32_bf16 v[52:55], v[208:211], v[128:131], v[52:55]
    ds_read_b128 v[96:99], v33 offset:3072
    ds_read_b128 v[100:103], v33 offset:4096
    v_mfma_f32_16x16x32_bf16 v[56:59], v[212:215], v[128:131], v[56:59]
    v_mfma_f32_16x16x32_bf16 v[60:63], v[216:219], v[128:131], v[60:63]
    s_waitcnt vmcnt(16)
    s_waitcnt lgkmcnt(5)
    v_mfma_f32_16x16x32_bf16 v[44:47], v[64:67], v[132:135], v[44:47]
    ds_read_b128 v[200:203], v33 offset:5120
    v_mfma_f32_16x16x32_bf16 v[48:51], v[68:71], v[132:135], v[48:51]
    ds_read_b128 v[204:207], v33 offset:6144
    ds_read_b128 v[208:211], v33 offset:7168
    v_mfma_f32_16x16x32_bf16 v[52:55], v[72:75], v[132:135], v[52:55]
    ds_read_b128 v[212:215], v33 offset:8192
    ds_read_b128 v[216:219], v33 offset:9216
    v_mfma_f32_16x16x32_bf16 v[56:59], v[76:79], v[132:135], v[56:59]
    v_mfma_f32_16x16x32_bf16 v[60:63], v[80:83], v[132:135], v[60:63]
    s_waitcnt vmcnt(15)
    s_waitcnt lgkmcnt(5)
    v_mfma_f32_16x16x32_bf16 v[44:47], v[84:87], v[136:139], v[44:47]
    ds_read_b128 v[64:67], v33 offset:10240
    v_mfma_f32_16x16x32_bf16 v[48:51], v[88:91], v[136:139], v[48:51]
    ds_read_b128 v[68:71], v33 offset:11264
    ds_read_b128 v[72:75], v33 offset:12288
    v_mfma_f32_16x16x32_bf16 v[52:55], v[92:95], v[136:139], v[52:55]
    ds_read_b128 v[76:79], v33 offset:13312
    ds_read_b128 v[80:83], v33 offset:14336
    v_mfma_f32_16x16x32_bf16 v[56:59], v[96:99], v[136:139], v[56:59]
    v_mfma_f32_16x16x32_bf16 v[60:63], v[100:103], v[136:139], v[60:63]
    s_waitcnt vmcnt(14)
    s_waitcnt lgkmcnt(5)
    v_mfma_f32_16x16x32_bf16 v[44:47], v[200:203], v[140:143], v[44:47]
    ds_read_b128 v[84:87], v33 offset:15360
    v_mfma_f32_16x16x32_bf16 v[48:51], v[204:207], v[140:143], v[48:51]
    ds_read_b128 v[88:91], v33 offset:16384
    ds_read_b128 v[92:95], v33 offset:17408
    v_mfma_f32_16x16x32_bf16 v[52:55], v[208:211], v[140:143], v[52:55]
    ds_read_b128 v[96:99], v33 offset:18432
    ds_read_b128 v[100:103], v33 offset:19456
    v_mfma_f32_16x16x32_bf16 v[56:59], v[212:215], v[140:143], v[56:59]
    v_mfma_f32_16x16x32_bf16 v[60:63], v[216:219], v[140:143], v[60:63]
    s_waitcnt vmcnt(13)
    s_waitcnt lgkmcnt(5)
    v_mfma_f32_16x16x32_bf16 v[44:47], v[64:67], v[144:147], v[44:47]
    s_add_u32 s57, s57, 20480
    s_cmp_ge_u32 s57, 102400
    s_cselect_b32 s57, 0, s57
    v_add_u32 v33, s57, v30
    ds_read_b128 v[200:203], v33 offset:0
    v_mfma_f32_16x16x32_bf16 v[48:51], v[68:71], v[144:147], v[48:51]
    ds_read_b128 v[204:207], v33 offset:1024
    ds_read_b128 v[208:211], v33 offset:2048
    v_mfma_f32_16x16x32_bf16 v[52:55], v[72:75], v[144:147], v[52:55]
    ds_read_b128 v[212:215], v33 offset:3072
    ds_read_b128 v[216:219], v33 offset:4096
    v_mfma_f32_16x16x32_bf16 v[56:59], v[76:79], v[144:147], v[56:59]
    v_mfma_f32_16x16x32_bf16 v[60:63], v[80:83], v[144:147], v[60:63]
    s_waitcnt vmcnt(12)
    s_waitcnt lgkmcnt(5)
    v_mfma_f32_16x16x32_bf16 v[44:47], v[84:87], v[148:151], v[44:47]
    ds_read_b128 v[64:67], v33 offset:5120
    v_mfma_f32_16x16x32_bf16 v[48:51], v[88:91], v[148:151], v[48:51]
    ds_read_b128 v[68:71], v33 offset:6144
    ds_read_b128 v[72:75], v33 offset:7168
    v_mfma_f32_16x16x32_bf16 v[52:55], v[92:95], v[148:151], v[52:55]
    ds_read_b128 v[76:79], v33 offset:8192
    ds_read_b128 v[80:83], v33 offset:9216
    v_mfma_f32_16x16x32_bf16 v[56:59], v[96:99], v[148:151], v[56:59]
    v_mfma_f32_16x16x32_bf16 v[60:63], v[100:103], v[148:151], v[60:63]
    s_waitcnt vmcnt(11)
    s_waitcnt lgkmcnt(5)
    v_mfma_f32_16x16x32_bf16 v[44:47], v[200:203], v[152:155], v[44:47]
    ds_read_b128 v[84:87], v33 offset:10240
    v_mfma_f32_16x16x32_bf16 v[48:51], v[204:207], v[152:155], v[48:51]
    ds_read_b128 v[88:91], v33 offset:11264
    ds_read_b128 v[92:95], v33 offset:12288
    v_mfma_f32_16x16x32_bf16 v[52:55], v[208:211], v[152:155], v[52:55]
    ds_read_b128 v[96:99], v33 offset:13312
    ds_read_b128 v[100:103], v33 offset:14336
    v_mfma_f32_16x16x32_bf16 v[56:59], v[212:215], v[152:155], v[56:59]
    v_mfma_f32_16x16x32_bf16 v[60:63], v[216:219], v[152:155], v[60:63]
    s_waitcnt vmcnt(10)
    s_waitcnt lgkmcnt(5)
    v_mfma_f32_16x16x32_bf16 v[44:47], v[64:67], v[156:159], v[44:47]
    ds_read_b128 v[200:203], v33 offset:15360
    v_mfma_f32_16x16x32_bf16 v[48:51], v[68:71], v[156:159], v[48:51]
    ds_read_b128 v[204:207], v33 offset:16384
    ds_read_b128 v[208:211], v33 offset:17408
    v_mfma_f32_16x16x32_bf16 v[52:55], v[72:75], v[156:159], v[52:55]
    ds_read_b128 v[212:215], v33 offset:18432
    ds_read_b128 v[216:219], v33 offset:19456
    v_mfma_f32_16x16x32_bf16 v[56:59], v[76:79], v[156:159], v[56:59]
    v_mfma_f32_16x16x32_bf16 v[60:63], v[80:83], v[156:159], v[60:63]
    s_waitcnt vmcnt(9)
    s_waitcnt lgkmcnt(5)
    v_mfma_f32_16x16x32_bf16 v[44:47], v[84:87], v[160:163], v[44:47]
    s_add_u32 s57, s57, 20480
    s_cmp_ge_u32 s57, 102400
    s_cselect_b32 s57, 0, s57
    v_add_u32 v33, s57, v30
    ds_read_b128 v[64:67], v33 offset:0
    v_mfma_f32_16x16x32_bf16 v[48:51], v[88:91], v[160:163], v[48:51]
    ds_read_b128 v[68:71], v33 offset:1024
    ds_read_b128 v[72:75], v33 offset:2048
    v_mfma_f32_16x16x32_bf16 v[52:55], v[92:95], v[160:163], v[52:55]
    ds_read_b128 v[76:79], v33 offset:3072
    ds_read_b128 v[80:83], v33 offset:4096
    v_mfma_f32_16x16x32_bf16 v[56:59], v[96:99], v[160:163], v[56:59]
    v_mfma_f32_16x16x32_bf16 v[60:63], v[100:103], v[160:163], v[60:63]
    s_waitcnt vmcnt(8)
    s_waitcnt lgkmcnt(5)
    v_mfma_f32_16x16x32_bf16 v[44:47], v[200:203], v[164:167], v[44:47]
    ds_read_b128 v[84:87], v33 offset:5120
    v_mfma_f32_16x16x32_bf16 v[48:51], v[204:207], v[164:167], v[48:51]
    ds_read_b128 v[88:91], v33 offset:6144
    ds_read_b128 v[92:95], v33 offset:7168
    v_mfma_f32_16x16x32_bf16 v[52:55], v[208:211], v[164:167], v[52:55]
    ds_read_b128 v[96:99], v33 offset:8192
    ds_read_b128 v[100:103], v33 offset:9216
    v_mfma_f32_16x16x32_bf16 v[56:59], v[212:215], v[164:167], v[56:59]
    v_mfma_f32_16x16x32_bf16 v[60:63], v[216:219], v[164:167], v[60:63]
    s_waitcnt vmcnt(7)
    s_waitcnt lgkmcnt(5)
    v_mfma_f32_16x16x32_bf16 v[44:47], v[64:67], v[168:171], v[44:47]
    ds_read_b128 v[200:203], v33 offset:10240
    v_mfma_f32_16x16x32_bf16 v[48:51], v[68:71], v[168:171], v[48:51]
    ds_read_b128 v[204:207], v33 offset:11264
    ds_read_b128 v[208:211], v33 offset:12288
    v_mfma_f32_16x16x32_bf16 v[52:55], v[72:75], v[168:171], v[52:55]
    ds_read_b128 v[212:215], v33 offset:13312
    ds_read_b128 v[216:219], v33 offset:14336
    v_mfma_f32_16x16x32_bf16 v[56:59], v[76:79], v[168:171], v[56:59]
    v_mfma_f32_16x16x32_bf16 v[60:63], v[80:83], v[168:171], v[60:63]
    s_waitcnt vmcnt(6)
    s_waitcnt lgkmcnt(5)
    v_mfma_f32_16x16x32_bf16 v[44:47], v[84:87], v[172:175], v[44:47]
    ds_read_b128 v[64:67], v33 offset:15360
    v_mfma_f32_16x16x32_bf16 v[48:51], v[88:91], v[172:175], v[48:51]
    ds_read_b128 v[68:71], v33 offset:16384
    ds_read_b128 v[72:75], v33 offset:17408
    v_mfma_f32_16x16x32_bf16 v[52:55], v[92:95], v[172:175], v[52:55]
    ds_read_b128 v[76:79], v33 offset:18432
    ds_read_b128 v[80:83], v33 offset:19456
    v_mfma_f32_16x16x32_bf16 v[56:59], v[96:99], v[172:175], v[56:59]
    v_mfma_f32_16x16x32_bf16 v[60:63], v[100:103], v[172:175], v[60:63]
    s_waitcnt vmcnt(5)
    s_waitcnt lgkmcnt(5)
    v_mfma_f32_16x16x32_bf16 v[44:47], v[200:203], v[176:179], v[44:47]
    s_add_u32 s57, s57, 20480
    s_cmp_ge_u32 s57, 102400
    s_cselect_b32 s57, 0, s57
    v_add_u32 v33, s57, v30
    ds_read_b128 v[84:87], v33 offset:0
    v_mfma_f32_16x16x32_bf16 v[48:51], v[204:207], v[176:179], v[48:51]
    ds_read_b128 v[88:91], v33 offset:1024
    ds_read_b128 v[92:95], v33 offset:2048
    v_mfma_f32_16x16x32_bf16 v[52:55], v[208:211], v[176:179], v[52:55]
    ds_read_b128 v[96:99], v33 offset:3072
    ds_read_b128 v[100:103], v33 offset:4096
    v_mfma_f32_16x16x32_bf16 v[56:59], v[212:215], v[176:179], v[56:59]
    v_mfma_f32_16x16x32_bf16 v[60:63], v[216:219], v[176:179], v[60:63]
    s_waitcnt vmcnt(4)
    s_waitcnt lgkmcnt(5)
    v_mfma_f32_16x16x32_bf16 v[44:47], v[64:67], v[180:183], v[44:47]
    ds_read_b128 v[200:203], v33 offset:5120
    v_mfma_f32_16x16x32_bf16 v[48:51], v[68:71], v[180:183], v[48:51]
    ds_read_b128 v[204:207], v33 offset:6144
    ds_read_b128 v[208:211], v33 offset:7168
    v_mfma_f32_16x16x32_bf16 v[52:55], v[72:75], v[180:183], v[52:55]
    ds_read_b128 v[212:215], v33 offset:8192
    ds_read_b128 v[216:219], v33 offset:9216
    v_mfma_f32_16x16x32_bf16 v[56:59], v[76:79], v[180:183], v[56:59]
    v_mfma_f32_16x16x32_bf16 v[60:63], v[80:83], v[180:183], v[60:63]
    s_waitcnt vmcnt(3)
    s_waitcnt lgkmcnt(5)
    v_mfma_f32_16x16x32_bf16 v[44:47], v[84:87], v[184:187], v[44:47]
    ds_read_b128 v[64:67], v33 offset:10240
    v_mfma_f32_16x16x32_bf16 v[48:51], v[88:91], v[184:187], v[48:51]
    ds_read_b128 v[68:71], v33 offset:11264
    ds_read_b128 v[72:75], v33 offset:12288
    v_mfma_f32_16x16x32_bf16 v[52:55], v[92:95], v[184:187], v[52:55]
    ds_read_b128 v[76:79], v33 offset:13312
    ds_read_b128 v[80:83], v33 offset:14336
    v_mfma_f32_16x16x32_bf16 v[56:59], v[96:99], v[184:187], v[56:59]
    v_mfma_f32_16x16x32_bf16 v[60:63], v[100:103], v[184:187], v[60:63]
    s_waitcnt vmcnt(2)
    s_waitcnt lgkmcnt(5)
    v_mfma_f32_16x16x32_bf16 v[44:47], v[200:203], v[188:191], v[44:47]
    ds_read_b128 v[84:87], v33 offset:15360
    v_mfma_f32_16x16x32_bf16 v[48:51], v[204:207], v[188:191], v[48:51]
    ds_read_b128 v[88:91], v33 offset:16384
    ds_read_b128 v[92:95], v33 offset:17408
    v_mfma_f32_16x16x32_bf16 v[52:55], v[208:211], v[188:191], v[52:55]
    ds_read_b128 v[96:99], v33 offset:18432
    ds_read_b128 v[100:103], v33 offset:19456
    v_mfma_f32_16x16x32_bf16 v[56:59], v[212:215], v[188:191], v[56:59]
    v_mfma_f32_16x16x32_bf16 v[60:63], v[216:219], v[188:191], v[60:63]
    s_waitcnt vmcnt(1)
    s_waitcnt lgkmcnt(5)
    v_mfma_f32_16x16x32_bf16 v[44:47], v[64:67], v[192:195], v[44:47]
    v_mfma_f32_16x16x32_bf16 v[48:51], v[68:71], v[192:195], v[48:51]
    v_mfma_f32_16x16x32_bf16 v[52:55], v[72:75], v[192:195], v[52:55]
    v_mfma_f32_16x16x32_bf16 v[56:59], v[76:79], v[192:195], v[56:59]
    v_mfma_f32_16x16x32_bf16 v[60:63], v[80:83], v[192:195], v[60:63]
    s_waitcnt vmcnt(0)
    s_waitcnt lgkmcnt(0)
    v_mfma_f32_16x16x32_bf16 v[44:47], v[84:87], v[196:199], v[44:47]
    v_mfma_f32_16x16x32_bf16 v[48:51], v[88:91], v[196:199], v[48:51]
    v_mfma_f32_16x16x32_bf16 v[52:55], v[92:95], v[196:199], v[52:55]
    v_mfma_f32_16x16x32_bf16 v[56:59], v[96:99], v[196:199], v[56:59]
    v_mfma_f32_16x16x32_bf16 v[60:63], v[100:103], v[196:199], v[60:63]
    s_mov_b32 s59, 0
    s_lshl_b32 s3, s27, 2
    s_add_u32 s3, s3, s22
    s_mul_i32 s68, s3, 57344
    s_add_u32 s68, s68, 0xf00000
    s_and_b32 s58, s22, 1
    s_lshl_b32 s3, s58, 11
    s_add_u32 s68, s68, s3
    s_add_u32 s67, s68, 53248
    s_lshl_b32 s3, s59, 12
    s_add_u32 s66, s68, s3
    s_mul_i32 s69, s58, -114688
    s_add_u32 s69, s69, 57344
    s_lshl_b32 s70, s58, 10
    s_sub_u32 s70, s67, s70
    s_mul_i32 s3, s58, 10240
    v_add_u32 v4, s3, v30
    v_add_u32 v5, s3, v31
    v_add_u32 v6, s3, v32
    s_mul_i32 s3, s58, 5120
    v_add_u32 v7, s3, v31
    s_barrier
    s_add_u32 s20, s66, s69
    buffer_load_dwordx4 v[164:167], v30, s[8:11], s66 offen offset:0 sc1
    buffer_load_dwordx4 v[168:171], v30, s[8:11], s20 offen offset:0 sc1
    buffer_load_dwordx4 v[172:175], v30, s[8:11], s66 offen offset:1024 sc1
    buffer_load_dwordx4 v[176:179], v30, s[8:11], s20 offen offset:1024 sc1
    s_add_u32 s66, s66, 4096
    s_cmp_ge_u32 s66, s67
    s_cselect_b32 s66, s68, s66
    s_add_u32 s20, s66, s69
    buffer_load_dwordx4 v[180:183], v30, s[8:11], s66 offen offset:0 sc1
    buffer_load_dwordx4 v[184:187], v30, s[8:11], s20 offen offset:0 sc1
    ds_read_b128 v[104:107], v5 offset:36864
    ds_read_b128 v[108:111], v5 offset:37888
    ds_read_b128 v[112:115], v5 offset:38912
    ds_read_b128 v[116:119], v5 offset:39936
    ds_read_b128 v[120:123], v5 offset:40960
    ds_read_b128 v[124:127], v5 offset:41984
    ds_read_b128 v[128:131], v5 offset:43008
    ds_read_b128 v[132:135], v5 offset:44032
    ds_read_b128 v[136:139], v5 offset:45056
    ds_read_b128 v[140:143], v5 offset:46080
    s_waitcnt vmcnt(4)
    s_waitcnt lgkmcnt(5)
    v_mfma_f32_16x16x32_bf16 v[64:67], v[104:107], v[164:167], 0
    s_barrier
    buffer_load_dwordx4 v[188:191], v30, s[8:11], s66 offen offset:1024 sc1
    v_mfma_f32_16x16x32_bf16 v[84:87], v[104:107], v[168:171], 0
    ds_read_b128 v[144:147], v5 offset:57344
    v_mfma_f32_16x16x32_bf16 v[68:71], v[108:111], v[164:167], 0
    ds_read_b128 v[148:151], v5 offset:58368
    buffer_load_dwordx4 v[192:195], v30, s[8:11], s20 offen offset:1024 sc1
    v_mfma_f32_16x16x32_bf16 v[88:91], v[108:111], v[168:171], 0
    ds_read_b128 v[152:155], v5 offset:59392
    v_mfma_f32_16x16x32_bf16 v[72:75], v[112:115], v[164:167], 0
    ds_read_b128 v[156:159], v5 offset:60416
    s_add_u32 s66, s66, 4096
    s_cmp_ge_u32 s66, s67
    s_cselect_b32 s66, s68, s66
    s_add_u32 s20, s66, s69
    buffer_load_dwordx4 v[196:199], v30, s[8:11], s66 offen offset:0 sc1
    v_mfma_f32_16x16x32_bf16 v[92:95], v[112:115], v[168:171], 0
    ds_read_b128 v[160:163], v5 offset:61440
    v_mfma_f32_16x16x32_bf16 v[76:79], v[116:119], v[164:167], 0
    v_mfma_f32_16x16x32_bf16 v[96:99], v[116:119], v[168:171], 0
    buffer_load_dwordx4 v[200:203], v30, s[8:11], s20 offen offset:0 sc1
    v_mfma_f32_16x16x32_bf16 v[80:83], v[120:123], v[164:167], 0
    v_mfma_f32_16x16x32_bf16 v[100:103], v[120:123], v[168:171], 0
    s_waitcnt vmcnt(6)
    s_waitcnt lgkmcnt(5)
    v_mfma_f32_16x16x32_bf16 v[64:67], v[124:127], v[172:175], v[64:67]
    v_mfma_f32_16x16x32_bf16 v[84:87], v[124:127], v[176:179], v[84:87]
    buffer_load_dwordx4 v[204:207], v30, s[8:11], s66 offen offset:1024 sc1
    ds_read_b128 v[104:107], v5 offset:62464
    v_mfma_f32_16x16x32_bf16 v[68:71], v[128:131], v[172:175], v[68:71]
    ds_read_b128 v[108:111], v5 offset:63488
    v_mfma_f32_16x16x32_bf16 v[88:91], v[128:131], v[176:179], v[88:91]
    buffer_load_dwordx4 v[208:211], v30, s[8:11], s20 offen offset:1024 sc1
    ds_read_b128 v[112:115], v5 offset:64512
    v_mfma_f32_16x16x32_bf16 v[72:75], v[132:135], v[172:175], v[72:75]
    ds_read_b128 v[116:119], v6 offset:0
    v_mfma_f32_16x16x32_bf16 v[92:95], v[132:135], v[176:179], v[92:95]
    s_add_u32 s66, s66, 4096
    s_cmp_ge_u32 s66, s67
    s_cselect_b32 s66, s68, s66
    s_add_u32 s20, s66, s69
    buffer_load_dwordx4 v[212:215], v30, s[8:11], s66 offen offset:0 sc1
    ds_read_b128 v[120:123], v6 offset:1024
    v_mfma_f32_16x16x32_bf16 v[76:79], v[136:139], v[172:175], v[76:79]
    v_mfma_f32_16x16x32_bf16 v[96:99], v[136:139], v[176:179], v[96:99]
    v_mfma_f32_16x16x32_bf16 v[80:83], v[140:143], v[172:175], v[80:83]
    buffer_load_dwordx4 v[216:219], v30, s[8:11], s20 offen offset:0 sc1
    v_mfma_f32_16x16x32_bf16 v[100:103], v[140:143], v[176:179], v[100:103]
    s_waitcnt vmcnt(8)
    s_waitcnt lgkmcnt(5)
    v_mfma_f32_16x16x32_bf16 v[64:67], v[144:147], v[180:183], v[64:67]
    s_barrier
    buffer_load_dwordx4 v[220:223], v30, s[8:11], s66 offen offset:1024 sc1
    v_mfma_f32_16x16x32_bf16 v[84:87], v[144:147], v[184:187], v[84:87]
    ds_read_b128 v[124:127], v4 offset:0
    v_mfma_f32_16x16x32_bf16 v[68:71], v[148:151], v[180:183], v[68:71]
    ds_read_b128 v[128:131], v4 offset:1024
    buffer_load_dwordx4 v[224:227], v30, s[8:11], s20 offen offset:1024 sc1
    v_mfma_f32_16x16x32_bf16 v[88:91], v[148:151], v[184:187], v[88:91]
    ds_read_b128 v[132:135], v4 offset:2048
    v_mfma_f32_16x16x32_bf16 v[72:75], v[152:155], v[180:183], v[72:75]
    ds_read_b128 v[136:139], v4 offset:3072
    s_add_u32 s66, s66, 4096
    s_cmp_ge_u32 s66, s67
    s_cselect_b32 s66, s68, s66
    s_add_u32 s20, s66, s69
    buffer_load_dwordx4 v[228:231], v30, s[8:11], s66 offen offset:0 sc1
    v_mfma_f32_16x16x32_bf16 v[92:95], v[152:155], v[184:187], v[92:95]
    ds_read_b128 v[140:143], v4 offset:4096
    v_mfma_f32_16x16x32_bf16 v[76:79], v[156:159], v[180:183], v[76:79]
    v_mfma_f32_16x16x32_bf16 v[96:99], v[156:159], v[184:187], v[96:99]
    buffer_load_dwordx4 v[232:235], v30, s[8:11], s20 offen offset:0 sc1
    v_mfma_f32_16x16x32_bf16 v[80:83], v[160:163], v[180:183], v[80:83]
    v_mfma_f32_16x16x32_bf16 v[100:103], v[160:163], v[184:187], v[100:103]
    s_waitcnt vmcnt(10)
    s_waitcnt lgkmcnt(5)
    v_mfma_f32_16x16x32_bf16 v[64:67], v[104:107], v[188:191], v[64:67]
    v_mfma_f32_16x16x32_bf16 v[84:87], v[104:107], v[192:195], v[84:87]
    buffer_load_dwordx4 v[8:11], v30, s[8:11], s66 offen offset:1024 sc1
    ds_read_b128 v[144:147], v4 offset:5120
    v_mfma_f32_16x16x32_bf16 v[68:71], v[108:111], v[188:191], v[68:71]
    ds_read_b128 v[148:151], v4 offset:6144
    v_mfma_f32_16x16x32_bf16 v[88:91], v[108:111], v[192:195], v[88:91]
    buffer_load_dwordx4 v[12:15], v30, s[8:11], s20 offen offset:1024 sc1
    ds_read_b128 v[152:155], v4 offset:7168
    v_mfma_f32_16x16x32_bf16 v[72:75], v[112:115], v[188:191], v[72:75]
    ds_read_b128 v[156:159], v4 offset:8192
    v_mfma_f32_16x16x32_bf16 v[92:95], v[112:115], v[192:195], v[92:95]
    s_add_u32 s66, s66, 4096
    s_cmp_ge_u32 s66, s67
    s_cselect_b32 s66, s68, s66
    s_add_u32 s20, s66, s69
    buffer_load_dwordx4 v[16:19], v30, s[8:11], s66 offen offset:0 sc1
    ds_read_b128 v[160:163], v4 offset:9216
    v_mfma_f32_16x16x32_bf16 v[76:79], v[116:119], v[188:191], v[76:79]
    v_mfma_f32_16x16x32_bf16 v[96:99], v[116:119], v[192:195], v[96:99]
    v_mfma_f32_16x16x32_bf16 v[80:83], v[120:123], v[188:191], v[80:83]
    buffer_load_dwordx4 v[20:23], v30, s[8:11], s20 offen offset:0 sc1
    v_mfma_f32_16x16x32_bf16 v[100:103], v[120:123], v[192:195], v[100:103]
    s_waitcnt vmcnt(12)
    s_waitcnt lgkmcnt(5)
    v_mfma_f32_16x16x32_bf16 v[64:67], v[124:127], v[196:199], v[64:67]
    s_barrier
    buffer_load_dwordx4 v[24:27], v30, s[8:11], s66 offen offset:1024 sc1
    v_mfma_f32_16x16x32_bf16 v[84:87], v[124:127], v[200:203], v[84:87]
    ds_read_b128 v[104:107], v4 offset:20480
    v_mfma_f32_16x16x32_bf16 v[68:71], v[128:131], v[196:199], v[68:71]
    ds_read_b128 v[108:111], v4 offset:21504
    buffer_load_dwordx4 v[36:39], v30, s[8:11], s20 offen offset:1024 sc1
    v_mfma_f32_16x16x32_bf16 v[88:91], v[128:131], v[200:203], v[88:91]
    ds_read_b128 v[112:115], v4 offset:22528
    v_mfma_f32_16x16x32_bf16 v[72:75], v[132:135], v[196:199], v[72:75]
    ds_read_b128 v[116:119], v4 offset:23552
    s_add_u32 s66, s66, 4096
    s_cmp_ge_u32 s66, s67
    s_cselect_b32 s66, s68, s66
    s_add_u32 s20, s66, s69
    buffer_load_dwordx4 v[164:167], v30, s[8:11], s66 offen offset:0 sc1
    v_mfma_f32_16x16x32_bf16 v[92:95], v[132:135], v[200:203], v[92:95]
    ds_read_b128 v[120:123], v4 offset:24576
    v_mfma_f32_16x16x32_bf16 v[76:79], v[136:139], v[196:199], v[76:79]
    v_mfma_f32_16x16x32_bf16 v[96:99], v[136:139], v[200:203], v[96:99]
    buffer_load_dwordx4 v[168:171], v30, s[8:11], s20 offen offset:0 sc1
    v_mfma_f32_16x16x32_bf16 v[80:83], v[140:143], v[196:199], v[80:83]
    v_mfma_f32_16x16x32_bf16 v[100:103], v[140:143], v[200:203], v[100:103]
    s_waitcnt vmcnt(14)
    s_waitcnt lgkmcnt(5)
    v_mfma_f32_16x16x32_bf16 v[64:67], v[144:147], v[204:207], v[64:67]
    v_mfma_f32_16x16x32_bf16 v[84:87], v[144:147], v[208:211], v[84:87]
    buffer_load_dwordx4 v[172:175], v30, s[8:11], s66 offen offset:1024 sc1
    ds_read_b128 v[124:127], v4 offset:25600
    v_mfma_f32_16x16x32_bf16 v[68:71], v[148:151], v[204:207], v[68:71]
    ds_read_b128 v[128:131], v4 offset:26624
    v_mfma_f32_16x16x32_bf16 v[88:91], v[148:151], v[208:211], v[88:91]
    buffer_load_dwordx4 v[176:179], v30, s[8:11], s20 offen offset:1024 sc1
    ds_read_b128 v[132:135], v4 offset:27648
    v_mfma_f32_16x16x32_bf16 v[72:75], v[152:155], v[204:207], v[72:75]
    ds_read_b128 v[136:139], v4 offset:28672
    v_mfma_f32_16x16x32_bf16 v[92:95], v[152:155], v[208:211], v[92:95]
    s_add_u32 s66, s66, 4096
    s_cmp_ge_u32 s66, s67
    s_cselect_b32 s66, s68, s66
    s_add_u32 s20, s66, s69
    buffer_load_dwordx4 v[180:183], v30, s[8:11], s66 offen offset:0 sc1
    ds_read_b128 v[140:143], v4 offset:29696
    v_mfma_f32_16x16x32_bf16 v[76:79], v[156:159], v[204:207], v[76:79]
    v_mfma_f32_16x16x32_bf16 v[96:99], v[156:159], v[208:211], v[96:99]
    v_mfma_f32_16x16x32_bf16 v[80:83], v[160:163], v[204:207], v[80:83]
    buffer_load_dwordx4 v[184:187], v30, s[8:11], s20 offen offset:0 sc1
    v_mfma_f32_16x16x32_bf16 v[100:103], v[160:163], v[208:211], v[100:103]
    s_waitcnt vmcnt(16)
    s_waitcnt lgkmcnt(5)
    v_mfma_f32_16x16x32_bf16 v[64:67], v[104:107], v[212:215], v[64:67]
    s_barrier
    buffer_load_dwordx4 v[188:191], v30, s[8:11], s66 offen offset:1024 sc1
    v_mfma_f32_16x16x32_bf16 v[84:87], v[104:107], v[216:219], v[84:87]
    ds_read_b128 v[144:147], v4 offset:40960
    v_mfma_f32_16x16x32_bf16 v[68:71], v[108:111], v[212:215], v[68:71]
    ds_read_b128 v[148:151], v4 offset:41984
    buffer_load_dwordx4 v[192:195], v30, s[8:11], s20 offen offset:1024 sc1
    v_mfma_f32_16x16x32_bf16 v[88:91], v[108:111], v[216:219], v[88:91]
    ds_read_b128 v[152:155], v4 offset:43008
    v_mfma_f32_16x16x32_bf16 v[72:75], v[112:115], v[212:215], v[72:75]
    ds_read_b128 v[156:159], v4 offset:44032
    s_add_u32 s66, s66, 4096
    s_cmp_ge_u32 s66, s67
    s_cselect_b32 s66, s68, s66
    s_add_u32 s20, s66, s69
    buffer_load_dwordx4 v[196:199], v30, s[8:11], s66 offen offset:0 sc1
    v_mfma_f32_16x16x32_bf16 v[92:95], v[112:115], v[216:219], v[92:95]
    ds_read_b128 v[160:163], v4 offset:45056
    v_mfma_f32_16x16x32_bf16 v[76:79], v[116:119], v[212:215], v[76:79]
    v_mfma_f32_16x16x32_bf16 v[96:99], v[116:119], v[216:219], v[96:99]
    buffer_load_dwordx4 v[200:203], v30, s[8:11], s20 offen offset:0 sc1
    v_mfma_f32_16x16x32_bf16 v[80:83], v[120:123], v[212:215], v[80:83]
    v_mfma_f32_16x16x32_bf16 v[100:103], v[120:123], v[216:219], v[100:103]
    s_waitcnt vmcnt(18)
    s_waitcnt lgkmcnt(5)
    v_mfma_f32_16x16x32_bf16 v[64:67], v[124:127], v[220:223], v[64:67]
    v_mfma_f32_16x16x32_bf16 v[84:87], v[124:127], v[224:227], v[84:87]
    buffer_load_dwordx4 v[204:207], v30, s[8:11], s66 offen offset:1024 sc1
    ds_read_b128 v[104:107], v4 offset:46080
    v_mfma_f32_16x16x32_bf16 v[68:71], v[128:131], v[220:223], v[68:71]
    ds_read_b128 v[108:111], v4 offset:47104
    v_mfma_f32_16x16x32_bf16 v[88:91], v[128:131], v[224:227], v[88:91]
    buffer_load_dwordx4 v[208:211], v30, s[8:11], s20 offen offset:1024 sc1
    ds_read_b128 v[112:115], v4 offset:48128
    v_mfma_f32_16x16x32_bf16 v[72:75], v[132:135], v[220:223], v[72:75]
    ds_read_b128 v[116:119], v4 offset:49152
    v_mfma_f32_16x16x32_bf16 v[92:95], v[132:135], v[224:227], v[92:95]
    s_add_u32 s66, s66, 4096
    s_cmp_ge_u32 s66, s67
    s_cselect_b32 s66, s68, s66
    s_add_u32 s20, s66, s69
    buffer_load_dwordx4 v[212:215], v30, s[8:11], s66 offen offset:0 sc1
    ds_read_b128 v[120:123], v4 offset:50176
    v_mfma_f32_16x16x32_bf16 v[76:79], v[136:139], v[220:223], v[76:79]
    v_mfma_f32_16x16x32_bf16 v[96:99], v[136:139], v[224:227], v[96:99]
    v_mfma_f32_16x16x32_bf16 v[80:83], v[140:143], v[220:223], v[80:83]
    buffer_load_dwordx4 v[216:219], v30, s[8:11], s20 offen offset:0 sc1
    v_mfma_f32_16x16x32_bf16 v[100:103], v[140:143], v[224:227], v[100:103]
    s_waitcnt vmcnt(20)
    s_waitcnt lgkmcnt(5)
    v_mfma_f32_16x16x32_bf16 v[64:67], v[144:147], v[228:231], v[64:67]
    s_barrier
    v_mfma_f32_16x16x32_bf16 v[84:87], v[144:147], v[232:235], v[84:87]
    ds_read_b128 v[124:127], v4 offset:61440
    buffer_load_dwordx4 v[220:223], v30, s[8:11], s66 offen offset:1024 sc1
    v_mfma_f32_16x16x32_bf16 v[68:71], v[148:151], v[228:231], v[68:71]
    ds_read_b128 v[128:131], v4 offset:62464
    v_mfma_f32_16x16x32_bf16 v[88:91], v[148:151], v[232:235], v[88:91]
    ds_read_b128 v[132:135], v4 offset:63488
    v_mfma_f32_16x16x32_bf16 v[72:75], v[152:155], v[228:231], v[72:75]
    ds_read_b128 v[136:139], v4 offset:64512
    v_mfma_f32_16x16x32_bf16 v[92:95], v[152:155], v[232:235], v[92:95]
    ds_read_b128 v[140:143], v5 offset:0
    buffer_load_dwordx4 v[224:227], v30, s[8:11], s20 offen offset:1024 sc1
    v_mfma_f32_16x16x32_bf16 v[76:79], v[156:159], v[228:231], v[76:79]
    v_mfma_f32_16x16x32_bf16 v[96:99], v[156:159], v[232:235], v[96:99]
    v_mfma_f32_16x16x32_bf16 v[80:83], v[160:163], v[228:231], v[80:83]
    v_mfma_f32_16x16x32_bf16 v[100:103], v[160:163], v[232:235], v[100:103]
    s_waitcnt vmcnt(20)
    s_waitcnt lgkmcnt(5)
    v_mfma_f32_16x16x32_bf16 v[64:67], v[104:107], v[8:11], v[64:67]
    v_mfma_f32_16x16x32_bf16 v[84:87], v[104:107], v[12:15], v[84:87]
    ds_read_b128 v[144:147], v5 offset:1024
    v_mfma_f32_16x16x32_bf16 v[68:71], v[108:111], v[8:11], v[68:71]
    s_add_u32 s66, s66, 4096
    s_cmp_ge_u32 s66, s67
    s_cselect_b32 s66, s68, s66
    s_add_u32 s20, s66, s69
    buffer_load_dwordx4 v[228:231], v30, s[8:11], s66 offen offset:0 sc1
    ds_read_b128 v[148:151], v5 offset:2048
    v_mfma_f32_16x16x32_bf16 v[88:91], v[108:111], v[12:15], v[88:91]
    ds_read_b128 v[152:155], v5 offset:3072
    v_mfma_f32_16x16x32_bf16 v[72:75], v[112:115], v[8:11], v[72:75]
    ds_read_b128 v[156:159], v5 offset:4096
    v_mfma_f32_16x16x32_bf16 v[92:95], v[112:115], v[12:15], v[92:95]
    ds_read_b128 v[160:163], v5 offset:5120
    v_mfma_f32_16x16x32_bf16 v[76:79], v[116:119], v[8:11], v[76:79]
    buffer_load_dwordx4 v[232:235], v30, s[8:11], s20 offen offset:0 sc1
    v_mfma_f32_16x16x32_bf16 v[96:99], v[116:119], v[12:15], v[96:99]
    v_mfma_f32_16x16x32_bf16 v[80:83], v[120:123], v[8:11], v[80:83]
    v_mfma_f32_16x16x32_bf16 v[100:103], v[120:123], v[12:15], v[100:103]
    s_waitcnt vmcnt(20)
    s_waitcnt lgkmcnt(5)
    v_mfma_f32_16x16x32_bf16 v[64:67], v[124:127], v[16:19], v[64:67]
    s_barrier
    v_mfma_f32_16x16x32_bf16 v[84:87], v[124:127], v[20:23], v[84:87]
    ds_read_b128 v[104:107], v5 offset:16384
    buffer_load_dwordx4 v[8:11], v30, s[8:11], s66 offen offset:1024 sc1
    v_mfma_f32_16x16x32_bf16 v[68:71], v[128:131], v[16:19], v[68:71]
    ds_read_b128 v[108:111], v5 offset:17408
    v_mfma_f32_16x16x32_bf16 v[88:91], v[128:131], v[20:23], v[88:91]
    ds_read_b128 v[112:115], v5 offset:18432
    v_mfma_f32_16x16x32_bf16 v[72:75], v[132:135], v[16:19], v[72:75]
    ds_read_b128 v[116:119], v5 offset:19456
    v_mfma_f32_16x16x32_bf16 v[92:95], v[132:135], v[20:23], v[92:95]
    ds_read_b128 v[120:123], v5 offset:20480
    buffer_load_dwordx4 v[12:15], v30, s[8:11], s20 offen offset:1024 sc1
    v_mfma_f32_16x16x32_bf16 v[76:79], v[136:139], v[16:19], v[76:79]
    v_mfma_f32_16x16x32_bf16 v[96:99], v[136:139], v[20:23], v[96:99]
    v_mfma_f32_16x16x32_bf16 v[80:83], v[140:143], v[16:19], v[80:83]
    v_mfma_f32_16x16x32_bf16 v[100:103], v[140:143], v[20:23], v[100:103]
    s_waitcnt vmcnt(20)
    s_waitcnt lgkmcnt(5)
    v_mfma_f32_16x16x32_bf16 v[64:67], v[144:147], v[24:27], v[64:67]
    v_mfma_f32_16x16x32_bf16 v[84:87], v[144:147], v[36:39], v[84:87]
    ds_read_b128 v[124:127], v5 offset:21504
    v_mfma_f32_16x16x32_bf16 v[68:71], v[148:151], v[24:27], v[68:71]
    s_add_u32 s66, s66, 4096
    s_cmp_ge_u32 s66, s67
    s_cselect_b32 s66, s68, s66
    s_add_u32 s20, s66, s69
    buffer_load_dwordx4 v[16:19], v30, s[8:11], s66 offen offset:0 sc1
    ds_read_b128 v[128:131], v5 offset:22528
    v_mfma_f32_16x16x32_bf16 v[88:91], v[148:151], v[36:39], v[88:91]
    ds_read_b128 v[132:135], v5 offset:23552
    v_mfma_f32_16x16x32_bf16 v[72:75], v[152:155], v[24:27], v[72:75]
    ds_read_b128 v[136:139], v5 offset:24576
    v_mfma_f32_16x16x32_bf16 v[92:95], v[152:155], v[36:39], v[92:95]
    ds_read_b128 v[140:143], v5 offset:25600
    v_mfma_f32_16x16x32_bf16 v[76:79], v[156:159], v[24:27], v[76:79]
    buffer_load_dwordx4 v[20:23], v30, s[8:11], s20 offen offset:0 sc1
    v_mfma_f32_16x16x32_bf16 v[96:99], v[156:159], v[36:39], v[96:99]
    v_mfma_f32_16x16x32_bf16 v[80:83], v[160:163], v[24:27], v[80:83]
    v_mfma_f32_16x16x32_bf16 v[100:103], v[160:163], v[36:39], v[100:103]
    s_waitcnt vmcnt(20)
    s_waitcnt lgkmcnt(5)
    v_mfma_f32_16x16x32_bf16 v[64:67], v[104:107], v[164:167], v[64:67]
    s_barrier
    v_mfma_f32_16x16x32_bf16 v[84:87], v[104:107], v[168:171], v[84:87]
    ds_read_b128 v[144:147], v5 offset:36864
    buffer_load_dwordx4 v[24:27], v30, s[8:11], s66 offen offset:1024 sc1
    v_mfma_f32_16x16x32_bf16 v[68:71], v[108:111], v[164:167], v[68:71]
    ds_read_b128 v[148:151], v5 offset:37888
    v_mfma_f32_16x16x32_bf16 v[88:91], v[108:111], v[168:171], v[88:91]
    ds_read_b128 v[152:155], v5 offset:38912
    v_mfma_f32_16x16x32_bf16 v[72:75], v[112:115], v[164:167], v[72:75]
    ds_read_b128 v[156:159], v5 offset:39936
    v_mfma_f32_16x16x32_bf16 v[92:95], v[112:115], v[168:171], v[92:95]
    ds_read_b128 v[160:163], v5 offset:40960
    buffer_load_dwordx4 v[36:39], v30, s[8:11], s20 offen offset:1024 sc1
    v_mfma_f32_16x16x32_bf16 v[76:79], v[116:119], v[164:167], v[76:79]
    v_mfma_f32_16x16x32_bf16 v[96:99], v[116:119], v[168:171], v[96:99]
    v_mfma_f32_16x16x32_bf16 v[80:83], v[120:123], v[164:167], v[80:83]
    v_mfma_f32_16x16x32_bf16 v[100:103], v[120:123], v[168:171], v[100:103]
    s_waitcnt vmcnt(20)
    s_waitcnt lgkmcnt(5)
    v_mfma_f32_16x16x32_bf16 v[64:67], v[124:127], v[172:175], v[64:67]
    v_mfma_f32_16x16x32_bf16 v[84:87], v[124:127], v[176:179], v[84:87]
    ds_read_b128 v[104:107], v5 offset:41984
    v_mfma_f32_16x16x32_bf16 v[68:71], v[128:131], v[172:175], v[68:71]
    s_add_u32 s66, s66, 4096
    s_cmp_ge_u32 s66, s67
    s_cselect_b32 s66, s68, s66
    s_add_u32 s20, s66, s69
    buffer_load_dwordx4 v[164:167], v30, s[8:11], s66 offen offset:0 sc1
    ds_read_b128 v[108:111], v5 offset:43008
    v_mfma_f32_16x16x32_bf16 v[88:91], v[128:131], v[176:179], v[88:91]
    ds_read_b128 v[112:115], v5 offset:44032
    v_mfma_f32_16x16x32_bf16 v[72:75], v[132:135], v[172:175], v[72:75]
    ds_read_b128 v[116:119], v5 offset:45056
    v_mfma_f32_16x16x32_bf16 v[92:95], v[132:135], v[176:179], v[92:95]
    ds_read_b128 v[120:123], v5 offset:46080
    v_mfma_f32_16x16x32_bf16 v[76:79], v[136:139], v[172:175], v[76:79]
    buffer_load_dwordx4 v[168:171], v30, s[8:11], s20 offen offset:0 sc1
    v_mfma_f32_16x16x32_bf16 v[96:99], v[136:139], v[176:179], v[96:99]
    v_mfma_f32_16x16x32_bf16 v[80:83], v[140:143], v[172:175], v[80:83]
    v_mfma_f32_16x16x32_bf16 v[100:103], v[140:143], v[176:179], v[100:103]
    s_waitcnt vmcnt(20)
    s_waitcnt lgkmcnt(5)
    v_mfma_f32_16x16x32_bf16 v[64:67], v[144:147], v[180:183], v[64:67]
    s_barrier
    v_mfma_f32_16x16x32_bf16 v[84:87], v[144:147], v[184:187], v[84:87]
    ds_read_b128 v[124:127], v5 offset:57344
    buffer_load_dwordx4 v[172:175], v30, s[8:11], s66 offen offset:1024 sc1
    v_mfma_f32_16x16x32_bf16 v[68:71], v[148:151], v[180:183], v[68:71]
    ds_read_b128 v[128:131], v5 offset:58368
    v_mfma_f32_16x16x32_bf16 v[88:91], v[148:151], v[184:187], v[88:91]
    ds_read_b128 v[132:135], v5 offset:59392
    v_mfma_f32_16x16x32_bf16 v[72:75], v[152:155], v[180:183], v[72:75]
    ds_read_b128 v[136:139], v5 offset:60416
    v_mfma_f32_16x16x32_bf16 v[92:95], v[152:155], v[184:187], v[92:95]
    ds_read_b128 v[140:143], v5 offset:61440
    buffer_load_dwordx4 v[176:179], v30, s[8:11], s20 offen offset:1024 sc1
    v_mfma_f32_16x16x32_bf16 v[76:79], v[156:159], v[180:183], v[76:79]
    v_mfma_f32_16x16x32_bf16 v[96:99], v[156:159], v[184:187], v[96:99]
    v_mfma_f32_16x16x32_bf16 v[80:83], v[160:163], v[180:183], v[80:83]
    v_mfma_f32_16x16x32_bf16 v[100:103], v[160:163], v[184:187], v[100:103]
    s_waitcnt vmcnt(20)
    s_waitcnt lgkmcnt(5)
    v_mfma_f32_16x16x32_bf16 v[64:67], v[104:107], v[188:191], v[64:67]
    v_mfma_f32_16x16x32_bf16 v[84:87], v[104:107], v[192:195], v[84:87]
    ds_read_b128 v[144:147], v5 offset:62464
    v_mfma_f32_16x16x32_bf16 v[68:71], v[108:111], v[188:191], v[68:71]
    s_mov_b32 s66, s70
    s_add_u32 s20, s66, s69
    buffer_load_dwordx4 v[180:183], v30, s[8:11], s66 offen offset:0 sc1
    ds_read_b128 v[148:151], v5 offset:63488
    v_mfma_f32_16x16x32_bf16 v[88:91], v[108:111], v[192:195], v[88:91]
    ds_read_b128 v[152:155], v5 offset:64512
    v_mfma_f32_16x16x32_bf16 v[72:75], v[112:115], v[188:191], v[72:75]
    ds_read_b128 v[156:159], v6 offset:0
    v_mfma_f32_16x16x32_bf16 v[92:95], v[112:115], v[192:195], v[92:95]
    ds_read_b128 v[160:163], v6 offset:1024
    v_mfma_f32_16x16x32_bf16 v[76:79], v[116:119], v[188:191], v[76:79]
    buffer_load_dwordx4 v[184:187], v30, s[8:11], s20 offen offset:0 sc1
    v_mfma_f32_16x16x32_bf16 v[96:99], v[116:119], v[192:195], v[96:99]
    v_mfma_f32_16x16x32_bf16 v[80:83], v[120:123], v[188:191], v[80:83]
    v_mfma_f32_16x16x32_bf16 v[100:103], v[120:123], v[192:195], v[100:103]
    s_waitcnt vmcnt(20)
    s_waitcnt lgkmcnt(5)
    v_mfma_f32_16x16x32_bf16 v[64:67], v[124:127], v[196:199], v[64:67]
    s_barrier
    v_mfma_f32_16x16x32_bf16 v[84:87], v[124:127], v[200:203], v[84:87]
    ds_read_b128 v[104:107], v4 offset:0
    v_mfma_f32_16x16x32_bf16 v[68:71], v[128:131], v[196:199], v[68:71]
    ds_read_b128 v[108:111], v4 offset:1024
    v_mfma_f32_16x16x32_bf16 v[88:91], v[128:131], v[200:203], v[88:91]
    ds_read_b128 v[112:115], v4 offset:2048
    v_mfma_f32_16x16x32_bf16 v[72:75], v[132:135], v[196:199], v[72:75]
    ds_read_b128 v[116:119], v4 offset:3072
    v_mfma_f32_16x16x32_bf16 v[92:95], v[132:135], v[200:203], v[92:95]
    ds_read_b128 v[120:123], v4 offset:4096
    v_mfma_f32_16x16x32_bf16 v[76:79], v[136:139], v[196:199], v[76:79]
    v_mfma_f32_16x16x32_bf16 v[96:99], v[136:139], v[200:203], v[96:99]
    v_mfma_f32_16x16x32_bf16 v[80:83], v[140:143], v[196:199], v[80:83]
    v_mfma_f32_16x16x32_bf16 v[100:103], v[140:143], v[200:203], v[100:103]
    s_waitcnt vmcnt(18)
    s_waitcnt lgkmcnt(5)
    v_mfma_f32_16x16x32_bf16 v[64:67], v[144:147], v[204:207], v[64:67]
    v_mfma_f32_16x16x32_bf16 v[84:87], v[144:147], v[208:211], v[84:87]
    ds_read_b128 v[124:127], v4 offset:5120
    v_mfma_f32_16x16x32_bf16 v[68:71], v[148:151], v[204:207], v[68:71]
    ds_read_b128 v[128:131], v4 offset:6144
    v_mfma_f32_16x16x32_bf16 v[88:91], v[148:151], v[208:211], v[88:91]
    ds_read_b128 v[132:135], v4 offset:7168
    v_mfma_f32_16x16x32_bf16 v[72:75], v[152:155], v[204:207], v[72:75]
    ds_read_b128 v[136:139], v4 offset:8192
    v_mfma_f32_16x16x32_bf16 v[92:95], v[152:155], v[208:211], v[92:95]
    ds_read_b128 v[140:143], v4 offset:9216
    v_mfma_f32_16x16x32_bf16 v[76:79], v[156:159], v[204:207], v[76:79]
    v_mfma_f32_16x16x32_bf16 v[96:99], v[156:159], v[208:211], v[96:99]
    v_mfma_f32_16x16x32_bf16 v[80:83], v[160:163], v[204:207], v[80:83]
    v_mfma_f32_16x16x32_bf16 v[100:103], v[160:163], v[208:211], v[100:103]
    s_waitcnt vmcnt(16)
    s_waitcnt lgkmcnt(5)
    v_mfma_f32_16x16x32_bf16 v[64:67], v[104:107], v[212:215], v[64:67]
    s_barrier
    v_mfma_f32_16x16x32_bf16 v[84:87], v[104:107], v[216:219], v[84:87]
    ds_read_b128 v[144:147], v4 offset:20480
    v_mfma_f32_16x16x32_bf16 v[68:71], v[108:111], v[212:215], v[68:71]
    ds_read_b128 v[148:151], v4 offset:21504
    v_mfma_f32_16x16x32_bf16 v[88:91], v[108:111], v[216:219], v[88:91]
    ds_read_b128 v[152:155], v4 offset:22528
    v_mfma_f32_16x16x32_bf16 v[72:75], v[112:115], v[212:215], v[72:75]
    ds_read_b128 v[156:159], v4 offset:23552
    v_mfma_f32_16x16x32_bf16 v[92:95], v[112:115], v[216:219], v[92:95]
    ds_read_b128 v[160:163], v4 offset:24576
    v_mfma_f32_16x16x32_bf16 v[76:79], v[116:119], v[212:215], v[76:79]
    v_mfma_f32_16x16x32_bf16 v[96:99], v[116:119], v[216:219], v[96:99]
    v_mfma_f32_16x16x32_bf16 v[80:83], v[120:123], v[212:215], v[80:83]
    v_mfma_f32_16x16x32_bf16 v[100:103], v[120:123], v[216:219], v[100:103]
    s_waitcnt vmcnt(14)
    s_waitcnt lgkmcnt(5)
    v_mfma_f32_16x16x32_bf16 v[64:67], v[124:127], v[220:223], v[64:67]
    v_mfma_f32_16x16x32_bf16 v[84:87], v[124:127], v[224:227], v[84:87]
    ds_read_b128 v[104:107], v4 offset:25600
    v_mfma_f32_16x16x32_bf16 v[68:71], v[128:131], v[220:223], v[68:71]
    ds_read_b128 v[108:111], v4 offset:26624
    v_mfma_f32_16x16x32_bf16 v[88:91], v[128:131], v[224:227], v[88:91]
    ds_read_b128 v[112:115], v4 offset:27648
    v_mfma_f32_16x16x32_bf16 v[72:75], v[132:135], v[220:223], v[72:75]
    ds_read_b128 v[116:119], v4 offset:28672
    v_mfma_f32_16x16x32_bf16 v[92:95], v[132:135], v[224:227], v[92:95]
    ds_read_b128 v[120:123], v4 offset:29696
    v_mfma_f32_16x16x32_bf16 v[76:79], v[136:139], v[220:223], v[76:79]
    v_mfma_f32_16x16x32_bf16 v[96:99], v[136:139], v[224:227], v[96:99]
    v_mfma_f32_16x16x32_bf16 v[80:83], v[140:143], v[220:223], v[80:83]
    v_mfma_f32_16x16x32_bf16 v[100:103], v[140:143], v[224:227], v[100:103]
    s_waitcnt vmcnt(12)
    s_waitcnt lgkmcnt(5)
    v_mfma_f32_16x16x32_bf16 v[64:67], v[144:147], v[228:231], v[64:67]
    v_mfma_f32_16x16x32_bf16 v[84:87], v[144:147], v[232:235], v[84:87]
    ds_read_b128 v[124:127], v4 offset:40960
    v_mfma_f32_16x16x32_bf16 v[68:71], v[148:151], v[228:231], v[68:71]
    ds_read_b128 v[128:131], v4 offset:41984
    v_mfma_f32_16x16x32_bf16 v[88:91], v[148:151], v[232:235], v[88:91]
    ds_read_b128 v[132:135], v4 offset:43008
    v_mfma_f32_16x16x32_bf16 v[72:75], v[152:155], v[228:231], v[72:75]
    ds_read_b128 v[136:139], v4 offset:44032
    v_mfma_f32_16x16x32_bf16 v[92:95], v[152:155], v[232:235], v[92:95]
    ds_read_b128 v[140:143], v4 offset:45056
    v_mfma_f32_16x16x32_bf16 v[76:79], v[156:159], v[228:231], v[76:79]
    v_mfma_f32_16x16x32_bf16 v[96:99], v[156:159], v[232:235], v[96:99]
    v_mfma_f32_16x16x32_bf16 v[80:83], v[160:163], v[228:231], v[80:83]
    v_mfma_f32_16x16x32_bf16 v[100:103], v[160:163], v[232:235], v[100:103]
    s_waitcnt vmcnt(10)
    s_waitcnt lgkmcnt(5)
    v_mfma_f32_16x16x32_bf16 v[64:67], v[104:107], v[8:11], v[64:67]
    v_mfma_f32_16x16x32_bf16 v[84:87], v[104:107], v[12:15], v[84:87]
    ds_read_b128 v[144:147], v4 offset:46080
    v_mfma_f32_16x16x32_bf16 v[68:71], v[108:111], v[8:11], v[68:71]
    ds_read_b128 v[148:151], v4 offset:47104
    v_mfma_f32_16x16x32_bf16 v[88:91], v[108:111], v[12:15], v[88:91]
    ds_read_b128 v[152:155], v4 offset:48128
    v_mfma_f32_16x16x32_bf16 v[72:75], v[112:115], v[8:11], v[72:75]
    ds_read_b128 v[156:159], v4 offset:49152
    v_mfma_f32_16x16x32_bf16 v[92:95], v[112:115], v[12:15], v[92:95]
    ds_read_b128 v[160:163], v4 offset:50176
    v_mfma_f32_16x16x32_bf16 v[76:79], v[116:119], v[8:11], v[76:79]
    v_mfma_f32_16x16x32_bf16 v[96:99], v[116:119], v[12:15], v[96:99]
    v_mfma_f32_16x16x32_bf16 v[80:83], v[120:123], v[8:11], v[80:83]
    v_mfma_f32_16x16x32_bf16 v[100:103], v[120:123], v[12:15], v[100:103]
    s_waitcnt vmcnt(8)
    s_waitcnt lgkmcnt(5)
    v_mfma_f32_16x16x32_bf16 v[64:67], v[124:127], v[16:19], v[64:67]
    v_mfma_f32_16x16x32_bf16 v[84:87], v[124:127], v[20:23], v[84:87]
    ds_read_b128 v[104:107], v4 offset:61440
    v_mfma_f32_16x16x32_bf16 v[68:71], v[128:131], v[16:19], v[68:71]
    ds_read_b128 v[108:111], v4 offset:62464
    v_mfma_f32_16x16x32_bf16 v[88:91], v[128:131], v[20:23], v[88:91]
    ds_read_b128 v[112:115], v4 offset:63488
    v_mfma_f32_16x16x32_bf16 v[72:75], v[132:135], v[16:19], v[72:75]
    ds_read_b128 v[116:119], v4 offset:64512
    v_mfma_f32_16x16x32_bf16 v[92:95], v[132:135], v[20:23], v[92:95]
    ds_read_b128 v[120:123], v5 offset:0
    v_mfma_f32_16x16x32_bf16 v[76:79], v[136:139], v[16:19], v[76:79]
    v_mfma_f32_16x16x32_bf16 v[96:99], v[136:139], v[20:23], v[96:99]
    v_mfma_f32_16x16x32_bf16 v[80:83], v[140:143], v[16:19], v[80:83]
    v_mfma_f32_16x16x32_bf16 v[100:103], v[140:143], v[20:23], v[100:103]
    s_waitcnt vmcnt(6)
    s_waitcnt lgkmcnt(5)
    v_mfma_f32_16x16x32_bf16 v[64:67], v[144:147], v[24:27], v[64:67]
    v_mfma_f32_16x16x32_bf16 v[84:87], v[144:147], v[36:39], v[84:87]
    ds_read_b128 v[124:127], v5 offset:1024
    v_mfma_f32_16x16x32_bf16 v[68:71], v[148:151], v[24:27], v[68:71]
    ds_read_b128 v[128:131], v5 offset:2048
    v_mfma_f32_16x16x32_bf16 v[88:91], v[148:151], v[36:39], v[88:91]
    ds_read_b128 v[132:135], v5 offset:3072
    v_mfma_f32_16x16x32_bf16 v[72:75], v[152:155], v[24:27], v[72:75]
    ds_read_b128 v[136:139], v5 offset:4096
    v_mfma_f32_16x16x32_bf16 v[92:95], v[152:155], v[36:39], v[92:95]
    ds_read_b128 v[140:143], v5 offset:5120
    v_mfma_f32_16x16x32_bf16 v[76:79], v[156:159], v[24:27], v[76:79]
    v_mfma_f32_16x16x32_bf16 v[96:99], v[156:159], v[36:39], v[96:99]
    v_mfma_f32_16x16x32_bf16 v[80:83], v[160:163], v[24:27], v[80:83]
    v_mfma_f32_16x16x32_bf16 v[100:103], v[160:163], v[36:39], v[100:103]
    s_waitcnt vmcnt(4)
    s_waitcnt lgkmcnt(5)
    v_mfma_f32_16x16x32_bf16 v[64:67], v[104:107], v[164:167], v[64:67]
    v_mfma_f32_16x16x32_bf16 v[84:87], v[104:107], v[168:171], v[84:87]
    ds_read_b128 v[144:147], v7 offset:16384
    v_mfma_f32_16x16x32_bf16 v[68:71], v[108:111], v[164:167], v[68:71]
    ds_read_b128 v[148:151], v7 offset:17408
    v_mfma_f32_16x16x32_bf16 v[88:91], v[108:111], v[168:171], v[88:91]
    ds_read_b128 v[152:155], v7 offset:18432
    v_mfma_f32_16x16x32_bf16 v[72:75], v[112:115], v[164:167], v[72:75]
    ds_read_b128 v[156:159], v7 offset:19456
    v_mfma_f32_16x16x32_bf16 v[92:95], v[112:115], v[168:171], v[92:95]
    ds_read_b128 v[160:163], v7 offset:20480
    v_mfma_f32_16x16x32_bf16 v[76:79], v[116:119], v[164:167], v[76:79]
    v_mfma_f32_16x16x32_bf16 v[96:99], v[116:119], v[168:171], v[96:99]
    v_mfma_f32_16x16x32_bf16 v[80:83], v[120:123], v[164:167], v[80:83]
    v_mfma_f32_16x16x32_bf16 v[100:103], v[120:123], v[168:171], v[100:103]
    s_waitcnt vmcnt(2)
    s_waitcnt lgkmcnt(5)
    v_mfma_f32_16x16x32_bf16 v[64:67], v[124:127], v[172:175], v[64:67]
    v_mfma_f32_16x16x32_bf16 v[84:87], v[124:127], v[176:179], v[84:87]
    v_mfma_f32_16x16x32_bf16 v[68:71], v[128:131], v[172:175], v[68:71]
    v_mfma_f32_16x16x32_bf16 v[88:91], v[128:131], v[176:179], v[88:91]
    v_mfma_f32_16x16x32_bf16 v[72:75], v[132:135], v[172:175], v[72:75]
    v_mfma_f32_16x16x32_bf16 v[92:95], v[132:135], v[176:179], v[92:95]
    v_mfma_f32_16x16x32_bf16 v[76:79], v[136:139], v[172:175], v[76:79]
    v_mfma_f32_16x16x32_bf16 v[96:99], v[136:139], v[176:179], v[96:99]
    v_mfma_f32_16x16x32_bf16 v[80:83], v[140:143], v[172:175], v[80:83]
    v_mfma_f32_16x16x32_bf16 v[100:103], v[140:143], v[176:179], v[100:103]
    s_waitcnt vmcnt(0)
    s_waitcnt lgkmcnt(0)
    v_mfma_f32_16x16x32_bf16 v[64:67], v[144:147], v[180:183], v[64:67]
    v_mfma_f32_16x16x32_bf16 v[84:87], v[144:147], v[184:187], v[84:87]
    v_mfma_f32_16x16x32_bf16 v[68:71], v[148:151], v[180:183], v[68:71]
    v_mfma_f32_16x16x32_bf16 v[88:91], v[148:151], v[184:187], v[88:91]
    v_mfma_f32_16x16x32_bf16 v[72:75], v[152:155], v[180:183], v[72:75]
    v_mfma_f32_16x16x32_bf16 v[92:95], v[152:155], v[184:187], v[92:95]
    v_mfma_f32_16x16x32_bf16 v[76:79], v[156:159], v[180:183], v[76:79]
    v_mfma_f32_16x16x32_bf16 v[96:99], v[156:159], v[184:187], v[96:99]
    v_mfma_f32_16x16x32_bf16 v[80:83], v[160:163], v[180:183], v[80:83]
    v_mfma_f32_16x16x32_bf16 v[100:103], v[160:163], v[184:187], v[100:103]
    s_xor_b32 s3, s22, 1
    s_mul_i32 s3, s3, 5120
    v_add_u32 v4, s3, v31
    s_mul_i32 s3, s22, 5120
    v_add_u32 v5, s3, v31
    s_nop 7
    ds_write_b128 v4, v[84:87] offset:36864
    ds_write_b128 v4, v[88:91] offset:37888
    ds_write_b128 v4, v[92:95] offset:38912
    ds_write_b128 v4, v[96:99] offset:39936
    ds_write_b128 v4, v[100:103] offset:40960
    s_waitcnt lgkmcnt(0)
    s_barrier
    ds_read_b128 v[8:11], v5 offset:36864
    ds_read_b128 v[12:15], v5 offset:37888
    ds_read_b128 v[16:19], v5 offset:38912
    ds_read_b128 v[20:23], v5 offset:39936
    ds_read_b128 v[24:27], v5 offset:40960
    v_lshlrev_b32 v84, 16, v236
    v_and_b32 v85, 0xffff0000, v236
    v_lshlrev_b32 v86, 16, v237
    v_and_b32 v87, 0xffff0000, v237
    v_lshlrev_b32 v88, 16, v238
    v_and_b32 v89, 0xffff0000, v238
    v_lshlrev_b32 v90, 16, v239
    v_and_b32 v91, 0xffff0000, v239
    v_lshlrev_b32 v92, 16, v240
    v_and_b32 v93, 0xffff0000, v240
    v_lshlrev_b32 v94, 16, v241
    v_and_b32 v95, 0xffff0000, v241
    v_lshlrev_b32 v96, 16, v242
    v_and_b32 v97, 0xffff0000, v242
    v_lshlrev_b32 v98, 16, v243
    v_and_b32 v99, 0xffff0000, v243
    v_lshlrev_b32 v100, 16, v244
    v_and_b32 v101, 0xffff0000, v244
    v_lshlrev_b32 v102, 16, v245
    v_and_b32 v103, 0xffff0000, v245
    s_waitcnt lgkmcnt(0)
    v_pk_add_f32 v[8:9], v[8:9], v[64:65]
    v_pk_add_f32 v[10:11], v[10:11], v[66:67]
    v_pk_add_f32 v[12:13], v[12:13], v[68:69]
    v_pk_add_f32 v[14:15], v[14:15], v[70:71]
    v_pk_add_f32 v[16:17], v[16:17], v[72:73]
    v_pk_add_f32 v[18:19], v[18:19], v[74:75]
    v_pk_add_f32 v[20:21], v[20:21], v[76:77]
    v_pk_add_f32 v[22:23], v[22:23], v[78:79]
    v_pk_add_f32 v[24:25], v[24:25], v[80:81]
    v_pk_add_f32 v[26:27], v[26:27], v[82:83]
    v_lshlrev_b32 v64, 16, v246
    v_and_b32 v65, 0xffff0000, v246
    v_lshlrev_b32 v66, 16, v247
    v_and_b32 v67, 0xffff0000, v247
    v_lshlrev_b32 v68, 16, v248
    v_and_b32 v69, 0xffff0000, v248
    v_lshlrev_b32 v70, 16, v249
    v_and_b32 v71, 0xffff0000, v249
    v_lshlrev_b32 v72, 16, v250
    v_and_b32 v73, 0xffff0000, v250
    v_lshlrev_b32 v74, 16, v251
    v_and_b32 v75, 0xffff0000, v251
    v_lshlrev_b32 v76, 16, v252
    v_and_b32 v77, 0xffff0000, v252
    v_lshlrev_b32 v78, 16, v253
    v_and_b32 v79, 0xffff0000, v253
    v_lshlrev_b32 v80, 16, v254
    v_and_b32 v81, 0xffff0000, v254
    v_lshlrev_b32 v82, 16, v255
    v_and_b32 v83, 0xffff0000, v255
    s_mov_b32 s54, 0xbfb8aa3b
    s_mov_b32 s55, s54
    v_pk_add_f32 v[8:9], v[8:9], v[64:65]
    v_pk_add_f32 v[10:11], v[10:11], v[66:67]
    v_pk_add_f32 v[12:13], v[12:13], v[68:69]
    v_pk_add_f32 v[14:15], v[14:15], v[70:71]
    v_pk_add_f32 v[16:17], v[16:17], v[72:73]
    v_pk_add_f32 v[18:19], v[18:19], v[74:75]
    v_pk_add_f32 v[20:21], v[20:21], v[76:77]
    v_pk_add_f32 v[22:23], v[22:23], v[78:79]
    v_pk_add_f32 v[24:25], v[24:25], v[80:81]
    v_pk_add_f32 v[26:27], v[26:27], v[82:83]
    v_pk_mul_f32 v[64:65], v[8:9], s[54:55]
    v_pk_mul_f32 v[66:67], v[10:11], s[54:55]
    v_pk_mul_f32 v[68:69], v[12:13], s[54:55]
    v_pk_mul_f32 v[70:71], v[14:15], s[54:55]
    v_pk_mul_f32 v[72:73], v[16:17], s[54:55]
    v_pk_mul_f32 v[74:75], v[18:19], s[54:55]
    v_pk_mul_f32 v[76:77], v[20:21], s[54:55]
    v_pk_mul_f32 v[78:79], v[22:23], s[54:55]
    v_pk_mul_f32 v[80:81], v[24:25], s[54:55]
    v_pk_mul_f32 v[82:83], v[26:27], s[54:55]
    v_exp_f32 v64, v64
    v_exp_f32 v65, v65
    v_exp_f32 v66, v66
    v_exp_f32 v67, v67
    v_exp_f32 v68, v68
    v_exp_f32 v69, v69
    v_exp_f32 v70, v70
    v_exp_f32 v71, v71
    v_exp_f32 v72, v72
    v_exp_f32 v73, v73
    v_exp_f32 v74, v74
    v_exp_f32 v75, v75
    v_exp_f32 v76, v76
    v_exp_f32 v77, v77
    v_exp_f32 v78, v78
    v_exp_f32 v79, v79
    v_exp_f32 v80, v80
    v_exp_f32 v81, v81
    v_exp_f32 v82, v82
    v_exp_f32 v83, v83
    v_pk_add_f32 v[64:65], v[64:65], 1.0 op_sel_hi:[1,0]
    v_pk_add_f32 v[66:67], v[66:67], 1.0 op_sel_hi:[1,0]
    v_pk_add_f32 v[68:69], v[68:69], 1.0 op_sel_hi:[1,0]
    v_pk_add_f32 v[70:71], v[70:71], 1.0 op_sel_hi:[1,0]
    v_pk_add_f32 v[72:73], v[72:73], 1.0 op_sel_hi:[1,0]
    v_pk_add_f32 v[74:75], v[74:75], 1.0 op_sel_hi:[1,0]
    v_pk_add_f32 v[76:77], v[76:77], 1.0 op_sel_hi:[1,0]
    v_pk_add_f32 v[78:79], v[78:79], 1.0 op_sel_hi:[1,0]
    v_pk_add_f32 v[80:81], v[80:81], 1.0 op_sel_hi:[1,0]
    v_pk_add_f32 v[82:83], v[82:83], 1.0 op_sel_hi:[1,0]
    v_rcp_f32 v64, v64
    v_rcp_f32 v65, v65
    v_rcp_f32 v66, v66
    v_rcp_f32 v67, v67
    v_rcp_f32 v68, v68
    v_rcp_f32 v69, v69
    v_rcp_f32 v70, v70
    v_rcp_f32 v71, v71
    v_rcp_f32 v72, v72
    v_rcp_f32 v73, v73
    v_rcp_f32 v74, v74
    v_rcp_f32 v75, v75
    v_rcp_f32 v76, v76
    v_rcp_f32 v77, v77
    v_rcp_f32 v78, v78
    v_rcp_f32 v79, v79
    v_rcp_f32 v80, v80
    v_rcp_f32 v81, v81
    v_rcp_f32 v82, v82
    v_rcp_f32 v83, v83
    v_pk_mul_f32 v[8:9], v[8:9], v[44:45]
    v_pk_mul_f32 v[10:11], v[10:11], v[46:47]
    v_pk_mul_f32 v[12:13], v[12:13], v[48:49]
    v_pk_mul_f32 v[14:15], v[14:15], v[50:51]
    v_pk_mul_f32 v[16:17], v[16:17], v[52:53]
    v_pk_mul_f32 v[18:19], v[18:19], v[54:55]
    v_pk_mul_f32 v[20:21], v[20:21], v[56:57]
    v_pk_mul_f32 v[22:23], v[22:23], v[58:59]
    v_pk_mul_f32 v[24:25], v[24:25], v[60:61]
    v_pk_mul_f32 v[26:27], v[26:27], v[62:63]
    v_pk_fma_f32 v[8:9], v[8:9], v[64:65], v[84:85]
    v_pk_fma_f32 v[10:11], v[10:11], v[66:67], v[86:87]
    v_pk_fma_f32 v[12:13], v[12:13], v[68:69], v[88:89]
    v_pk_fma_f32 v[14:15], v[14:15], v[70:71], v[90:91]
    v_pk_fma_f32 v[16:17], v[16:17], v[72:73], v[92:93]
    v_pk_fma_f32 v[18:19], v[18:19], v[74:75], v[94:95]
    v_pk_fma_f32 v[20:21], v[20:21], v[76:77], v[96:97]
    v_pk_fma_f32 v[22:23], v[22:23], v[78:79], v[98:99]
    v_pk_fma_f32 v[24:25], v[24:25], v[80:81], v[100:101]
    v_pk_fma_f32 v[26:27], v[26:27], v[82:83], v[102:103]
    v_cvt_pk_bf16_f32 v128, v8, v9
    v_cvt_pk_bf16_f32 v129, v10, v11
    v_cvt_pk_bf16_f32 v130, v12, v13
    v_cvt_pk_bf16_f32 v131, v14, v15
    v_cvt_pk_bf16_f32 v132, v16, v17
    v_cvt_pk_bf16_f32 v133, v18, v19
    v_cvt_pk_bf16_f32 v134, v20, v21
    v_cvt_pk_bf16_f32 v135, v22, v23
    v_cvt_pk_bf16_f32 v136, v24, v25
    v_cvt_pk_bf16_f32 v137, v26, v27
    buffer_store_dwordx4 v[128:131], v28, s[16:19], s60 offen offset:0
    buffer_store_dwordx4 v[132:135], v28, s[16:19], s60 offen offset:64
    buffer_store_dwordx2 v[136:137], v29, s[16:19], s61 offen offset:0
Lend:
    s_endpgm
Lpk_issue:
    s_mov_b32 s91, 0
    s_movk_i32 s85, 1280
    s_cmp_ge_u32 s100, 940
    s_cbranch_scc1 Lpk_w4
    s_cmp_ge_u32 s100, 740
    s_cbranch_scc1 Lpk_wo
    s_cmp_ge_u32 s100, 200
    s_cbranch_scc1 Lpk_w3
    s_mov_b64 s[92:93], s[42:43]
    s_mov_b32 s94, 819200
    s_mov_b32 s89, 0
    s_movk_i32 s90, 100
    s_mov_b32 s3, s100
    s_mov_b32 s31, 5
    s_branch Lpk_acc10
Lpk_w4:
    s_mov_b64 s[92:93], s[46:47]
    s_mov_b32 s94, 2211840
    s_mov_b32 s89, 3840
    s_movk_i32 s90, 270
    s_sub_u32 s3, s100, 940
    s_mov_b32 s31, 7
Lpk_acc10:
    s_mul_i32 s83, s3, 6554
    s_lshr_b32 s83, s83, 16
    s_mul_i32 s84, s83, 10
    s_sub_u32 s84, s3, s84
    s_lshl_b32 s86, s83, 5
    s_mov_b32 s29, 0x4210
    s_bitset1_b32 s29, 19
    s_cmp_eq_u32 s31, 5
    s_cselect_b32 s30, s29, 0x81020408
    s_mov_b32 s31, 0x00102040
    s_bitcmp1_b64 s[30:31], s83
    s_cselect_b32 s87, 4, 16
    s_cselect_b32 s88, 8, 4
    s_branch Lpk_go
Lpk_wo:
    s_mov_b64 s[92:93], s[36:37]
    s_mov_b32 s94, 819200
    s_mov_b32 s89, 800
    s_movk_i32 s90, 100
    s_sub_u32 s3, s100, 740
    s_mul_i32 s83, s3, 6554
    s_lshr_b32 s83, s83, 16
    s_mul_i32 s84, s83, 10
    s_sub_u32 s84, s3, s84
    s_mul_i32 s29, s83, 13108
    s_lshr_b32 s29, s29, 16
    s_mul_i32 s30, s29, 5
    s_sub_u32 s30, s83, s30
    s_mul_i32 s86, s29, 160
    s_mul_i32 s3, s30, 40
    s_cmp_eq_u32 s30, 4
    s_cselect_b32 s3, 16, s3
    s_mov_b32 s87, 20
    s_cselect_b32 s88, 40, 4
    s_add_u32 s86, s86, s3
    s_branch Lpk_go
Lpk_w3:
    s_mov_b64 s[92:93], s[44:45]
    s_mov_b32 s94, 2211840
    s_mov_b32 s89, 1600
    s_movk_i32 s90, 140
    s_mov_b32 s91, 1
    s_movk_i32 s85, 3456
    s_sub_u32 s3, s100, 200
    s_mul_i32 s83, s3, 2428
    s_lshr_b32 s83, s83, 16
    s_mul_i32 s84, s83, 27
    s_sub_u32 s84, s3, s84
    s_mul_i32 s29, s83, 13108
    s_lshr_b32 s29, s29, 16
    s_mul_i32 s30, s29, 5
    s_sub_u32 s30, s83, s30
    s_lshl_b32 s86, s83, 5
    s_mov_b32 s87, 4
    s_mov_b32 s88, 8
Lpk_go:
    v_mul_lo_u32 v242, v236, s87
    v_add_u32 v242, v242, v237
    v_mul_lo_u32 v242, v242, s85
    v_add_u32 v242, v242, v238
    s_mul_i32 s86, s86, s85
    s_lshl_b32 s3, s84, 7
    s_add_u32 s86, s86, s3
    s_mul_i32 s88, s88, s85
    s_add_u32 m0, s101, 0
    s_nop 0
    buffer_load_dwordx4 v242, s[92:95], s86 offen lds
    s_add_u32 s86, s86, s88
    s_add_u32 m0, s101, 1024
    s_nop 0
    buffer_load_dwordx4 v242, s[92:95], s86 offen lds
    s_add_u32 s86, s86, s88
    s_add_u32 m0, s101, 2048
    s_nop 0
    buffer_load_dwordx4 v242, s[92:95], s86 offen lds
    s_add_u32 s86, s86, s88
    s_add_u32 m0, s101, 3072
    s_nop 0
    buffer_load_dwordx4 v242, s[92:95], s86 offen lds
    s_lshl_b32 s3, s84, 1
    s_add_u32 s3, s3, 0
    s_cmp_lg_u32 s91, 0
    s_cbranch_scc1 Lpkd8
    s_mul_i32 s29, s3, 13108
    s_lshr_b32 s29, s29, 16
    s_mul_i32 s30, s29, 5
    s_sub_u32 s30, s3, s30
    s_lshl_b32 s29, s29, 1
    s_lshr_b32 s3, s30, 1
    s_and_b32 s31, s30, 1
    s_lshl_b32 s31, s31, 1
    s_cmp_eq_u32 s30, 4
    s_cselect_b32 s3, 0, s3
    s_cselect_b32 s31, 4, s31
    s_cselect_b32 s86, s90, 1
    s_cselect_b32 s87, 8, 16
    s_cselect_b32 s30, 32, 8
    s_add_u32 s29, s29, s3
    s_mul_i32 s29, s29, s90
    s_mul_i32 s3, s83, 5
    s_branch Lpkd9
Lpkd8:
    s_mul_i32 s29, s3, 9363
    s_lshr_b32 s29, s29, 16
    s_mul_i32 s30, s29, 7
    s_sub_u32 s30, s3, s30
    s_lshl_b32 s29, s29, 1
    s_lshr_b32 s3, s30, 2
    s_and_b32 s31, s30, 3
    s_lshl_b32 s31, s31, 1
    s_cmp_eq_u32 s30, 3
    s_cselect_b32 s86, s90, 1
    s_mov_b32 s87, 8
    s_mov_b32 s30, 32
    s_add_u32 s29, s29, s3
    s_mul_i32 s29, s29, s90
    s_mul_i32 s3, s83, 7
Lpkd9:
    s_add_u32 s29, s29, s3
    s_add_u32 s29, s29, s31
    s_add_u32 s96, s29, s89
    s_add_u32 s97, s96, s86
    v_mul_lo_u32 v243, v240, s87
    v_add3_u32 v243, v243, v239, s101
    v_add_u32 v244, s30, v243
    s_lshl_b32 s3, s84, 1
    s_add_u32 s3, s3, 1
    s_cmp_lg_u32 s91, 0
    s_cbranch_scc1 Lpkd10
    s_mul_i32 s29, s3, 13108
    s_lshr_b32 s29, s29, 16
    s_mul_i32 s30, s29, 5
    s_sub_u32 s30, s3, s30
    s_lshl_b32 s29, s29, 1
    s_lshr_b32 s3, s30, 1
    s_and_b32 s31, s30, 1
    s_lshl_b32 s31, s31, 1
    s_cmp_eq_u32 s30, 4
    s_cselect_b32 s3, 0, s3
    s_cselect_b32 s31, 4, s31
    s_cselect_b32 s86, s90, 1
    s_cselect_b32 s87, 8, 16
    s_cselect_b32 s30, 32, 8
    s_add_u32 s29, s29, s3
    s_mul_i32 s29, s29, s90
    s_mul_i32 s3, s83, 5
    s_branch Lpkd11
Lpkd10:
    s_mul_i32 s29, s3, 9363
    s_lshr_b32 s29, s29, 16
    s_mul_i32 s30, s29, 7
    s_sub_u32 s30, s3, s30
    s_lshl_b32 s29, s29, 1
    s_lshr_b32 s3, s30, 2
    s_and_b32 s31, s30, 3
    s_lshl_b32 s31, s31, 1
    s_cmp_eq_u32 s30, 3
    s_cselect_b32 s86, s90, 1
    s_mov_b32 s87, 8
    s_mov_b32 s30, 32
    s_add_u32 s29, s29, s3
    s_mul_i32 s29, s29, s90
    s_mul_i32 s3, s83, 7
Lpkd11:
    s_add_u32 s29, s29, s3
    s_add_u32 s29, s29, s31
    s_add_u32 s98, s29, s89
    s_add_u32 s99, s98, s86
    v_mul_lo_u32 v245, v240, s87
    v_add3_u32 v245, v245, v239, s101
    v_add_u32 v246, s30, v245
    s_setpc_b64 s[70:71]
Lpk_fin:
    ds_read_b64_tr_b16 v[200:201], v243 offset:0
    ds_read_b64_tr_b16 v[202:203], v243 offset:512
    ds_read_b64_tr_b16 v[204:205], v244 offset:0
    ds_read_b64_tr_b16 v[206:207], v244 offset:512
    ds_read_b64_tr_b16 v[208:209], v245 offset:64
    ds_read_b64_tr_b16 v[210:211], v245 offset:576
    ds_read_b64_tr_b16 v[212:213], v246 offset:64
    ds_read_b64_tr_b16 v[214:215], v246 offset:576
    s_waitcnt lgkmcnt(0)
    v_mfma_f32_16x16x32_bf16 v[216:219], v[196:199], v[200:203], 0
    v_mfma_f32_16x16x32_bf16 v[220:223], v[196:199], v[204:207], 0
    v_mfma_f32_16x16x32_bf16 v[224:227], v[196:199], v[208:211], 0
    v_mfma_f32_16x16x32_bf16 v[228:231], v[196:199], v[212:215], 0
    s_lshl_b32 s3, s96, 10
    s_add_u32 s3, s3, 0x1600000
    buffer_store_dwordx4 v[200:203], v251, s[8:11], s3 offen sc1
    s_lshl_b32 s3, s97, 10
    s_add_u32 s3, s3, 0x1600000
    buffer_store_dwordx4 v[204:207], v251, s[8:11], s3 offen sc1
    s_lshl_b32 s3, s98, 10
    s_add_u32 s3, s3, 0x1600000
    buffer_store_dwordx4 v[208:211], v251, s[8:11], s3 offen sc1
    s_lshl_b32 s3, s99, 10
    s_add_u32 s3, s3, 0x1600000
    buffer_store_dwordx4 v[212:215], v251, s[8:11], s3 offen sc1
    s_mov_b64 exec, 0xffff
    s_lshl_b32 s3, s96, 6
    s_add_u32 s3, s3, 0x1c80000
    buffer_store_dword v216, v241, s[8:11], s3 offen sc1
    s_lshl_b32 s3, s97, 6
    s_add_u32 s3, s3, 0x1c80000
    buffer_store_dword v220, v241, s[8:11], s3 offen sc1
    s_lshl_b32 s3, s98, 6
    s_add_u32 s3, s3, 0x1c80000
    buffer_store_dword v224, v241, s[8:11], s3 offen sc1
    s_lshl_b32 s3, s99, 6
    s_add_u32 s3, s3, 0x1c80000
    buffer_store_dword v228, v241, s[8:11], s3 offen sc1
    s_mov_b64 exec, -1
    s_setpc_b64 s[70:71]
Lx4load:
    s_and_b32 s58, s22, 1
    v_lshlrev_b32 v2, 4, v1
    v_lshrrev_b32 v4, 3, v1
    v_and_b32 v5, 7, v1
    v_lshrrev_b32 v6, 1, v4
    v_xor_b32 v5, v5, v6
    v_mul_u32_u24 v4, 1280, v4
    v_lshl_add_u32 v8, v5, 4, v4
    v_xor_b32 v9, 64, v8
    s_lshl_b32 s3, s23, 1
    s_add_u32 s3, s3, s58
    s_mul_i32 s66, s3, 81920
    s_mov_b32 s64, 128
    s_add_u32 s3, s23, s24
    s_mul_i32 s3, s3, 3
    s_mul_i32 s29, s3, 6554
    s_lshr_b32 s29, s29, 16
    s_mul_i32 s29, s29, 10
    s_sub_u32 s59, s3, s29
    s_mul_i32 s65, s64, 10
    s_add_u32 s63, s66, s65
    s_mul_i32 s3, s59, s64
    s_add_u32 s62, s66, s3
    s_lshl_b32 s3, s58, 13
    s_add_u32 s68, s3, 0
    s_mov_b32 s69, s62
    s_add_u32 m0, s68, 0
    s_nop 0
    buffer_load_dwordx4 v8, s[4:7], s69 offen offset:0  lds
    s_add_u32 m0, s68, 1024
    s_add_u32 s69, s69, 10240
    buffer_load_dwordx4 v9, s[4:7], s69 offen offset:0  lds
    s_add_u32 m0, s68, 2048
    s_add_u32 s69, s69, 10240
    buffer_load_dwordx4 v8, s[4:7], s69 offen offset:0  lds
    s_add_u32 m0, s68, 3072
    s_add_u32 s69, s69, 10240
    buffer_load_dwordx4 v9, s[4:7], s69 offen offset:0  lds
    s_add_u32 m0, s68, 4096
    s_add_u32 s69, s69, 10240
    buffer_load_dwordx4 v8, s[4:7], s69 offen offset:0  lds
    s_add_u32 m0, s68, 5120
    s_add_u32 s69, s69, 10240
    buffer_load_dwordx4 v9, s[4:7], s69 offen offset:0  lds
    s_add_u32 m0, s68, 6144
    s_add_u32 s69, s69, 10240
    buffer_load_dwordx4 v8, s[4:7], s69 offen offset:0  lds
    s_add_u32 m0, s68, 7168
    s_add_u32 s69, s69, 10240
    buffer_load_dwordx4 v9, s[4:7], s69 offen offset:0  lds
    s_add_u32 s62, s62, s64
    s_cmp_ge_u32 s62, s63
    s_cselect_b32 s3, s65, 0
    s_sub_u32 s62, s62, s3
    s_and_b32 s3, s2, 7
    s_lshl_b32 s3, s3, 10
    s_add_u32 s3, s3, 0x1c40000
    v_add_u32 v16, s3, v2
    v_lshlrev_b32 v17, 10, v1
    v_mov_b32 v18, 1
    v_mov_b32 v15, 0
    v_mov_b32 v19, 150784
    s_lshl_b32 s3, s58, 13
    s_add_u32 s68, s3, 36864
    s_mov_b32 s69, s62
    s_add_u32 m0, s68, 0
    s_nop 0
    buffer_load_dwordx4 v8, s[4:7], s69 offen offset:0  lds
    s_add_u32 m0, s68, 1024
    s_add_u32 s69, s69, 10240
    buffer_load_dwordx4 v9, s[4:7], s69 offen offset:0  lds
    s_add_u32 m0, s68, 2048
    s_add_u32 s69, s69, 10240
    buffer_load_dwordx4 v8, s[4:7], s69 offen offset:0  lds
    s_add_u32 m0, s68, 3072
    s_add_u32 s69, s69, 10240
    buffer_load_dwordx4 v9, s[4:7], s69 offen offset:0  lds
    s_add_u32 m0, s68, 4096
    s_add_u32 s69, s69, 10240
    buffer_load_dwordx4 v8, s[4:7], s69 offen offset:0  lds
    s_add_u32 m0, s68, 5120
    s_add_u32 s69, s69, 10240
    buffer_load_dwordx4 v9, s[4:7], s69 offen offset:0  lds
    s_add_u32 m0, s68, 6144
    s_add_u32 s69, s69, 10240
    buffer_load_dwordx4 v8, s[4:7], s69 offen offset:0  lds
    s_add_u32 m0, s68, 7168
    s_add_u32 s69, s69, 10240
    buffer_load_dwordx4 v9, s[4:7], s69 offen offset:0  lds
    s_add_u32 s62, s62, s64
    s_cmp_ge_u32 s62, s63
    s_cselect_b32 s3, s65, 0
    s_sub_u32 s62, s62, s3
    s_sub_u32 s3, s22, 4
    s_mul_i32 s3, s3, 25600
    s_mul_i32 s56, s28, 102400
    s_add_u32 s56, s56, s3
    s_add_u32 s56, s56, 0x1600000
    v_add_u32 v3, s3, v2
    s_mul_i32 s57, s39, 143360
    s_add_u32 s57, s57, s3
    s_add_u32 s57, s57, 0x1790000
    s_waitcnt vmcnt(8)
    s_barrier
    global_load_dword v14, v15, s[50:51]
    s_lshl_b32 s3, s58, 13
    s_add_u32 s68, s3, 73728
    s_mov_b32 s69, s62
    s_add_u32 m0, s68, 0
    s_nop 0
    buffer_load_dwordx4 v8, s[4:7], s69 offen offset:0  lds
    s_add_u32 m0, s68, 1024
    s_add_u32 s69, s69, 10240
    buffer_load_dwordx4 v9, s[4:7], s69 offen offset:0  lds
    s_add_u32 m0, s68, 2048
    s_add_u32 s69, s69, 10240
    buffer_load_dwordx4 v8, s[4:7], s69 offen offset:0  lds
    s_add_u32 m0, s68, 3072
    s_add_u32 s69, s69, 10240
    buffer_load_dwordx4 v9, s[4:7], s69 offen offset:0  lds
    s_add_u32 m0, s68, 4096
    s_add_u32 s69, s69, 10240
    buffer_load_dwordx4 v8, s[4:7], s69 offen offset:0  lds
    s_add_u32 m0, s68, 5120
    s_add_u32 s69, s69, 10240
    buffer_load_dwordx4 v9, s[4:7], s69 offen offset:0  lds
    s_add_u32 m0, s68, 6144
    s_add_u32 s69, s69, 10240
    buffer_load_dwordx4 v8, s[4:7], s69 offen offset:0  lds
    s_add_u32 m0, s68, 7168
    s_add_u32 s69, s69, 10240
    buffer_load_dwordx4 v9, s[4:7], s69 offen offset:0  lds
    s_add_u32 s62, s62, s64
    s_cmp_ge_u32 s62, s63
    s_cselect_b32 s3, s65, 0
    s_sub_u32 s62, s62, s3
    s_lshl_b32 s3, s58, 13
    s_add_u32 s68, s3, 110592
    s_mov_b32 s69, s62
    s_add_u32 m0, s68, 0
    s_nop 0
    buffer_load_dwordx4 v8, s[4:7], s69 offen offset:0  lds
    s_add_u32 m0, s68, 1024
    s_add_u32 s69, s69, 10240
    buffer_load_dwordx4 v9, s[4:7], s69 offen offset:0  lds
    s_add_u32 m0, s68, 2048
    s_add_u32 s69, s69, 10240
    buffer_load_dwordx4 v8, s[4:7], s69 offen offset:0  lds
    s_add_u32 m0, s68, 3072
    s_add_u32 s69, s69, 10240
    buffer_load_dwordx4 v9, s[4:7], s69 offen offset:0  lds
    s_add_u32 m0, s68, 4096
    s_add_u32 s69, s69, 10240
    buffer_load_dwordx4 v8, s[4:7], s69 offen offset:0  lds
    s_add_u32 m0, s68, 5120
    s_add_u32 s69, s69, 10240
    buffer_load_dwordx4 v9, s[4:7], s69 offen offset:0  lds
    s_add_u32 m0, s68, 6144
    s_add_u32 s69, s69, 10240
    buffer_load_dwordx4 v8, s[4:7], s69 offen offset:0  lds
    s_add_u32 m0, s68, 7168
    s_add_u32 s69, s69, 10240
    buffer_load_dwordx4 v9, s[4:7], s69 offen offset:0  lds
    s_add_u32 s62, s62, s64
    s_cmp_ge_u32 s62, s63
    s_cselect_b32 s3, s65, 0
    s_sub_u32 s62, s62, s3
    v_mov_b32 v20, 0
    v_mov_b32 v21, 0
    ds_write_b64 v19, v[20:21]
    ds_write_b64 v19, v[20:21] offset:8
    s_waitcnt lgkmcnt(0)
    s_waitcnt vmcnt(17)
    s_barrier
    s_waitcnt vmcnt(16)
    s_mov_b32 s31, 0
Lini12:
    v_cmp_eq_u32 vcc, 0, v14
    s_cbranch_vccz Linix13
    s_add_u32 s31, s31, 1
    s_cmp_gt_u32 s31, 400000
    s_cbranch_scc1 Linix13
    global_load_dword v14, v15, s[50:51] sc0 sc1
    s_waitcnt vmcnt(0)
    s_branch Lini12
Linix13:
    s_lshl_b32 s70, s2, 2
    s_add_u32 s70, s70, 0x1c40000
    s_mov_b64 exec, 0xff
    buffer_store_dword v18, v17, s[8:11], s70 offen sc1
    s_mov_b64 exec, -1
    s_lshl_b32 s3, s58, 13
    s_add_u32 s68, s3, 0
    s_mov_b32 s69, s62
    s_add_u32 m0, s68, 0
    s_nop 0
    buffer_load_dwordx4 v8, s[4:7], s69 offen offset:0  lds
    s_add_u32 m0, s68, 1024
    s_add_u32 s69, s69, 10240
    buffer_load_dwordx4 v9, s[4:7], s69 offen offset:0  lds
    s_add_u32 m0, s68, 2048
    s_add_u32 s69, s69, 10240
    buffer_load_dwordx4 v8, s[4:7], s69 offen offset:0  lds
    s_add_u32 m0, s68, 3072
    s_add_u32 s69, s69, 10240
    buffer_load_dwordx4 v9, s[4:7], s69 offen offset:0  lds
    s_add_u32 m0, s68, 4096
    s_add_u32 s69, s69, 10240
    buffer_load_dwordx4 v8, s[4:7], s69 offen offset:0  lds
    s_add_u32 m0, s68, 5120
    s_add_u32 s69, s69, 10240
    buffer_load_dwordx4 v9, s[4:7], s69 offen offset:0  lds
    s_add_u32 m0, s68, 6144
    s_add_u32 s69, s69, 10240
    buffer_load_dwordx4 v8, s[4:7], s69 offen offset:0  lds
    s_add_u32 m0, s68, 7168
    s_add_u32 s69, s69, 10240
    buffer_load_dwordx4 v9, s[4:7], s69 offen offset:0  lds
    s_add_u32 s62, s62, s64
    s_cmp_ge_u32 s62, s63
    s_cselect_b32 s3, s65, 0
    s_sub_u32 s62, s62, s3
    s_waitcnt vmcnt(17)
    s_barrier
    s_lshl_b32 s3, s58, 13
    s_add_u32 s68, s3, 36864
    s_mov_b32 s69, s62
    s_add_u32 m0, s68, 0
    s_nop 0
    buffer_load_dwordx4 v8, s[4:7], s69 offen offset:0  lds
    s_add_u32 m0, s68, 1024
    s_add_u32 s69, s69, 10240
    buffer_load_dwordx4 v9, s[4:7], s69 offen offset:0  lds
    s_add_u32 m0, s68, 2048
    s_add_u32 s69, s69, 10240
    buffer_load_dwordx4 v8, s[4:7], s69 offen offset:0  lds
    s_add_u32 m0, s68, 3072
    s_add_u32 s69, s69, 10240
    buffer_load_dwordx4 v9, s[4:7], s69 offen offset:0  lds
    s_add_u32 m0, s68, 4096
    s_add_u32 s69, s69, 10240
    buffer_load_dwordx4 v8, s[4:7], s69 offen offset:0  lds
    s_add_u32 m0, s68, 5120
    s_add_u32 s69, s69, 10240
    buffer_load_dwordx4 v9, s[4:7], s69 offen offset:0  lds
    s_add_u32 m0, s68, 6144
    s_add_u32 s69, s69, 10240
    buffer_load_dwordx4 v8, s[4:7], s69 offen offset:0  lds
    s_add_u32 m0, s68, 7168
    s_add_u32 s69, s69, 10240
    buffer_load_dwordx4 v9, s[4:7], s69 offen offset:0  lds
    s_add_u32 s62, s62, s64
    s_cmp_ge_u32 s62, s63
    s_cselect_b32 s3, s65, 0
    s_sub_u32 s62, s62, s3
    s_waitcnt vmcnt(17)
    s_barrier
    s_lshl_b32 s3, s58, 13
    s_add_u32 s68, s3, 73728
    s_mov_b32 s69, s62
    s_add_u32 m0, s68, 0
    s_nop 0
    buffer_load_dwordx4 v8, s[4:7], s69 offen offset:0  lds
    s_add_u32 m0, s68, 1024
    s_add_u32 s69, s69, 10240
    buffer_load_dwordx4 v9, s[4:7], s69 offen offset:0  lds
    s_add_u32 m0, s68, 2048
    s_add_u32 s69, s69, 10240
    buffer_load_dwordx4 v8, s[4:7], s69 offen offset:0  lds
    s_add_u32 m0, s68, 3072
    s_add_u32 s69, s69, 10240
    buffer_load_dwordx4 v9, s[4:7], s69 offen offset:0  lds
    s_add_u32 m0, s68, 4096
    s_add_u32 s69, s69, 10240
    buffer_load_dwordx4 v8, s[4:7], s69 offen offset:0  lds
    s_add_u32 m0, s68, 5120
    s_add_u32 s69, s69, 10240
    buffer_load_dwordx4 v9, s[4:7], s69 offen offset:0  lds
    s_add_u32 m0, s68, 6144
    s_add_u32 s69, s69, 10240
    buffer_load_dwordx4 v8, s[4:7], s69 offen offset:0  lds
    s_add_u32 m0, s68, 7168
    s_add_u32 s69, s69, 10240
    buffer_load_dwordx4 v9, s[4:7], s69 offen offset:0  lds
    s_add_u32 s62, s62, s64
    s_cmp_ge_u32 s62, s63
    s_cselect_b32 s3, s65, 0
    s_sub_u32 s62, s62, s3
    s_waitcnt vmcnt(16)
    s_barrier
    buffer_load_dwordx4 v[224:227], v16, s[8:11], 0 offen sc1
    s_lshl_b32 s3, s58, 13
    s_add_u32 s68, s3, 110592
    s_mov_b32 s69, s62
    s_add_u32 m0, s68, 0
    s_nop 0
    buffer_load_dwordx4 v8, s[4:7], s69 offen offset:0  lds
    s_add_u32 m0, s68, 1024
    s_add_u32 s69, s69, 10240
    buffer_load_dwordx4 v9, s[4:7], s69 offen offset:0  lds
    s_add_u32 m0, s68, 2048
    s_add_u32 s69, s69, 10240
    buffer_load_dwordx4 v8, s[4:7], s69 offen offset:0  lds
    s_add_u32 m0, s68, 3072
    s_add_u32 s69, s69, 10240
    buffer_load_dwordx4 v9, s[4:7], s69 offen offset:0  lds
    s_add_u32 m0, s68, 4096
    s_add_u32 s69, s69, 10240
    buffer_load_dwordx4 v8, s[4:7], s69 offen offset:0  lds
    s_add_u32 m0, s68, 5120
    s_add_u32 s69, s69, 10240
    buffer_load_dwordx4 v9, s[4:7], s69 offen offset:0  lds
    s_add_u32 m0, s68, 6144
    s_add_u32 s69, s69, 10240
    buffer_load_dwordx4 v8, s[4:7], s69 offen offset:0  lds
    s_add_u32 m0, s68, 7168
    s_add_u32 s69, s69, 10240
    buffer_load_dwordx4 v9, s[4:7], s69 offen offset:0  lds
    s_add_u32 s62, s62, s64
    s_cmp_ge_u32 s62, s63
    s_cselect_b32 s3, s65, 0
    s_sub_u32 s62, s62, s3
    s_waitcnt vmcnt(17)
    s_waitcnt vmcnt(8)
    s_mov_b32 s31, 0
Lpk14:
    v_min_u32 v224, v224, v225
    v_min3_u32 v224, v224, v226, v227
    v_cmp_eq_u32 vcc, 0, v224
    s_cbranch_vccz Lpkok15
    s_add_u32 s31, s31, 1
    s_cmp_gt_u32 s31, 400000
    s_cbranch_scc1 Lpkok15
Lpkld16:
    buffer_load_dwordx4 v[224:227], v16, s[8:11], 0 offen sc1
    s_waitcnt vmcnt(0)
    s_branch Lpk14
Lpkok15:
    s_barrier
    s_lshl_b32 s3, s58, 13
    s_add_u32 s68, s3, 0
    s_mov_b32 s69, s62
    s_add_u32 m0, s68, 0
    s_nop 0
    buffer_load_dwordx4 v8, s[4:7], s69 offen offset:0  lds
    s_add_u32 m0, s68, 1024
    s_add_u32 s69, s69, 10240
    buffer_load_dwordx4 v9, s[4:7], s69 offen offset:0  lds
    s_add_u32 m0, s68, 2048
    s_add_u32 s69, s69, 10240
    buffer_load_dwordx4 v8, s[4:7], s69 offen offset:0  lds
    s_add_u32 m0, s68, 3072
    s_add_u32 s69, s69, 10240
    buffer_load_dwordx4 v9, s[4:7], s69 offen offset:0  lds
    s_add_u32 m0, s68, 4096
    s_add_u32 s69, s69, 10240
    buffer_load_dwordx4 v8, s[4:7], s69 offen offset:0  lds
    s_add_u32 m0, s68, 5120
    s_add_u32 s69, s69, 10240
    buffer_load_dwordx4 v9, s[4:7], s69 offen offset:0  lds
    s_add_u32 m0, s68, 6144
    s_add_u32 s69, s69, 10240
    buffer_load_dwordx4 v8, s[4:7], s69 offen offset:0  lds
    s_add_u32 m0, s68, 7168
    s_add_u32 s69, s69, 10240
    buffer_load_dwordx4 v9, s[4:7], s69 offen offset:0  lds
    s_add_u32 s62, s62, s64
    s_cmp_ge_u32 s62, s63
    s_cselect_b32 s3, s65, 0
    s_sub_u32 s62, s62, s3
    buffer_load_dwordx4 v[120:123], v2, s[8:11], s56 offen offset:0 sc1
    buffer_load_dwordx4 v[124:127], v2, s[8:11], s56 offen offset:1024 sc1
    buffer_load_dwordx4 v[128:131], v2, s[8:11], s56 offen offset:2048 sc1
    buffer_load_dwordx4 v[132:135], v2, s[8:11], s56 offen offset:3072 sc1
    s_add_u32 s56, s56, 4096
    buffer_load_dwordx4 v[136:139], v2, s[8:11], s56 offen offset:0 sc1
    buffer_load_dwordx4 v[140:143], v2, s[8:11], s56 offen offset:1024 sc1
    buffer_load_dwordx4 v[144:147], v2, s[8:11], s56 offen offset:2048 sc1
    buffer_load_dwordx4 v[148:151], v2, s[8:11], s56 offen offset:3072 sc1
    s_barrier
    s_lshl_b32 s3, s58, 13
    s_add_u32 s68, s3, 36864
    s_mov_b32 s69, s62
    s_add_u32 m0, s68, 0
    s_nop 0
    buffer_load_dwordx4 v8, s[4:7], s69 offen offset:0  lds
    s_add_u32 m0, s68, 1024
    s_add_u32 s69, s69, 10240
    buffer_load_dwordx4 v9, s[4:7], s69 offen offset:0  lds
    s_add_u32 m0, s68, 2048
    s_add_u32 s69, s69, 10240
    buffer_load_dwordx4 v8, s[4:7], s69 offen offset:0  lds
    s_add_u32 m0, s68, 3072
    s_add_u32 s69, s69, 10240
    buffer_load_dwordx4 v9, s[4:7], s69 offen offset:0  lds
    s_add_u32 m0, s68, 4096
    s_add_u32 s69, s69, 10240
    buffer_load_dwordx4 v8, s[4:7], s69 offen offset:0  lds
    s_add_u32 m0, s68, 5120
    s_add_u32 s69, s69, 10240
    buffer_load_dwordx4 v9, s[4:7], s69 offen offset:0  lds
    s_add_u32 m0, s68, 6144
    s_add_u32 s69, s69, 10240
    buffer_load_dwordx4 v8, s[4:7], s69 offen offset:0  lds
    s_add_u32 m0, s68, 7168
    s_add_u32 s69, s69, 10240
    buffer_load_dwordx4 v9, s[4:7], s69 offen offset:0  lds
    s_add_u32 s62, s62, s64
    s_cmp_ge_u32 s62, s63
    s_cselect_b32 s3, s65, 0
    s_sub_u32 s62, s62, s3
    s_add_u32 s56, s56, 4096
    buffer_load_dwordx4 v[152:155], v2, s[8:11], s56 offen offset:0 sc1
    buffer_load_dwordx4 v[156:159], v2, s[8:11], s56 offen offset:1024 sc1
    buffer_load_dwordx4 v[160:163], v2, s[8:11], s56 offen offset:2048 sc1
    buffer_load_dwordx4 v[164:167], v2, s[8:11], s56 offen offset:3072 sc1
    s_add_u32 s56, s56, 4096
    buffer_load_dwordx4 v[168:171], v2, s[8:11], s56 offen offset:0 sc1
    buffer_load_dwordx4 v[172:175], v2, s[8:11], s56 offen offset:1024 sc1
    buffer_load_dwordx4 v[176:179], v2, s[8:11], s56 offen offset:2048 sc1
    buffer_load_dwordx4 v[180:183], v2, s[8:11], s56 offen offset:3072 sc1
    s_add_u32 s56, s56, 4096
    buffer_load_dwordx4 v[184:187], v2, s[8:11], s56 offen offset:0 sc1
    buffer_load_dwordx4 v[188:191], v2, s[8:11], s56 offen offset:1024 sc1
    s_waitcnt vmcnt(34)
    s_barrier
    s_lshl_b32 s70, s2, 2
    s_add_u32 s70, s70, 0x1c46000
    s_mov_b64 exec, 0xff
    buffer_store_dword v18, v17, s[8:11], s70 offen sc1
    s_mov_b64 exec, -1
    buffer_load_dwordx4 v[192:195], v2, s[8:11], s56 offen offset:2048 sc1
    buffer_load_dwordx4 v[196:199], v2, s[8:11], s56 offen offset:3072 sc1
    s_add_u32 s56, s56, 4096
    buffer_load_dwordx4 v[200:203], v2, s[8:11], s56 offen offset:0 sc1
    buffer_load_dwordx4 v[204:207], v2, s[8:11], s56 offen offset:1024 sc1
    buffer_load_dwordx4 v[208:211], v2, s[8:11], s56 offen offset:2048 sc1
    buffer_load_dwordx4 v[212:215], v2, s[8:11], s56 offen offset:3072 sc1
    s_add_u32 s56, s56, 4096
    buffer_load_dwordx4 v[216:219], v2, s[8:11], s56 offen offset:0 sc1
    buffer_load_dwordx4 v[20:23], v2, s[8:11], s57 offen offset:0 sc1
    buffer_load_dwordx4 v[24:27], v2, s[8:11], s57 offen offset:1024 sc1
    buffer_load_dwordx4 v[28:31], v2, s[8:11], s57 offen offset:2048 sc1
    s_waitcnt vmcnt(36)
    s_barrier
    buffer_load_dwordx4 v[32:35], v2, s[8:11], s57 offen offset:3072 sc1
    s_add_u32 s57, s57, 4096
    buffer_load_dwordx4 v[36:39], v2, s[8:11], s57 offen offset:0 sc1
    buffer_load_dwordx4 v[40:43], v2, s[8:11], s57 offen offset:1024 sc1
    buffer_load_dwordx4 v[44:47], v2, s[8:11], s57 offen offset:2048 sc1
    buffer_load_dwordx4 v[48:51], v2, s[8:11], s57 offen offset:3072 sc1
    s_add_u32 s57, s57, 4096
    buffer_load_dwordx4 v[52:55], v2, s[8:11], s57 offen offset:0 sc1
    buffer_load_dwordx4 v[56:59], v2, s[8:11], s57 offen offset:1024 sc1
    buffer_load_dwordx4 v[60:63], v2, s[8:11], s57 offen offset:2048 sc1
    buffer_load_dwordx4 v[64:67], v2, s[8:11], s57 offen offset:3072 sc1
    s_add_u32 s57, s57, 4096
    buffer_load_dwordx4 v[68:71], v2, s[8:11], s57 offen offset:0 sc1
    s_waitcnt vmcnt(30)
    s_barrier
    buffer_load_dwordx4 v[72:75], v2, s[8:11], s57 offen offset:1024 sc1
    buffer_load_dwordx4 v[76:79], v2, s[8:11], s57 offen offset:2048 sc1
    buffer_load_dwordx4 v[80:83], v2, s[8:11], s57 offen offset:3072 sc1
    s_add_u32 s57, s57, 4096
    buffer_load_dwordx4 v[84:87], v2, s[8:11], s57 offen offset:0 sc1
    buffer_load_dwordx4 v[88:91], v2, s[8:11], s57 offen offset:1024 sc1
    buffer_load_dwordx4 v[92:95], v2, s[8:11], s57 offen offset:2048 sc1
    buffer_load_dwordx4 v[96:99], v2, s[8:11], s57 offen offset:3072 sc1
    s_add_u32 s57, s57, 4096
    buffer_load_dwordx4 v[100:103], v2, s[8:11], s57 offen offset:0 sc1
    buffer_load_dwordx4 v[104:107], v2, s[8:11], s57 offen offset:1024 sc1
    buffer_load_dwordx4 v[108:111], v2, s[8:11], s57 offen offset:2048 sc1
    s_branch Ltail
Lx5load:
    s_and_b32 s58, s22, 1
    v_lshlrev_b32 v2, 4, v1
    v_lshrrev_b32 v4, 3, v1
    v_and_b32 v5, 7, v1
    v_lshrrev_b32 v6, 1, v4
    v_xor_b32 v5, v5, v6
    v_mul_u32_u24 v4, 1280, v4
    v_lshl_add_u32 v8, v5, 4, v4
    v_xor_b32 v9, 64, v8
    s_lshl_b32 s3, s23, 1
    s_add_u32 s3, s3, s58
    s_mul_i32 s66, s3, 81920
    s_mov_b32 s64, 128
    s_add_u32 s3, s23, s24
    s_mul_i32 s3, s3, 3
    s_mul_i32 s29, s3, 6554
    s_lshr_b32 s29, s29, 16
    s_mul_i32 s29, s29, 10
    s_sub_u32 s59, s3, s29
    s_mul_i32 s65, s64, 10
    s_add_u32 s63, s66, s65
    s_mul_i32 s3, s59, s64
    s_add_u32 s62, s66, s3
    s_lshl_b32 s3, s58, 13
    s_add_u32 s68, s3, 0
    s_mov_b32 s69, s62
    s_add_u32 m0, s68, 0
    s_nop 0
    buffer_load_dwordx4 v8, s[4:7], s69 offen offset:0  lds
    s_add_u32 m0, s68, 1024
    s_add_u32 s69, s69, 10240
    buffer_load_dwordx4 v9, s[4:7], s69 offen offset:0  lds
    s_add_u32 m0, s68, 2048
    s_add_u32 s69, s69, 10240
    buffer_load_dwordx4 v8, s[4:7], s69 offen offset:0  lds
    s_add_u32 m0, s68, 3072
    s_add_u32 s69, s69, 10240
    buffer_load_dwordx4 v9, s[4:7], s69 offen offset:0  lds
    s_add_u32 m0, s68, 4096
    s_add_u32 s69, s69, 10240
    buffer_load_dwordx4 v8, s[4:7], s69 offen offset:0  lds
    s_add_u32 m0, s68, 5120
    s_add_u32 s69, s69, 10240
    buffer_load_dwordx4 v9, s[4:7], s69 offen offset:0  lds
    s_add_u32 m0, s68, 6144
    s_add_u32 s69, s69, 10240
    buffer_load_dwordx4 v8, s[4:7], s69 offen offset:0  lds
    s_add_u32 m0, s68, 7168
    s_add_u32 s69, s69, 10240
    buffer_load_dwordx4 v9, s[4:7], s69 offen offset:0  lds
    s_add_u32 s62, s62, s64
    s_cmp_ge_u32 s62, s63
    s_cselect_b32 s3, s65, 0
    s_sub_u32 s62, s62, s3
    s_sub_u32 s3, s22, 5
    s_lshl_b32 s100, s3, 8
    s_add_u32 s100, s100, s2
    s_cmp_ge_u32 s100, 740
    s_cselect_b32 s29, 256, 0
    s_sub_u32 s100, s100, s29
    s_add_u32 s100, s100, 740
    s_lshl_b32 s101, s3, 12
    s_add_u32 s101, s101, 151552
    s_lshl_b32 s3, s58, 13
    s_add_u32 s68, s3, 36864
    s_mov_b32 s69, s62
    s_add_u32 m0, s68, 0
    s_nop 0
    buffer_load_dwordx4 v8, s[4:7], s69 offen offset:0  lds
    s_add_u32 m0, s68, 1024
    s_add_u32 s69, s69, 10240
    buffer_load_dwordx4 v9, s[4:7], s69 offen offset:0  lds
    s_add_u32 m0, s68, 2048
    s_add_u32 s69, s69, 10240
    buffer_load_dwordx4 v8, s[4:7], s69 offen offset:0  lds
    s_add_u32 m0, s68, 3072
    s_add_u32 s69, s69, 10240
    buffer_load_dwordx4 v9, s[4:7], s69 offen offset:0  lds
    s_add_u32 m0, s68, 4096
    s_add_u32 s69, s69, 10240
    buffer_load_dwordx4 v8, s[4:7], s69 offen offset:0  lds
    s_add_u32 m0, s68, 5120
    s_add_u32 s69, s69, 10240
    buffer_load_dwordx4 v9, s[4:7], s69 offen offset:0  lds
    s_add_u32 m0, s68, 6144
    s_add_u32 s69, s69, 10240
    buffer_load_dwordx4 v8, s[4:7], s69 offen offset:0  lds
    s_add_u32 m0, s68, 7168
    s_add_u32 s69, s69, 10240
    buffer_load_dwordx4 v9, s[4:7], s69 offen offset:0  lds
    s_add_u32 s62, s62, s64
    s_cmp_ge_u32 s62, s63
    s_cselect_b32 s3, s65, 0
    s_sub_u32 s62, s62, s3
    s_mov_b32 s95, 0x20000
    v_lshrrev_b32 v236, 5, v1
    v_bfe_u32 v237, v1, 3, 2
    v_and_b32 v238, 7, v1
    v_lshlrev_b32 v238, 4, v238
    v_lshrrev_b32 v239, 4, v1
    v_lshlrev_b32 v239, 3, v239
    v_bfe_u32 v240, v1, 2, 2
    v_add_u32 v239, v239, v240
    v_lshlrev_b32 v239, 7, v239
    v_and_b32 v240, 3, v1
    v_lshlrev_b32 v241, 2, v1
    v_lshlrev_b32 v251, 4, v1
    v_mov_b32 v196, 0x3f803f80
    v_mov_b32 v197, 0x3f803f80
    v_mov_b32 v198, 0x3f803f80
    v_mov_b32 v199, 0x3f803f80
    s_sub_u32 s3, s22, 4
    s_mul_i32 s3, s3, 25600
    s_mul_i32 s56, s28, 102400
    s_add_u32 s56, s56, s3
    s_add_u32 s56, s56, 0x1600000
    v_add_u32 v3, s3, v2
    s_mul_i32 s57, s39, 143360
    s_add_u32 s57, s57, s3
    s_add_u32 s57, s57, 0x1790000
    s_waitcnt vmcnt(8)
    s_barrier
    s_lshl_b32 s3, s58, 13
    s_add_u32 s68, s3, 73728
    s_mov_b32 s69, s62
    s_add_u32 m0, s68, 0
    s_nop 0
    buffer_load_dwordx4 v8, s[4:7], s69 offen offset:0  lds
    s_add_u32 m0, s68, 1024
    s_add_u32 s69, s69, 10240
    buffer_load_dwordx4 v9, s[4:7], s69 offen offset:0  lds
    s_add_u32 m0, s68, 2048
    s_add_u32 s69, s69, 10240
    buffer_load_dwordx4 v8, s[4:7], s69 offen offset:0  lds
    s_add_u32 m0, s68, 3072
    s_add_u32 s69, s69, 10240
    buffer_load_dwordx4 v9, s[4:7], s69 offen offset:0  lds
    s_add_u32 m0, s68, 4096
    s_add_u32 s69, s69, 10240
    buffer_load_dwordx4 v8, s[4:7], s69 offen offset:0  lds
    s_add_u32 m0, s68, 5120
    s_add_u32 s69, s69, 10240
    buffer_load_dwordx4 v9, s[4:7], s69 offen offset:0  lds
    s_add_u32 m0, s68, 6144
    s_add_u32 s69, s69, 10240
    buffer_load_dwordx4 v8, s[4:7], s69 offen offset:0  lds
    s_add_u32 m0, s68, 7168
    s_add_u32 s69, s69, 10240
    buffer_load_dwordx4 v9, s[4:7], s69 offen offset:0  lds
    s_add_u32 s62, s62, s64
    s_cmp_ge_u32 s62, s63
    s_cselect_b32 s3, s65, 0
    s_sub_u32 s62, s62, s3
    s_lshl_b32 s3, s58, 13
    s_add_u32 s68, s3, 110592
    s_mov_b32 s69, s62
    s_add_u32 m0, s68, 0
    s_nop 0
    buffer_load_dwordx4 v8, s[4:7], s69 offen offset:0  lds
    s_add_u32 m0, s68, 1024
    s_add_u32 s69, s69, 10240
    buffer_load_dwordx4 v9, s[4:7], s69 offen offset:0  lds
    s_add_u32 m0, s68, 2048
    s_add_u32 s69, s69, 10240
    buffer_load_dwordx4 v8, s[4:7], s69 offen offset:0  lds
    s_add_u32 m0, s68, 3072
    s_add_u32 s69, s69, 10240
    buffer_load_dwordx4 v9, s[4:7], s69 offen offset:0  lds
    s_add_u32 m0, s68, 4096
    s_add_u32 s69, s69, 10240
    buffer_load_dwordx4 v8, s[4:7], s69 offen offset:0  lds
    s_add_u32 m0, s68, 5120
    s_add_u32 s69, s69, 10240
    buffer_load_dwordx4 v9, s[4:7], s69 offen offset:0  lds
    s_add_u32 m0, s68, 6144
    s_add_u32 s69, s69, 10240
    buffer_load_dwordx4 v8, s[4:7], s69 offen offset:0  lds
    s_add_u32 m0, s68, 7168
    s_add_u32 s69, s69, 10240
    buffer_load_dwordx4 v9, s[4:7], s69 offen offset:0  lds
    s_add_u32 s62, s62, s64
    s_cmp_ge_u32 s62, s63
    s_cselect_b32 s3, s65, 0
    s_sub_u32 s62, s62, s3
    s_waitcnt vmcnt(16)
    s_barrier
    s_lshl_b32 s3, s58, 13
    s_add_u32 s68, s3, 0
    s_mov_b32 s69, s62
    s_add_u32 m0, s68, 0
    s_nop 0
    buffer_load_dwordx4 v8, s[4:7], s69 offen offset:0  lds
    s_add_u32 m0, s68, 1024
    s_add_u32 s69, s69, 10240
    buffer_load_dwordx4 v9, s[4:7], s69 offen offset:0  lds
    s_add_u32 m0, s68, 2048
    s_add_u32 s69, s69, 10240
    buffer_load_dwordx4 v8, s[4:7], s69 offen offset:0  lds
    s_add_u32 m0, s68, 3072
    s_add_u32 s69, s69, 10240
    buffer_load_dwordx4 v9, s[4:7], s69 offen offset:0  lds
    s_add_u32 m0, s68, 4096
    s_add_u32 s69, s69, 10240
    buffer_load_dwordx4 v8, s[4:7], s69 offen offset:0  lds
    s_add_u32 m0, s68, 5120
    s_add_u32 s69, s69, 10240
    buffer_load_dwordx4 v9, s[4:7], s69 offen offset:0  lds
    s_add_u32 m0, s68, 6144
    s_add_u32 s69, s69, 10240
    buffer_load_dwordx4 v8, s[4:7], s69 offen offset:0  lds
    s_add_u32 m0, s68, 7168
    s_add_u32 s69, s69, 10240
    buffer_load_dwordx4 v9, s[4:7], s69 offen offset:0  lds
    s_add_u32 s62, s62, s64
    s_cmp_ge_u32 s62, s63
    s_cselect_b32 s3, s65, 0
    s_sub_u32 s62, s62, s3
    s_waitcnt vmcnt(16)
    s_barrier
    s_lshl_b32 s3, s58, 13
    s_add_u32 s68, s3, 36864
    s_mov_b32 s69, s62
    s_add_u32 m0, s68, 0
    s_nop 0
    buffer_load_dwordx4 v8, s[4:7], s69 offen offset:0  lds
    s_add_u32 m0, s68, 1024
    s_add_u32 s69, s69, 10240
    buffer_load_dwordx4 v9, s[4:7], s69 offen offset:0  lds
    s_add_u32 m0, s68, 2048
    s_add_u32 s69, s69, 10240
    buffer_load_dwordx4 v8, s[4:7], s69 offen offset:0  lds
    s_add_u32 m0, s68, 3072
    s_add_u32 s69, s69, 10240
    buffer_load_dwordx4 v9, s[4:7], s69 offen offset:0  lds
    s_add_u32 m0, s68, 4096
    s_add_u32 s69, s69, 10240
    buffer_load_dwordx4 v8, s[4:7], s69 offen offset:0  lds
    s_add_u32 m0, s68, 5120
    s_add_u32 s69, s69, 10240
    buffer_load_dwordx4 v9, s[4:7], s69 offen offset:0  lds
    s_add_u32 m0, s68, 6144
    s_add_u32 s69, s69, 10240
    buffer_load_dwordx4 v8, s[4:7], s69 offen offset:0  lds
    s_add_u32 m0, s68, 7168
    s_add_u32 s69, s69, 10240
    buffer_load_dwordx4 v9, s[4:7], s69 offen offset:0  lds
    s_add_u32 s62, s62, s64
    s_cmp_ge_u32 s62, s63
    s_cselect_b32 s3, s65, 0
    s_sub_u32 s62, s62, s3
    s_call_b64 s[70:71], Lpk_issue
    s_waitcnt vmcnt(20)
    s_barrier
    s_lshl_b32 s3, s58, 13
    s_add_u32 s68, s3, 73728
    s_mov_b32 s69, s62
    s_add_u32 m0, s68, 0
    s_nop 0
    buffer_load_dwordx4 v8, s[4:7], s69 offen offset:0  lds
    s_add_u32 m0, s68, 1024
    s_add_u32 s69, s69, 10240
    buffer_load_dwordx4 v9, s[4:7], s69 offen offset:0  lds
    s_add_u32 m0, s68, 2048
    s_add_u32 s69, s69, 10240
    buffer_load_dwordx4 v8, s[4:7], s69 offen offset:0  lds
    s_add_u32 m0, s68, 3072
    s_add_u32 s69, s69, 10240
    buffer_load_dwordx4 v9, s[4:7], s69 offen offset:0  lds
    s_add_u32 m0, s68, 4096
    s_add_u32 s69, s69, 10240
    buffer_load_dwordx4 v8, s[4:7], s69 offen offset:0  lds
    s_add_u32 m0, s68, 5120
    s_add_u32 s69, s69, 10240
    buffer_load_dwordx4 v9, s[4:7], s69 offen offset:0  lds
    s_add_u32 m0, s68, 6144
    s_add_u32 s69, s69, 10240
    buffer_load_dwordx4 v8, s[4:7], s69 offen offset:0  lds
    s_add_u32 m0, s68, 7168
    s_add_u32 s69, s69, 10240
    buffer_load_dwordx4 v9, s[4:7], s69 offen offset:0  lds
    s_add_u32 s62, s62, s64
    s_cmp_ge_u32 s62, s63
    s_cselect_b32 s3, s65, 0
    s_sub_u32 s62, s62, s3
    s_waitcnt vmcnt(20)
    s_barrier
    s_lshl_b32 s3, s58, 13
    s_add_u32 s68, s3, 110592
    s_mov_b32 s69, s62
    s_add_u32 m0, s68, 0
    s_nop 0
    buffer_load_dwordx4 v8, s[4:7], s69 offen offset:0  lds
    s_add_u32 m0, s68, 1024
    s_add_u32 s69, s69, 10240
    buffer_load_dwordx4 v9, s[4:7], s69 offen offset:0  lds
    s_add_u32 m0, s68, 2048
    s_add_u32 s69, s69, 10240
    buffer_load_dwordx4 v8, s[4:7], s69 offen offset:0  lds
    s_add_u32 m0, s68, 3072
    s_add_u32 s69, s69, 10240
    buffer_load_dwordx4 v9, s[4:7], s69 offen offset:0  lds
    s_add_u32 m0, s68, 4096
    s_add_u32 s69, s69, 10240
    buffer_load_dwordx4 v8, s[4:7], s69 offen offset:0  lds
    s_add_u32 m0, s68, 5120
    s_add_u32 s69, s69, 10240
    buffer_load_dwordx4 v9, s[4:7], s69 offen offset:0  lds
    s_add_u32 m0, s68, 6144
    s_add_u32 s69, s69, 10240
    buffer_load_dwordx4 v8, s[4:7], s69 offen offset:0  lds
    s_add_u32 m0, s68, 7168
    s_add_u32 s69, s69, 10240
    buffer_load_dwordx4 v9, s[4:7], s69 offen offset:0  lds
    s_add_u32 s62, s62, s64
    s_cmp_ge_u32 s62, s63
    s_cselect_b32 s3, s65, 0
    s_sub_u32 s62, s62, s3
    s_waitcnt vmcnt(20)
    s_barrier
    s_lshl_b32 s3, s58, 13
    s_add_u32 s68, s3, 0
    s_mov_b32 s69, s62
    s_add_u32 m0, s68, 0
    s_nop 0
    buffer_load_dwordx4 v8, s[4:7], s69 offen offset:0  lds
    s_add_u32 m0, s68, 1024
    s_add_u32 s69, s69, 10240
    buffer_load_dwordx4 v9, s[4:7], s69 offen offset:0  lds
    s_add_u32 m0, s68, 2048
    s_add_u32 s69, s69, 10240
    buffer_load_dwordx4 v8, s[4:7], s69 offen offset:0  lds
    s_add_u32 m0, s68, 3072
    s_add_u32 s69, s69, 10240
    buffer_load_dwordx4 v9, s[4:7], s69 offen offset:0  lds
    s_add_u32 m0, s68, 4096
    s_add_u32 s69, s69, 10240
    buffer_load_dwordx4 v8, s[4:7], s69 offen offset:0  lds
    s_add_u32 m0, s68, 5120
    s_add_u32 s69, s69, 10240
    buffer_load_dwordx4 v9, s[4:7], s69 offen offset:0  lds
    s_add_u32 m0, s68, 6144
    s_add_u32 s69, s69, 10240
    buffer_load_dwordx4 v8, s[4:7], s69 offen offset:0  lds
    s_add_u32 m0, s68, 7168
    s_add_u32 s69, s69, 10240
    buffer_load_dwordx4 v9, s[4:7], s69 offen offset:0  lds
    s_add_u32 s62, s62, s64
    s_cmp_ge_u32 s62, s63
    s_cselect_b32 s3, s65, 0
    s_sub_u32 s62, s62, s3
    s_waitcnt vmcnt(24)
    s_call_b64 s[70:71], Lpk_fin
    buffer_load_dwordx4 v[120:123], v2, s[8:11], s56 offen offset:0 sc1
    buffer_load_dwordx4 v[124:127], v2, s[8:11], s56 offen offset:1024 sc1
    buffer_load_dwordx4 v[128:131], v2, s[8:11], s56 offen offset:2048 sc1
    buffer_load_dwordx4 v[132:135], v2, s[8:11], s56 offen offset:3072 sc1
    s_add_u32 s56, s56, 4096
    buffer_load_dwordx4 v[136:139], v2, s[8:11], s56 offen offset:0 sc1
    buffer_load_dwordx4 v[140:143], v2, s[8:11], s56 offen offset:1024 sc1
    buffer_load_dwordx4 v[144:147], v2, s[8:11], s56 offen offset:2048 sc1
    buffer_load_dwordx4 v[148:151], v2, s[8:11], s56 offen offset:3072 sc1
    s_waitcnt vmcnt(32)
    s_barrier
    s_lshl_b32 s3, s58, 13
    s_add_u32 s68, s3, 36864
    s_mov_b32 s69, s62
    s_add_u32 m0, s68, 0
    s_nop 0
    buffer_load_dwordx4 v8, s[4:7], s69 offen offset:0  lds
    s_add_u32 m0, s68, 1024
    s_add_u32 s69, s69, 10240
    buffer_load_dwordx4 v9, s[4:7], s69 offen offset:0  lds
    s_add_u32 m0, s68, 2048
    s_add_u32 s69, s69, 10240
    buffer_load_dwordx4 v8, s[4:7], s69 offen offset:0  lds
    s_add_u32 m0, s68, 3072
    s_add_u32 s69, s69, 10240
    buffer_load_dwordx4 v9, s[4:7], s69 offen offset:0  lds
    s_add_u32 m0, s68, 4096
    s_add_u32 s69, s69, 10240
    buffer_load_dwordx4 v8, s[4:7], s69 offen offset:0  lds
    s_add_u32 m0, s68, 5120
    s_add_u32 s69, s69, 10240
    buffer_load_dwordx4 v9, s[4:7], s69 offen offset:0  lds
    s_add_u32 m0, s68, 6144
    s_add_u32 s69, s69, 10240
    buffer_load_dwordx4 v8, s[4:7], s69 offen offset:0  lds
    s_add_u32 m0, s68, 7168
    s_add_u32 s69, s69, 10240
    buffer_load_dwordx4 v9, s[4:7], s69 offen offset:0  lds
    s_add_u32 s62, s62, s64
    s_cmp_ge_u32 s62, s63
    s_cselect_b32 s3, s65, 0
    s_sub_u32 s62, s62, s3
    s_add_u32 s56, s56, 4096
    buffer_load_dwordx4 v[152:155], v2, s[8:11], s56 offen offset:0 sc1
    buffer_load_dwordx4 v[156:159], v2, s[8:11], s56 offen offset:1024 sc1
    buffer_load_dwordx4 v[160:163], v2, s[8:11], s56 offen offset:2048 sc1
    buffer_load_dwordx4 v[164:167], v2, s[8:11], s56 offen offset:3072 sc1
    s_add_u32 s56, s56, 4096
    buffer_load_dwordx4 v[168:171], v2, s[8:11], s56 offen offset:0 sc1
    buffer_load_dwordx4 v[172:175], v2, s[8:11], s56 offen offset:1024 sc1
    buffer_load_dwordx4 v[176:179], v2, s[8:11], s56 offen offset:2048 sc1
    buffer_load_dwordx4 v[180:183], v2, s[8:11], s56 offen offset:3072 sc1
    s_add_u32 s56, s56, 4096
    buffer_load_dwordx4 v[184:187], v2, s[8:11], s56 offen offset:0 sc1
    buffer_load_dwordx4 v[188:191], v2, s[8:11], s56 offen offset:1024 sc1
    s_waitcnt vmcnt(42)
    s_waitcnt vmcnt(26)
    s_barrier
    buffer_load_dwordx4 v[192:195], v2, s[8:11], s56 offen offset:2048 sc1
    buffer_load_dwordx4 v[196:199], v2, s[8:11], s56 offen offset:3072 sc1
    s_add_u32 s56, s56, 4096
    buffer_load_dwordx4 v[200:203], v2, s[8:11], s56 offen offset:0 sc1
    buffer_load_dwordx4 v[204:207], v2, s[8:11], s56 offen offset:1024 sc1
    buffer_load_dwordx4 v[208:211], v2, s[8:11], s56 offen offset:2048 sc1
    buffer_load_dwordx4 v[212:215], v2, s[8:11], s56 offen offset:3072 sc1
    s_add_u32 s56, s56, 4096
    buffer_load_dwordx4 v[216:219], v2, s[8:11], s56 offen offset:0 sc1
    buffer_load_dwordx4 v[20:23], v2, s[8:11], s57 offen offset:0 sc1
    buffer_load_dwordx4 v[24:27], v2, s[8:11], s57 offen offset:1024 sc1
    buffer_load_dwordx4 v[28:31], v2, s[8:11], s57 offen offset:2048 sc1
    s_barrier
    buffer_load_dwordx4 v[32:35], v2, s[8:11], s57 offen offset:3072 sc1
    s_add_u32 s57, s57, 4096
    buffer_load_dwordx4 v[36:39], v2, s[8:11], s57 offen offset:0 sc1
    buffer_load_dwordx4 v[40:43], v2, s[8:11], s57 offen offset:1024 sc1
    buffer_load_dwordx4 v[44:47], v2, s[8:11], s57 offen offset:2048 sc1
    buffer_load_dwordx4 v[48:51], v2, s[8:11], s57 offen offset:3072 sc1
    s_add_u32 s57, s57, 4096
    buffer_load_dwordx4 v[52:55], v2, s[8:11], s57 offen offset:0 sc1
    buffer_load_dwordx4 v[56:59], v2, s[8:11], s57 offen offset:1024 sc1
    buffer_load_dwordx4 v[60:63], v2, s[8:11], s57 offen offset:2048 sc1
    buffer_load_dwordx4 v[64:67], v2, s[8:11], s57 offen offset:3072 sc1
    s_add_u32 s57, s57, 4096
    buffer_load_dwordx4 v[68:71], v2, s[8:11], s57 offen offset:0 sc1
    s_waitcnt vmcnt(30)
    s_barrier
    buffer_load_dwordx4 v[72:75], v2, s[8:11], s57 offen offset:1024 sc1
    buffer_load_dwordx4 v[76:79], v2, s[8:11], s57 offen offset:2048 sc1
    buffer_load_dwordx4 v[80:83], v2, s[8:11], s57 offen offset:3072 sc1
    s_add_u32 s57, s57, 4096
    buffer_load_dwordx4 v[84:87], v2, s[8:11], s57 offen offset:0 sc1
    buffer_load_dwordx4 v[88:91], v2, s[8:11], s57 offen offset:1024 sc1
    buffer_load_dwordx4 v[92:95], v2, s[8:11], s57 offen offset:2048 sc1
    buffer_load_dwordx4 v[96:99], v2, s[8:11], s57 offen offset:3072 sc1
    s_add_u32 s57, s57, 4096
    buffer_load_dwordx4 v[100:103], v2, s[8:11], s57 offen offset:0 sc1
    buffer_load_dwordx4 v[104:107], v2, s[8:11], s57 offen offset:1024 sc1
    buffer_load_dwordx4 v[108:111], v2, s[8:11], s57 offen offset:2048 sc1
    s_branch Ltail
Lwload:
    s_and_b32 s58, s22, 1
    v_lshlrev_b32 v2, 4, v1
    s_movk_i32 s60, 3840
    s_cmp_ge_u32 s24, 12
    s_cselect_b32 s60, 1280, s60
    s_cselect_b32 s3, 12, 0
    s_sub_u32 s3, s24, s3
    s_mul_i32 s61, s3, 320
    v_add_u32 v4, 0, v1
    v_mul_u32_u24 v5, 3277, v4
    v_lshrrev_b32 v5, 16, v5
    v_mul_u32_u24 v6, 20, v5
    v_sub_u32 v6, v4, v6
    v_lshrrev_b32 v7, 2, v5
    v_and_b32 v7, 2, v7
    v_xor_b32 v6, v6, v7
    v_mul_lo_u32 v5, v5, s60
    v_lshl_add_u32 v8, v6, 4, v5
    v_add_u32 v4, 64, v1
    v_mul_u32_u24 v5, 3277, v4
    v_lshrrev_b32 v5, 16, v5
    v_mul_u32_u24 v6, 20, v5
    v_sub_u32 v6, v4, v6
    v_lshrrev_b32 v7, 2, v5
    v_and_b32 v7, 2, v7
    v_xor_b32 v6, v6, v7
    v_mul_lo_u32 v5, v5, s60
    v_lshl_add_u32 v9, v6, 4, v5
    v_add_u32 v4, 128, v1
    v_mul_u32_u24 v5, 3277, v4
    v_lshrrev_b32 v5, 16, v5
    v_mul_u32_u24 v6, 20, v5
    v_sub_u32 v6, v4, v6
    v_lshrrev_b32 v7, 2, v5
    v_and_b32 v7, 2, v7
    v_xor_b32 v6, v6, v7
    v_mul_lo_u32 v5, v5, s60
    v_lshl_add_u32 v10, v6, 4, v5
    v_add_u32 v4, 192, v1
    v_mul_u32_u24 v5, 3277, v4
    v_lshrrev_b32 v5, 16, v5
    v_mul_u32_u24 v6, 20, v5
    v_sub_u32 v6, v4, v6
    v_lshrrev_b32 v7, 2, v5
    v_and_b32 v7, 2, v7
    v_xor_b32 v6, v6, v7
    v_mul_lo_u32 v5, v5, s60
    v_lshl_add_u32 v11, v6, 4, v5
    v_add_u32 v4, 256, v1
    v_mul_u32_u24 v5, 3277, v4
    v_lshrrev_b32 v5, 16, v5
    v_mul_u32_u24 v6, 20, v5
    v_sub_u32 v6, v4, v6
    v_lshrrev_b32 v7, 2, v5
    v_and_b32 v7, 2, v7
    v_xor_b32 v6, v6, v7
    v_mul_lo_u32 v5, v5, s60
    v_lshl_add_u32 v12, v6, 4, v5
    s_lshl_b32 s3, s58, 5
    s_mul_i32 s66, s3, s60
    s_add_u32 s66, s66, s61
    s_lshl_b32 s64, s60, 6
    s_lshl_b32 s67, s60, 4
    s_add_u32 s3, s23, s24
    s_mul_i32 s3, s3, 3
    s_mul_i32 s29, s3, 6554
    s_lshr_b32 s29, s29, 16
    s_mul_i32 s29, s29, 10
    s_sub_u32 s59, s3, s29
    s_mul_i32 s65, s64, 10
    s_add_u32 s63, s66, s65
    s_mul_i32 s3, s59, s64
    s_add_u32 s62, s66, s3
    s_mul_i32 s3, s58, 10240
    s_add_u32 s68, s3, 16384
    s_add_u32 s69, s62, s67
    s_add_u32 m0, s68, 0
    s_nop 0
    buffer_load_dwordx4 v8, s[12:15], s62 offen offset:0  lds
    s_add_u32 m0, s68, 1024
    s_nop 0
    buffer_load_dwordx4 v9, s[12:15], s62 offen offset:0  lds
    s_add_u32 m0, s68, 2048
    s_nop 0
    buffer_load_dwordx4 v10, s[12:15], s62 offen offset:0  lds
    s_add_u32 m0, s68, 3072
    s_nop 0
    buffer_load_dwordx4 v11, s[12:15], s62 offen offset:0  lds
    s_add_u32 m0, s68, 4096
    s_nop 0
    buffer_load_dwordx4 v12, s[12:15], s62 offen offset:0  lds
    s_add_u32 m0, s68, 5120
    s_nop 0
    buffer_load_dwordx4 v8, s[12:15], s69 offen offset:0  lds
    s_add_u32 m0, s68, 6144
    s_nop 0
    buffer_load_dwordx4 v9, s[12:15], s69 offen offset:0  lds
    s_add_u32 m0, s68, 7168
    s_nop 0
    buffer_load_dwordx4 v10, s[12:15], s69 offen offset:0  lds
    s_add_u32 m0, s68, 8192
    s_nop 0
    buffer_load_dwordx4 v11, s[12:15], s69 offen offset:0  lds
    s_add_u32 m0, s68, 9216
    s_nop 0
    buffer_load_dwordx4 v12, s[12:15], s69 offen offset:0  lds
    s_add_u32 s62, s62, s64
    s_cmp_ge_u32 s62, s63
    s_cselect_b32 s3, s65, 0
    s_sub_u32 s62, s62, s3
    s_sub_u32 s3, s22, 5
    s_lshl_b32 s100, s3, 8
    s_add_u32 s100, s100, s2
    s_cmp_ge_u32 s100, 740
    s_cselect_b32 s29, 256, 0
    s_sub_u32 s100, s100, s29
    s_add_u32 s100, s100, 740
    s_lshl_b32 s101, s3, 12
    s_add_u32 s101, s101, 151552
    s_mul_i32 s3, s58, 10240
    s_add_u32 s68, s3, 53248
    s_add_u32 s69, s62, s67
    s_add_u32 m0, s68, 0
    s_nop 0
    buffer_load_dwordx4 v8, s[12:15], s62 offen offset:0  lds
    s_add_u32 m0, s68, 1024
    s_nop 0
    buffer_load_dwordx4 v9, s[12:15], s62 offen offset:0  lds
    s_add_u32 m0, s68, 2048
    s_nop 0
    buffer_load_dwordx4 v10, s[12:15], s62 offen offset:0  lds
    s_add_u32 m0, s68, 3072
    s_nop 0
    buffer_load_dwordx4 v11, s[12:15], s62 offen offset:0  lds
    s_add_u32 m0, s68, 4096
    s_nop 0
    buffer_load_dwordx4 v12, s[12:15], s62 offen offset:0  lds
    s_add_u32 m0, s68, 5120
    s_nop 0
    buffer_load_dwordx4 v8, s[12:15], s69 offen offset:0  lds
    s_add_u32 m0, s68, 6144
    s_nop 0
    buffer_load_dwordx4 v9, s[12:15], s69 offen offset:0  lds
    s_add_u32 m0, s68, 7168
    s_nop 0
    buffer_load_dwordx4 v10, s[12:15], s69 offen offset:0  lds
    s_add_u32 m0, s68, 8192
    s_nop 0
    buffer_load_dwordx4 v11, s[12:15], s69 offen offset:0  lds
    s_add_u32 m0, s68, 9216
    s_nop 0
    buffer_load_dwordx4 v12, s[12:15], s69 offen offset:0  lds
    s_add_u32 s62, s62, s64
    s_cmp_ge_u32 s62, s63
    s_cselect_b32 s3, s65, 0
    s_sub_u32 s62, s62, s3
    s_mov_b32 s95, 0x20000
    v_lshrrev_b32 v236, 5, v1
    v_bfe_u32 v237, v1, 3, 2
    v_and_b32 v238, 7, v1
    v_lshlrev_b32 v238, 4, v238
    v_lshrrev_b32 v239, 4, v1
    v_lshlrev_b32 v239, 3, v239
    v_bfe_u32 v240, v1, 2, 2
    v_add_u32 v239, v239, v240
    v_lshlrev_b32 v239, 7, v239
    v_and_b32 v240, 3, v1
    v_lshlrev_b32 v241, 2, v1
    v_lshlrev_b32 v251, 4, v1
    v_mov_b32 v196, 0x3f803f80
    v_mov_b32 v197, 0x3f803f80
    v_mov_b32 v198, 0x3f803f80
    v_mov_b32 v199, 0x3f803f80
    s_sub_u32 s3, s22, 4
    s_mul_i32 s3, s3, 25600
    s_mul_i32 s56, s28, 102400
    s_add_u32 s56, s56, s3
    s_add_u32 s56, s56, 0x1600000
    v_add_u32 v3, s3, v2
    s_mul_i32 s57, s39, 143360
    s_add_u32 s57, s57, s3
    s_add_u32 s57, s57, 0x1790000
    s_waitcnt vmcnt(10)
    s_barrier
    s_mul_i32 s3, s58, 10240
    s_add_u32 s68, s3, 90112
    s_add_u32 s69, s62, s67
    s_add_u32 m0, s68, 0
    s_nop 0
    buffer_load_dwordx4 v8, s[12:15], s62 offen offset:0  lds
    s_add_u32 m0, s68, 1024
    s_nop 0
    buffer_load_dwordx4 v9, s[12:15], s62 offen offset:0  lds
    s_add_u32 m0, s68, 2048
    s_nop 0
    buffer_load_dwordx4 v10, s[12:15], s62 offen offset:0  lds
    s_add_u32 m0, s68, 3072
    s_nop 0
    buffer_load_dwordx4 v11, s[12:15], s62 offen offset:0  lds
    s_add_u32 m0, s68, 4096
    s_nop 0
    buffer_load_dwordx4 v12, s[12:15], s62 offen offset:0  lds
    s_add_u32 m0, s68, 5120
    s_nop 0
    buffer_load_dwordx4 v8, s[12:15], s69 offen offset:0  lds
    s_add_u32 m0, s68, 6144
    s_nop 0
    buffer_load_dwordx4 v9, s[12:15], s69 offen offset:0  lds
    s_add_u32 m0, s68, 7168
    s_nop 0
    buffer_load_dwordx4 v10, s[12:15], s69 offen offset:0  lds
    s_add_u32 m0, s68, 8192
    s_nop 0
    buffer_load_dwordx4 v11, s[12:15], s69 offen offset:0  lds
    s_add_u32 m0, s68, 9216
    s_nop 0
    buffer_load_dwordx4 v12, s[12:15], s69 offen offset:0  lds
    s_add_u32 s62, s62, s64
    s_cmp_ge_u32 s62, s63
    s_cselect_b32 s3, s65, 0
    s_sub_u32 s62, s62, s3
    s_mul_i32 s3, s58, 10240
    s_add_u32 s68, s3, 126976
    s_add_u32 s69, s62, s67
    s_add_u32 m0, s68, 0
    s_nop 0
    buffer_load_dwordx4 v8, s[12:15], s62 offen offset:0  lds
    s_add_u32 m0, s68, 1024
    s_nop 0
    buffer_load_dwordx4 v9, s[12:15], s62 offen offset:0  lds
    s_add_u32 m0, s68, 2048
    s_nop 0
    buffer_load_dwordx4 v10, s[12:15], s62 offen offset:0  lds
    s_add_u32 m0, s68, 3072
    s_nop 0
    buffer_load_dwordx4 v11, s[12:15], s62 offen offset:0  lds
    s_add_u32 m0, s68, 4096
    s_nop 0
    buffer_load_dwordx4 v12, s[12:15], s62 offen offset:0  lds
    s_add_u32 m0, s68, 5120
    s_nop 0
    buffer_load_dwordx4 v8, s[12:15], s69 offen offset:0  lds
    s_add_u32 m0, s68, 6144
    s_nop 0
    buffer_load_dwordx4 v9, s[12:15], s69 offen offset:0  lds
    s_add_u32 m0, s68, 7168
    s_nop 0
    buffer_load_dwordx4 v10, s[12:15], s69 offen offset:0  lds
    s_add_u32 m0, s68, 8192
    s_nop 0
    buffer_load_dwordx4 v11, s[12:15], s69 offen offset:0  lds
    s_add_u32 m0, s68, 9216
    s_nop 0
    buffer_load_dwordx4 v12, s[12:15], s69 offen offset:0  lds
    s_add_u32 s62, s62, s64
    s_cmp_ge_u32 s62, s63
    s_cselect_b32 s3, s65, 0
    s_sub_u32 s62, s62, s3
    s_waitcnt vmcnt(20)
    s_barrier
    s_mul_i32 s3, s58, 10240
    s_add_u32 s68, s3, 16384
    s_add_u32 s69, s62, s67
    s_add_u32 m0, s68, 0
    s_nop 0
    buffer_load_dwordx4 v8, s[12:15], s62 offen offset:0  lds
    s_add_u32 m0, s68, 1024
    s_nop 0
    buffer_load_dwordx4 v9, s[12:15], s62 offen offset:0  lds
    s_add_u32 m0, s68, 2048
    s_nop 0
    buffer_load_dwordx4 v10, s[12:15], s62 offen offset:0  lds
    s_add_u32 m0, s68, 3072
    s_nop 0
    buffer_load_dwordx4 v11, s[12:15], s62 offen offset:0  lds
    s_add_u32 m0, s68, 4096
    s_nop 0
    buffer_load_dwordx4 v12, s[12:15], s62 offen offset:0  lds
    s_add_u32 m0, s68, 5120
    s_nop 0
    buffer_load_dwordx4 v8, s[12:15], s69 offen offset:0  lds
    s_add_u32 m0, s68, 6144
    s_nop 0
    buffer_load_dwordx4 v9, s[12:15], s69 offen offset:0  lds
    s_add_u32 m0, s68, 7168
    s_nop 0
    buffer_load_dwordx4 v10, s[12:15], s69 offen offset:0  lds
    s_add_u32 m0, s68, 8192
    s_nop 0
    buffer_load_dwordx4 v11, s[12:15], s69 offen offset:0  lds
    s_add_u32 m0, s68, 9216
    s_nop 0
    buffer_load_dwordx4 v12, s[12:15], s69 offen offset:0  lds
    s_add_u32 s62, s62, s64
    s_cmp_ge_u32 s62, s63
    s_cselect_b32 s3, s65, 0
    s_sub_u32 s62, s62, s3
    s_waitcnt vmcnt(20)
    s_barrier
    s_mul_i32 s3, s58, 10240
    s_add_u32 s68, s3, 53248
    s_add_u32 s69, s62, s67
    s_add_u32 m0, s68, 0
    s_nop 0
    buffer_load_dwordx4 v8, s[12:15], s62 offen offset:0  lds
    s_add_u32 m0, s68, 1024
    s_nop 0
    buffer_load_dwordx4 v9, s[12:15], s62 offen offset:0  lds
    s_add_u32 m0, s68, 2048
    s_nop 0
    buffer_load_dwordx4 v10, s[12:15], s62 offen offset:0  lds
    s_add_u32 m0, s68, 3072
    s_nop 0
    buffer_load_dwordx4 v11, s[12:15], s62 offen offset:0  lds
    s_add_u32 m0, s68, 4096
    s_nop 0
    buffer_load_dwordx4 v12, s[12:15], s62 offen offset:0  lds
    s_add_u32 m0, s68, 5120
    s_nop 0
    buffer_load_dwordx4 v8, s[12:15], s69 offen offset:0  lds
    s_add_u32 m0, s68, 6144
    s_nop 0
    buffer_load_dwordx4 v9, s[12:15], s69 offen offset:0  lds
    s_add_u32 m0, s68, 7168
    s_nop 0
    buffer_load_dwordx4 v10, s[12:15], s69 offen offset:0  lds
    s_add_u32 m0, s68, 8192
    s_nop 0
    buffer_load_dwordx4 v11, s[12:15], s69 offen offset:0  lds
    s_add_u32 m0, s68, 9216
    s_nop 0
    buffer_load_dwordx4 v12, s[12:15], s69 offen offset:0  lds
    s_add_u32 s62, s62, s64
    s_cmp_ge_u32 s62, s63
    s_cselect_b32 s3, s65, 0
    s_sub_u32 s62, s62, s3
    s_call_b64 s[70:71], Lpk_issue
    s_waitcnt vmcnt(24)
    s_barrier
    s_mul_i32 s3, s58, 10240
    s_add_u32 s68, s3, 90112
    s_add_u32 s69, s62, s67
    s_add_u32 m0, s68, 0
    s_nop 0
    buffer_load_dwordx4 v8, s[12:15], s62 offen offset:0  lds
    s_add_u32 m0, s68, 1024
    s_nop 0
    buffer_load_dwordx4 v9, s[12:15], s62 offen offset:0  lds
    s_add_u32 m0, s68, 2048
    s_nop 0
    buffer_load_dwordx4 v10, s[12:15], s62 offen offset:0  lds
    s_add_u32 m0, s68, 3072
    s_nop 0
    buffer_load_dwordx4 v11, s[12:15], s62 offen offset:0  lds
    s_add_u32 m0, s68, 4096
    s_nop 0
    buffer_load_dwordx4 v12, s[12:15], s62 offen offset:0  lds
    s_add_u32 m0, s68, 5120
    s_nop 0
    buffer_load_dwordx4 v8, s[12:15], s69 offen offset:0  lds
    s_add_u32 m0, s68, 6144
    s_nop 0
    buffer_load_dwordx4 v9, s[12:15], s69 offen offset:0  lds
    s_add_u32 m0, s68, 7168
    s_nop 0
    buffer_load_dwordx4 v10, s[12:15], s69 offen offset:0  lds
    s_add_u32 m0, s68, 8192
    s_nop 0
    buffer_load_dwordx4 v11, s[12:15], s69 offen offset:0  lds
    s_add_u32 m0, s68, 9216
    s_nop 0
    buffer_load_dwordx4 v12, s[12:15], s69 offen offset:0  lds
    s_add_u32 s62, s62, s64
    s_cmp_ge_u32 s62, s63
    s_cselect_b32 s3, s65, 0
    s_sub_u32 s62, s62, s3
    s_waitcnt vmcnt(24)
    s_barrier
    s_mul_i32 s3, s58, 10240
    s_add_u32 s68, s3, 126976
    s_add_u32 s69, s62, s67
    s_add_u32 m0, s68, 0
    s_nop 0
    buffer_load_dwordx4 v8, s[12:15], s62 offen offset:0  lds
    s_add_u32 m0, s68, 1024
    s_nop 0
    buffer_load_dwordx4 v9, s[12:15], s62 offen offset:0  lds
    s_add_u32 m0, s68, 2048
    s_nop 0
    buffer_load_dwordx4 v10, s[12:15], s62 offen offset:0  lds
    s_add_u32 m0, s68, 3072
    s_nop 0
    buffer_load_dwordx4 v11, s[12:15], s62 offen offset:0  lds
    s_add_u32 m0, s68, 4096
    s_nop 0
    buffer_load_dwordx4 v12, s[12:15], s62 offen offset:0  lds
    s_add_u32 m0, s68, 5120
    s_nop 0
    buffer_load_dwordx4 v8, s[12:15], s69 offen offset:0  lds
    s_add_u32 m0, s68, 6144
    s_nop 0
    buffer_load_dwordx4 v9, s[12:15], s69 offen offset:0  lds
    s_add_u32 m0, s68, 7168
    s_nop 0
    buffer_load_dwordx4 v10, s[12:15], s69 offen offset:0  lds
    s_add_u32 m0, s68, 8192
    s_nop 0
    buffer_load_dwordx4 v11, s[12:15], s69 offen offset:0  lds
    s_add_u32 m0, s68, 9216
    s_nop 0
    buffer_load_dwordx4 v12, s[12:15], s69 offen offset:0  lds
    s_add_u32 s62, s62, s64
    s_cmp_ge_u32 s62, s63
    s_cselect_b32 s3, s65, 0
    s_sub_u32 s62, s62, s3
    s_waitcnt vmcnt(24)
    s_barrier
    s_mul_i32 s3, s58, 10240
    s_add_u32 s68, s3, 16384
    s_add_u32 s69, s62, s67
    s_add_u32 m0, s68, 0
    s_nop 0
    buffer_load_dwordx4 v8, s[12:15], s62 offen offset:0  lds
    s_add_u32 m0, s68, 1024
    s_nop 0
    buffer_load_dwordx4 v9, s[12:15], s62 offen offset:0  lds
    s_add_u32 m0, s68, 2048
    s_nop 0
    buffer_load_dwordx4 v10, s[12:15], s62 offen offset:0  lds
    s_add_u32 m0, s68, 3072
    s_nop 0
    buffer_load_dwordx4 v11, s[12:15], s62 offen offset:0  lds
    s_add_u32 m0, s68, 4096
    s_nop 0
    buffer_load_dwordx4 v12, s[12:15], s62 offen offset:0  lds
    s_add_u32 m0, s68, 5120
    s_nop 0
    buffer_load_dwordx4 v8, s[12:15], s69 offen offset:0  lds
    s_add_u32 m0, s68, 6144
    s_nop 0
    buffer_load_dwordx4 v9, s[12:15], s69 offen offset:0  lds
    s_add_u32 m0, s68, 7168
    s_nop 0
    buffer_load_dwordx4 v10, s[12:15], s69 offen offset:0  lds
    s_add_u32 m0, s68, 8192
    s_nop 0
    buffer_load_dwordx4 v11, s[12:15], s69 offen offset:0  lds
    s_add_u32 m0, s68, 9216
    s_nop 0
    buffer_load_dwordx4 v12, s[12:15], s69 offen offset:0  lds
    s_add_u32 s62, s62, s64
    s_cmp_ge_u32 s62, s63
    s_cselect_b32 s3, s65, 0
    s_sub_u32 s62, s62, s3
    s_waitcnt vmcnt(30)
    s_call_b64 s[70:71], Lpk_fin
    buffer_load_dwordx4 v[120:123], v2, s[8:11], s56 offen offset:0 sc1
    buffer_load_dwordx4 v[124:127], v2, s[8:11], s56 offen offset:1024 sc1
    buffer_load_dwordx4 v[128:131], v2, s[8:11], s56 offen offset:2048 sc1
    buffer_load_dwordx4 v[132:135], v2, s[8:11], s56 offen offset:3072 sc1
    s_add_u32 s56, s56, 4096
    buffer_load_dwordx4 v[136:139], v2, s[8:11], s56 offen offset:0 sc1
    buffer_load_dwordx4 v[140:143], v2, s[8:11], s56 offen offset:1024 sc1
    buffer_load_dwordx4 v[144:147], v2, s[8:11], s56 offen offset:2048 sc1
    buffer_load_dwordx4 v[148:151], v2, s[8:11], s56 offen offset:3072 sc1
    s_waitcnt vmcnt(36)
    s_barrier
    s_mul_i32 s3, s58, 10240
    s_add_u32 s68, s3, 53248
    s_add_u32 s69, s62, s67
    s_add_u32 m0, s68, 0
    s_nop 0
    buffer_load_dwordx4 v8, s[12:15], s62 offen offset:0  lds
    s_add_u32 m0, s68, 1024
    s_nop 0
    buffer_load_dwordx4 v9, s[12:15], s62 offen offset:0  lds
    s_add_u32 m0, s68, 2048
    s_nop 0
    buffer_load_dwordx4 v10, s[12:15], s62 offen offset:0  lds
    s_add_u32 m0, s68, 3072
    s_nop 0
    buffer_load_dwordx4 v11, s[12:15], s62 offen offset:0  lds
    s_add_u32 m0, s68, 4096
    s_nop 0
    buffer_load_dwordx4 v12, s[12:15], s62 offen offset:0  lds
    s_add_u32 m0, s68, 5120
    s_nop 0
    buffer_load_dwordx4 v8, s[12:15], s69 offen offset:0  lds
    s_add_u32 m0, s68, 6144
    s_nop 0
    buffer_load_dwordx4 v9, s[12:15], s69 offen offset:0  lds
    s_add_u32 m0, s68, 7168
    s_nop 0
    buffer_load_dwordx4 v10, s[12:15], s69 offen offset:0  lds
    s_add_u32 m0, s68, 8192
    s_nop 0
    buffer_load_dwordx4 v11, s[12:15], s69 offen offset:0  lds
    s_add_u32 m0, s68, 9216
    s_nop 0
    buffer_load_dwordx4 v12, s[12:15], s69 offen offset:0  lds
    s_add_u32 s62, s62, s64
    s_cmp_ge_u32 s62, s63
    s_cselect_b32 s3, s65, 0
    s_sub_u32 s62, s62, s3
    s_add_u32 s56, s56, 4096
    buffer_load_dwordx4 v[152:155], v2, s[8:11], s56 offen offset:0 sc1
    buffer_load_dwordx4 v[156:159], v2, s[8:11], s56 offen offset:1024 sc1
    buffer_load_dwordx4 v[160:163], v2, s[8:11], s56 offen offset:2048 sc1
    buffer_load_dwordx4 v[164:167], v2, s[8:11], s56 offen offset:3072 sc1
    s_add_u32 s56, s56, 4096
    buffer_load_dwordx4 v[168:171], v2, s[8:11], s56 offen offset:0 sc1
    buffer_load_dwordx4 v[172:175], v2, s[8:11], s56 offen offset:1024 sc1
    buffer_load_dwordx4 v[176:179], v2, s[8:11], s56 offen offset:2048 sc1
    buffer_load_dwordx4 v[180:183], v2, s[8:11], s56 offen offset:3072 sc1
    s_add_u32 s56, s56, 4096
    buffer_load_dwordx4 v[184:187], v2, s[8:11], s56 offen offset:0 sc1
    buffer_load_dwordx4 v[188:191], v2, s[8:11], s56 offen offset:1024 sc1
    s_waitcnt vmcnt(46)
    s_waitcnt vmcnt(28)
    s_barrier
    buffer_load_dwordx4 v[192:195], v2, s[8:11], s56 offen offset:2048 sc1
    buffer_load_dwordx4 v[196:199], v2, s[8:11], s56 offen offset:3072 sc1
    s_add_u32 s56, s56, 4096
    buffer_load_dwordx4 v[200:203], v2, s[8:11], s56 offen offset:0 sc1
    buffer_load_dwordx4 v[204:207], v2, s[8:11], s56 offen offset:1024 sc1
    buffer_load_dwordx4 v[208:211], v2, s[8:11], s56 offen offset:2048 sc1
    buffer_load_dwordx4 v[212:215], v2, s[8:11], s56 offen offset:3072 sc1
    s_add_u32 s56, s56, 4096
    buffer_load_dwordx4 v[216:219], v2, s[8:11], s56 offen offset:0 sc1
    buffer_load_dwordx4 v[20:23], v2, s[8:11], s57 offen offset:0 sc1
    buffer_load_dwordx4 v[24:27], v2, s[8:11], s57 offen offset:1024 sc1
    buffer_load_dwordx4 v[28:31], v2, s[8:11], s57 offen offset:2048 sc1
    s_barrier
    buffer_load_dwordx4 v[32:35], v2, s[8:11], s57 offen offset:3072 sc1
    s_add_u32 s57, s57, 4096
    buffer_load_dwordx4 v[36:39], v2, s[8:11], s57 offen offset:0 sc1
    buffer_load_dwordx4 v[40:43], v2, s[8:11], s57 offen offset:1024 sc1
    buffer_load_dwordx4 v[44:47], v2, s[8:11], s57 offen offset:2048 sc1
    buffer_load_dwordx4 v[48:51], v2, s[8:11], s57 offen offset:3072 sc1
    s_add_u32 s57, s57, 4096
    buffer_load_dwordx4 v[52:55], v2, s[8:11], s57 offen offset:0 sc1
    buffer_load_dwordx4 v[56:59], v2, s[8:11], s57 offen offset:1024 sc1
    buffer_load_dwordx4 v[60:63], v2, s[8:11], s57 offen offset:2048 sc1
    buffer_load_dwordx4 v[64:67], v2, s[8:11], s57 offen offset:3072 sc1
    s_add_u32 s57, s57, 4096
    buffer_load_dwordx4 v[68:71], v2, s[8:11], s57 offen offset:0 sc1
    s_waitcnt vmcnt(30)
    s_barrier
    buffer_load_dwordx4 v[72:75], v2, s[8:11], s57 offen offset:1024 sc1
    buffer_load_dwordx4 v[76:79], v2, s[8:11], s57 offen offset:2048 sc1
    buffer_load_dwordx4 v[80:83], v2, s[8:11], s57 offen offset:3072 sc1
    s_add_u32 s57, s57, 4096
    buffer_load_dwordx4 v[84:87], v2, s[8:11], s57 offen offset:0 sc1
    buffer_load_dwordx4 v[88:91], v2, s[8:11], s57 offen offset:1024 sc1
    buffer_load_dwordx4 v[92:95], v2, s[8:11], s57 offen offset:2048 sc1
    buffer_load_dwordx4 v[96:99], v2, s[8:11], s57 offen offset:3072 sc1
    s_add_u32 s57, s57, 4096
    buffer_load_dwordx4 v[100:103], v2, s[8:11], s57 offen offset:0 sc1
    buffer_load_dwordx4 v[104:107], v2, s[8:11], s57 offen offset:1024 sc1
    buffer_load_dwordx4 v[108:111], v2, s[8:11], s57 offen offset:2048 sc1
Ltail:
    s_sub_u32 s58, s22, 4
    s_mul_i32 s67, s39, 143360
    s_add_u32 s67, s67, 0x1790000
    s_barrier
    buffer_load_dwordx4 v[112:115], v2, s[8:11], s57 offen offset:3072 sc1
    s_add_u32 s57, s57, 4096
    buffer_load_dwordx4 v[116:119], v2, s[8:11], s57 offen offset:0 sc1
    s_mul_i32 s3, s58, 10240
    s_add_u32 s69, s67, s3
    s_add_u32 s69, s69, 102400
    s_mul_i32 s68, s58, 10240
    s_add_u32 s68, s68, 102400
    s_add_u32 m0, s68, 0
    s_nop 0
    buffer_load_dwordx4 v2, s[8:11], s69 offen offset:0 sc1 lds
    buffer_load_dwordx4 v2, s[8:11], s69 offen offset:1024 sc1 lds
    buffer_load_dwordx4 v2, s[8:11], s69 offen offset:2048 sc1 lds
    buffer_load_dwordx4 v2, s[8:11], s69 offen offset:3072 sc1 lds
    s_add_u32 m0, s68, 4096
    s_add_u32 s69, s69, 4096
    buffer_load_dwordx4 v2, s[8:11], s69 offen offset:0 sc1 lds
    buffer_load_dwordx4 v2, s[8:11], s69 offen offset:1024 sc1 lds
    buffer_load_dwordx4 v2, s[8:11], s69 offen offset:2048 sc1 lds
    buffer_load_dwordx4 v2, s[8:11], s69 offen offset:3072 sc1 lds
    s_add_u32 m0, s68, 8192
    s_add_u32 s69, s69, 4096
    buffer_load_dwordx4 v2, s[8:11], s69 offen offset:0 sc1 lds
    buffer_load_dwordx4 v2, s[8:11], s69 offen offset:1024 sc1 lds
    s_waitcnt vmcnt(35)
    ds_write_b128 v3, v[120:123] offset:0
    ds_write_b128 v3, v[124:127] offset:1024
    ds_write_b128 v3, v[128:131] offset:2048
    ds_write_b128 v3, v[132:135] offset:3072
    ds_write_b128 v3, v[136:139] offset:4096
    ds_write_b128 v3, v[140:143] offset:5120
    ds_write_b128 v3, v[144:147] offset:6144
    ds_write_b128 v3, v[148:151] offset:7168
    ds_write_b128 v3, v[152:155] offset:8192
    ds_write_b128 v3, v[156:159] offset:9216
    ds_write_b128 v3, v[160:163] offset:10240
    ds_write_b128 v3, v[164:167] offset:11264
    ds_write_b128 v3, v[168:171] offset:12288
    ds_write_b128 v3, v[172:175] offset:13312
    ds_write_b128 v3, v[176:179] offset:14336
    ds_write_b128 v3, v[180:183] offset:15360
    ds_write_b128 v3, v[184:187] offset:16384
    ds_write_b128 v3, v[188:191] offset:17408
    ds_write_b128 v3, v[192:195] offset:18432
    ds_write_b128 v3, v[196:199] offset:19456
    ds_write_b128 v3, v[200:203] offset:20480
    ds_write_b128 v3, v[204:207] offset:21504
    ds_write_b128 v3, v[208:211] offset:22528
    ds_write_b128 v3, v[212:215] offset:23552
    ds_write_b128 v3, v[216:219] offset:24576
    s_waitcnt lgkmcnt(0)
    s_cmp_lg_u32 s22, 5
    s_cbranch_scc1 Lonly17
    s_waitcnt vmcnt(40)
    s_mul_i32 s69, s39, 8960
    s_add_u32 s69, s69, 0x1c99000
    v_and_b32 v4, 31, v1
    v_lshlrev_b32 v4, 4, v4
    v_lshrrev_b32 v5, 5, v1
    v_mul_u32_u24 v5, 4480, v5
    v_add_u32 v5, v5, v4
    buffer_load_dwordx4 v[168:171], v5, s[8:11], s69 offen offset:0 sc1
    buffer_load_dwordx4 v[172:175], v5, s[8:11], s69 offen offset:448 sc1
    buffer_load_dwordx4 v[176:179], v5, s[8:11], s69 offen offset:896 sc1
    buffer_load_dwordx4 v[180:183], v5, s[8:11], s69 offen offset:1344 sc1
    buffer_load_dwordx4 v[184:187], v5, s[8:11], s69 offen offset:1792 sc1
    buffer_load_dwordx4 v[188:191], v5, s[8:11], s69 offen offset:2240 sc1
    buffer_load_dwordx4 v[192:195], v5, s[8:11], s69 offen offset:2688 sc1
    buffer_load_dwordx4 v[196:199], v5, s[8:11], s69 offen offset:3136 sc1
    buffer_load_dwordx4 v[200:203], v5, s[8:11], s69 offen offset:3584 sc1
    buffer_load_dwordx4 v[204:207], v5, s[8:11], s69 offen offset:4032 sc1
    s_waitcnt vmcnt(0)
    v_pk_add_f32 v[168:169], v[168:169], v[172:173]
    v_pk_add_f32 v[170:171], v[170:171], v[174:175]
    v_pk_add_f32 v[168:169], v[168:169], v[176:177]
    v_pk_add_f32 v[170:171], v[170:171], v[178:179]
    v_pk_add_f32 v[168:169], v[168:169], v[180:181]
    v_pk_add_f32 v[170:171], v[170:171], v[182:183]
    v_pk_add_f32 v[168:169], v[168:169], v[184:185]
    v_pk_add_f32 v[170:171], v[170:171], v[186:187]
    v_pk_add_f32 v[168:169], v[168:169], v[188:189]
    v_pk_add_f32 v[170:171], v[170:171], v[190:191]
    v_pk_add_f32 v[168:169], v[168:169], v[192:193]
    v_pk_add_f32 v[170:171], v[170:171], v[194:195]
    v_pk_add_f32 v[168:169], v[168:169], v[196:197]
    v_pk_add_f32 v[170:171], v[170:171], v[198:199]
    v_pk_add_f32 v[168:169], v[168:169], v[200:201]
    v_pk_add_f32 v[170:171], v[170:171], v[202:203]
    v_pk_add_f32 v[168:169], v[168:169], v[204:205]
    v_pk_add_f32 v[170:171], v[170:171], v[206:207]
    v_mov_b32 v172, v168
    v_mov_b32 v173, v169
    v_mov_b32 v174, v170
    v_mov_b32 v175, v171
    s_nop 1
    v_permlane32_swap_b32 v172, v168
    v_permlane32_swap_b32 v173, v169
    v_permlane32_swap_b32 v174, v170
    v_permlane32_swap_b32 v175, v171
    v_pk_add_f32 v[168:169], v[168:169], v[172:173]
    v_pk_add_f32 v[170:171], v[170:171], v[174:175]
    v_add_u32 v4, 151040, v4
    ds_write_b128 v4, v[168:171]
    s_waitcnt lgkmcnt(0)
Lonly17:
    s_and_b32 s3, s2, 7
    s_lshl_b32 s3, s3, 10
    s_add_u32 s3, s3, 0x1c46000
    v_add_u32 v16, s3, v2
    s_mov_b32 s31, 0
    s_branch Lpkld20
Lpk18:
    v_min_u32 v224, v224, v225
    v_min3_u32 v224, v224, v226, v227
    v_cmp_eq_u32 vcc, 0, v224
    s_cbranch_vccz Lpkok19
    s_add_u32 s31, s31, 1
    s_cmp_gt_u32 s31, 400000
    s_cbranch_scc1 Lpkok19
Lpkld20:
    buffer_load_dwordx4 v[224:227], v16, s[8:11], 0 offen sc1
    s_waitcnt vmcnt(0)
    s_branch Lpk18
Lpkok19:
    s_mul_i32 s69, s28, 102400
    s_mul_i32 s3, s58, 25600
    s_add_u32 s69, s69, s3
    s_add_u32 s69, s69, 0x16c8000
    v_mov_b32 v4, 150784
    s_mov_b32 s31, 0
Lspin:
    ds_read_b32 v5, v4
    s_add_u32 s31, s31, 1
    s_cmp_gt_u32 s31, 400000
    s_cbranch_scc1 Lspinx
    s_waitcnt lgkmcnt(0)
    v_cmp_gt_u32 vcc, 4, v5
    s_cbranch_vccnz Lspin
Lspinx:
    buffer_load_dwordx4 v[120:123], v2, s[8:11], s69 offen offset:0 sc1
    buffer_load_dwordx4 v[124:127], v2, s[8:11], s69 offen offset:1024 sc1
    buffer_load_dwordx4 v[128:131], v2, s[8:11], s69 offen offset:2048 sc1
    buffer_load_dwordx4 v[132:135], v2, s[8:11], s69 offen offset:3072 sc1
    s_add_u32 s69, s69, 4096
    buffer_load_dwordx4 v[136:139], v2, s[8:11], s69 offen offset:0 sc1
    buffer_load_dwordx4 v[140:143], v2, s[8:11], s69 offen offset:1024 sc1
    buffer_load_dwordx4 v[144:147], v2, s[8:11], s69 offen offset:2048 sc1
    buffer_load_dwordx4 v[148:151], v2, s[8:11], s69 offen offset:3072 sc1
    s_add_u32 s69, s69, 4096
    buffer_load_dwordx4 v[152:155], v2, s[8:11], s69 offen offset:0 sc1
    buffer_load_dwordx4 v[156:159], v2, s[8:11], s69 offen offset:1024 sc1
    buffer_load_dwordx4 v[160:163], v2, s[8:11], s69 offen offset:2048 sc1
    buffer_load_dwordx4 v[164:167], v2, s[8:11], s69 offen offset:3072 sc1
    s_add_u32 s69, s69, 4096
    buffer_load_dwordx4 v[168:171], v2, s[8:11], s69 offen offset:0 sc1
    buffer_load_dwordx4 v[172:175], v2, s[8:11], s69 offen offset:1024 sc1
    buffer_load_dwordx4 v[176:179], v2, s[8:11], s69 offen offset:2048 sc1
    buffer_load_dwordx4 v[180:183], v2, s[8:11], s69 offen offset:3072 sc1
    s_add_u32 s69, s69, 4096
    buffer_load_dwordx4 v[184:187], v2, s[8:11], s69 offen offset:0 sc1
    buffer_load_dwordx4 v[188:191], v2, s[8:11], s69 offen offset:1024 sc1
    buffer_load_dwordx4 v[192:195], v2, s[8:11], s69 offen offset:2048 sc1
    buffer_load_dwordx4 v[196:199], v2, s[8:11], s69 offen offset:3072 sc1
    s_add_u32 s69, s69, 4096
    buffer_load_dwordx4 v[200:203], v2, s[8:11], s69 offen offset:0 sc1
    buffer_load_dwordx4 v[204:207], v2, s[8:11], s69 offen offset:1024 sc1
    buffer_load_dwordx4 v[208:211], v2, s[8:11], s69 offen offset:2048 sc1
    buffer_load_dwordx4 v[212:215], v2, s[8:11], s69 offen offset:3072 sc1
    s_add_u32 s69, s69, 4096
    buffer_load_dwordx4 v[216:219], v2, s[8:11], s69 offen offset:0 sc1
    s_cmp_lg_u32 s22, 4
    s_cbranch_scc1 Lonly21
    s_and_b32 s3, s27, 1
    s_lshl_b32 s3, s3, 1
    s_add_u32 s3, s3, s25
    s_add_u32 s3, s3, 15
    s_and_b32 s67, s3, 15
    v_mov_b32 v4, s25
    s_mov_b32 exec_lo, 0
    v_mov_b32 v4, s67
    s_mov_b32 exec_lo, -1
    v_and_b32 v5, 3, v1
    v_add_u32 v5, 12, v5
    v_lshlrev_b32 v5, 2, v5
    v_lshl_add_u32 v4, v4, 7, v5
    s_and_b32 s3, s26, 3
    s_lshl_b32 s3, s3, 11
    s_add_u32 s3, s3, 0x1c42000
    v_add_u32 v4, s3, v4
    v_mov_b32 v5, 1
    s_mov_b32 s31, 0
Lpoll22:
    buffer_load_dword v6, v4, s[8:11], 0 offen sc1
    s_add_u32 s31, s31, 1
    s_cmp_gt_u32 s31, 400000
    s_cbranch_scc1 Lpollx23
    s_waitcnt vmcnt(0)
    v_cmp_lt_u32 vcc, v6, v5
    s_cbranch_vccnz Lpoll22
Lpollx23:
    s_waitcnt vmcnt(0)
Lonly21:
    s_barrier
    s_mov_b32 s59, 0
    s_mul_i32 s66, s28, 276480
    s_mul_i32 s3, s58, 5120
    s_add_u32 s61, s66, 0x19c0000
    s_add_u32 s66, s61, s3
    s_movk_i32 s64, 20480
    v_add_u32 v11, s3, v2
    s_mul_i32 s65, s64, 13
    s_add_u32 s63, s66, s65
    s_mul_i32 s3, s59, s64
    s_add_u32 s62, s66, s3
    v_add_u32 v12, 0x10000, v11
    v_add_u32 v13, 0x20000, v11
    s_mov_b32 s56, s62
    s_add_u32 s62, s62, s64
    s_cmp_ge_u32 s62, s63
    s_cselect_b32 s3, s65, 0
    s_sub_u32 s62, s62, s3
    s_mov_b32 s57, s62
    s_add_u32 s62, s62, s64
    s_cmp_ge_u32 s62, s63
    s_cselect_b32 s3, s65, 0
    s_sub_u32 s62, s62, s3
    s_add_u32 s61, s61, s65
    s_lshl_b32 s3, s58, 11
    s_add_u32 s60, s61, s3
    v_add_u32 v14, s3, v2
    s_and_b32 s3, s58, 1
    s_lshl_b32 s3, s3, 10
    s_add_u32 s3, s3, 8192
    s_add_u32 s61, s61, s3
    v_add_u32 v15, s3, v2
    v_add_u32 v14, 81920, v14
    v_add_u32 v15, 81920, v15
    s_cmp_lg_u32 s22, 4
    s_cbranch_scc1 Lonly24
    s_max_u32 s67, s25, 1
    s_sub_u32 s67, s67, 1
    v_mov_b32 v4, s25
    s_mov_b32 exec_lo, 0
    v_mov_b32 v4, s67
    s_mov_b32 exec_lo, -1
    v_and_b32 v5, 15, v1
    v_min_u32 v5, 11, v5
    v_lshlrev_b32 v5, 2, v5
    v_lshl_add_u32 v4, v4, 7, v5
    s_and_b32 s3, s26, 3
    s_lshl_b32 s3, s3, 11
    s_add_u32 s3, s3, 0x1c42000
    v_add_u32 v4, s3, v4
    v_mov_b32 v5, 1
    s_mov_b32 s31, 0
Lpoll25:
    buffer_load_dword v6, v4, s[8:11], 0 offen sc1
    s_add_u32 s31, s31, 1
    s_cmp_gt_u32 s31, 400000
    s_cbranch_scc1 Lpollx26
    s_waitcnt vmcnt(0)
    v_cmp_lt_u32 vcc, v6, v5
    s_cbranch_vccnz Lpoll25
Lpollx26:
    s_waitcnt vmcnt(0)
Lonly24:
    s_waitcnt vmcnt(0)
    s_barrier
    s_mul_i32 s69, s28, 102400
    s_mul_i32 s3, s58, 25600
    s_add_u32 s69, s69, s3
    s_add_u32 s69, s69, 0x16c8000
    s_mov_b32 s55, s62
    s_add_u32 s62, s62, s64
    s_cmp_ge_u32 s62, s63
    s_cselect_b32 s3, s65, 0
    s_sub_u32 s62, s62, s3
    s_add_u32 s62, s62, s64
    s_cmp_ge_u32 s62, s63
    s_cselect_b32 s3, s65, 0
    s_sub_u32 s62, s62, s3
    s_add_u32 s62, s62, s64
    s_cmp_ge_u32 s62, s63
    s_cselect_b32 s3, s65, 0
    s_sub_u32 s62, s62, s3
    s_add_u32 s62, s62, s64
    s_cmp_ge_u32 s62, s63
    s_cselect_b32 s3, s65, 0
    s_sub_u32 s62, s62, s3
    s_add_u32 s62, s62, s64
    s_cmp_ge_u32 s62, s63
    s_cselect_b32 s3, s65, 0
    s_sub_u32 s62, s62, s3
    s_barrier
    ds_write_b128 v3, v[20:23] offset:0
    ds_write_b128 v3, v[24:27] offset:1024
    ds_write_b128 v3, v[28:31] offset:2048
    ds_write_b128 v3, v[32:35] offset:3072
    ds_write_b128 v3, v[36:39] offset:4096
    ds_write_b128 v3, v[40:43] offset:5120
    ds_write_b128 v3, v[44:47] offset:6144
    ds_write_b128 v3, v[48:51] offset:7168
    ds_write_b128 v3, v[52:55] offset:8192
    ds_write_b128 v3, v[56:59] offset:9216
    ds_write_b128 v3, v[60:63] offset:10240
    ds_write_b128 v3, v[64:67] offset:11264
    ds_write_b128 v3, v[68:71] offset:12288
    ds_write_b128 v3, v[72:75] offset:13312
    ds_write_b128 v3, v[76:79] offset:14336
    ds_write_b128 v3, v[80:83] offset:15360
    ds_write_b128 v3, v[84:87] offset:16384
    ds_write_b128 v3, v[88:91] offset:17408
    ds_write_b128 v3, v[92:95] offset:18432
    ds_write_b128 v3, v[96:99] offset:19456
    ds_write_b128 v3, v[100:103] offset:20480
    ds_write_b128 v3, v[104:107] offset:21504
    ds_write_b128 v3, v[108:111] offset:22528
    ds_write_b128 v3, v[112:115] offset:23552
    ds_write_b128 v3, v[116:119] offset:24576
    s_waitcnt lgkmcnt(0)
    s_mov_b32 s69, s62
    buffer_load_dwordx4 v[20:23], v2, s[8:11], s69 offen offset:0 sc1
    buffer_load_dwordx4 v[24:27], v2, s[8:11], s69 offen offset:1024 sc1
    buffer_load_dwordx4 v[28:31], v2, s[8:11], s69 offen offset:2048 sc1
    buffer_load_dwordx4 v[32:35], v2, s[8:11], s69 offen offset:3072 sc1
    s_add_u32 s69, s69, 4096
    buffer_load_dwordx4 v[36:39], v2, s[8:11], s69 offen offset:0 sc1
    s_add_u32 s62, s62, s64
    s_cmp_ge_u32 s62, s63
    s_cselect_b32 s3, s65, 0
    s_sub_u32 s62, s62, s3
    s_mov_b32 s69, s62
    buffer_load_dwordx4 v[40:43], v2, s[8:11], s69 offen offset:0 sc1
    buffer_load_dwordx4 v[44:47], v2, s[8:11], s69 offen offset:1024 sc1
    buffer_load_dwordx4 v[48:51], v2, s[8:11], s69 offen offset:2048 sc1
    buffer_load_dwordx4 v[52:55], v2, s[8:11], s69 offen offset:3072 sc1
    s_add_u32 s69, s69, 4096
    buffer_load_dwordx4 v[56:59], v2, s[8:11], s69 offen offset:0 sc1
    s_add_u32 s62, s62, s64
    s_cmp_ge_u32 s62, s63
    s_cselect_b32 s3, s65, 0
    s_sub_u32 s62, s62, s3
    s_mov_b32 s69, s62
    buffer_load_dwordx4 v[60:63], v2, s[8:11], s69 offen offset:0 sc1
    buffer_load_dwordx4 v[64:67], v2, s[8:11], s69 offen offset:1024 sc1
    buffer_load_dwordx4 v[68:71], v2, s[8:11], s69 offen offset:2048 sc1
    buffer_load_dwordx4 v[72:75], v2, s[8:11], s69 offen offset:3072 sc1
    s_add_u32 s69, s69, 4096
    buffer_load_dwordx4 v[76:79], v2, s[8:11], s69 offen offset:0 sc1
    s_add_u32 s62, s62, s64
    s_cmp_ge_u32 s62, s63
    s_cselect_b32 s3, s65, 0
    s_sub_u32 s62, s62, s3
    s_mov_b32 s69, s62
    buffer_load_dwordx4 v[80:83], v2, s[8:11], s69 offen offset:0 sc1
    buffer_load_dwordx4 v[84:87], v2, s[8:11], s69 offen offset:1024 sc1
    buffer_load_dwordx4 v[88:91], v2, s[8:11], s69 offen offset:2048 sc1
    buffer_load_dwordx4 v[92:95], v2, s[8:11], s69 offen offset:3072 sc1
    s_add_u32 s69, s69, 4096
    buffer_load_dwordx4 v[96:99], v2, s[8:11], s69 offen offset:0 sc1
    s_add_u32 s62, s62, s64
    s_cmp_ge_u32 s62, s63
    s_cselect_b32 s3, s65, 0
    s_sub_u32 s62, s62, s3
    s_mov_b32 s69, s62
    buffer_load_dwordx4 v[100:103], v2, s[8:11], s69 offen offset:0 sc1
    buffer_load_dwordx4 v[104:107], v2, s[8:11], s69 offen offset:1024 sc1
    buffer_load_dwordx4 v[108:111], v2, s[8:11], s69 offen offset:2048 sc1
    buffer_load_dwordx4 v[112:115], v2, s[8:11], s69 offen offset:3072 sc1
    s_add_u32 s69, s69, 4096
    buffer_load_dwordx4 v[116:119], v2, s[8:11], s69 offen offset:0 sc1
    s_add_u32 s62, s62, s64
    s_cmp_ge_u32 s62, s63
    s_cselect_b32 s3, s65, 0
    s_sub_u32 s62, s62, s3
    s_mov_b32 s69, s62
    buffer_load_dwordx4 v[220:223], v2, s[8:11], s69 offen offset:0 sc1
    buffer_load_dwordx4 v[224:227], v2, s[8:11], s69 offen offset:1024 sc1
    buffer_load_dwordx4 v[228:231], v2, s[8:11], s69 offen offset:2048 sc1
    buffer_load_dwordx4 v[232:235], v2, s[8:11], s69 offen offset:3072 sc1
    s_add_u32 s69, s69, 4096
    buffer_load_dwordx4 v[236:239], v2, s[8:11], s69 offen offset:0 sc1
    s_add_u32 s62, s62, s64
    s_cmp_ge_u32 s62, s63
    s_cselect_b32 s3, s65, 0
    s_sub_u32 s62, s62, s3
    s_cmp_lg_u32 s22, 4
    s_cbranch_scc1 Lonly27
    s_lshl_b32 s29, s38, 7
    s_add_u32 s29, s29, 0x1c44000
    v_and_b32 v4, 15, v1
    v_lshl_add_u32 v4, v4, 2, s29
    v_mov_b32 v5, 1
    s_mov_b32 s31, 0
Lpoll28:
    buffer_load_dword v6, v4, s[8:11], 0 offen sc1
    s_add_u32 s31, s31, 1
    s_cmp_gt_u32 s31, 400000
    s_cbranch_scc1 Lpollx29
    s_waitcnt vmcnt(0)
    v_cmp_lt_u32 vcc, v6, v5
    s_cbranch_vccnz Lpoll28
Lpollx29:
    s_waitcnt vmcnt(0)
Lonly27:
    s_waitcnt lgkmcnt(0)
    s_barrier
    s_barrier
    s_cmp_lg_u32 s22, 4
    s_cbranch_scc1 Lonly30
    s_lshl_b32 s29, s25, 8
    s_add_u32 s29, s29, 0x1c45000
    v_and_b32 v4, 63, v1
    v_lshl_add_u32 v4, v4, 2, s29
    v_mov_b32 v5, 1
    s_mov_b32 s31, 0
Lpoll31:
    buffer_load_dword v6, v4, s[8:11], 0 offen sc1
    s_add_u32 s31, s31, 1
    s_cmp_gt_u32 s31, 400000
    s_cbranch_scc1 Lpollx32
    s_waitcnt vmcnt(0)
    v_cmp_lt_u32 vcc, v6, v5
    s_cbranch_vccnz Lpoll31
Lpollx32:
    s_waitcnt vmcnt(0)
Lonly30:
    buffer_load_dwordx4 v[240:243], v2, s[8:11], s60 offen offset:0 sc1
    buffer_load_dwordx4 v[244:247], v2, s[8:11], s60 offen offset:1024 sc1
    buffer_load_dwordx4 v[248:251], v2, s[8:11], s61 offen offset:0 sc1
    s_barrier
    s_mul_i32 s69, s28, 102400
    s_mul_i32 s3, s58, 25600
    s_add_u32 s69, s69, s3
    s_add_u32 s69, s69, 0x16c8000
    ds_write_b128 v3, v[120:123] offset:0
    ds_write_b128 v3, v[124:127] offset:1024
    ds_write_b128 v3, v[128:131] offset:2048
    ds_write_b128 v3, v[132:135] offset:3072
    ds_write_b128 v3, v[136:139] offset:4096
    ds_write_b128 v3, v[140:143] offset:5120
    ds_write_b128 v3, v[144:147] offset:6144
    ds_write_b128 v3, v[148:151] offset:7168
    ds_write_b128 v3, v[152:155] offset:8192
    ds_write_b128 v3, v[156:159] offset:9216
    ds_write_b128 v3, v[160:163] offset:10240
    ds_write_b128 v3, v[164:167] offset:11264
    ds_write_b128 v3, v[168:171] offset:12288
    ds_write_b128 v3, v[172:175] offset:13312
    ds_write_b128 v3, v[176:179] offset:14336
    ds_write_b128 v3, v[180:183] offset:15360
    ds_write_b128 v3, v[184:187] offset:16384
    ds_write_b128 v3, v[188:191] offset:17408
    ds_write_b128 v3, v[192:195] offset:18432
    ds_write_b128 v3, v[196:199] offset:19456
    ds_write_b128 v3, v[200:203] offset:20480
    ds_write_b128 v3, v[204:207] offset:21504
    ds_write_b128 v3, v[208:211] offset:22528
    ds_write_b128 v3, v[212:215] offset:23552
    ds_write_b128 v3, v[216:219] offset:24576
    s_mul_i32 s68, s58, 5120
    s_add_u32 s68, s68, 102400
    s_add_u32 m0, s68, 0
    s_nop 0
    buffer_load_dwordx4 v2, s[8:11], s56 offen offset:0 sc1 lds
    buffer_load_dwordx4 v2, s[8:11], s56 offen offset:1024 sc1 lds
    buffer_load_dwordx4 v2, s[8:11], s56 offen offset:2048 sc1 lds
    buffer_load_dwordx4 v2, s[8:11], s56 offen offset:3072 sc1 lds
    s_add_u32 m0, s68, 4096
    s_add_u32 s56, s56, 4096
    buffer_load_dwordx4 v2, s[8:11], s56 offen offset:0 sc1 lds
    s_mul_i32 s68, s58, 5120
    s_add_u32 s68, s68, 122880
    s_add_u32 m0, s68, 0
    s_nop 0
    buffer_load_dwordx4 v2, s[8:11], s57 offen offset:0 sc1 lds
    buffer_load_dwordx4 v2, s[8:11], s57 offen offset:1024 sc1 lds
    buffer_load_dwordx4 v2, s[8:11], s57 offen offset:2048 sc1 lds
    buffer_load_dwordx4 v2, s[8:11], s57 offen offset:3072 sc1 lds
    s_add_u32 m0, s68, 4096
    s_add_u32 s57, s57, 4096
    buffer_load_dwordx4 v2, s[8:11], s57 offen offset:0 sc1 lds
    s_waitcnt lgkmcnt(0)
    s_barrier
    s_mov_b32 s62, s55
    s_mov_b32 s69, s62
    buffer_load_dwordx4 v[120:123], v2, s[8:11], s69 offen offset:0 sc1
    buffer_load_dwordx4 v[124:127], v2, s[8:11], s69 offen offset:1024 sc1
    buffer_load_dwordx4 v[128:131], v2, s[8:11], s69 offen offset:2048 sc1
    buffer_load_dwordx4 v[132:135], v2, s[8:11], s69 offen offset:3072 sc1
    s_add_u32 s69, s69, 4096
    buffer_load_dwordx4 v[136:139], v2, s[8:11], s69 offen offset:0 sc1
    s_add_u32 s62, s62, s64
    s_cmp_ge_u32 s62, s63
    s_cselect_b32 s3, s65, 0
    s_sub_u32 s62, s62, s3
    s_mov_b32 s69, s62
    buffer_load_dwordx4 v[140:143], v2, s[8:11], s69 offen offset:0 sc1
    buffer_load_dwordx4 v[144:147], v2, s[8:11], s69 offen offset:1024 sc1
    buffer_load_dwordx4 v[148:151], v2, s[8:11], s69 offen offset:2048 sc1
    buffer_load_dwordx4 v[152:155], v2, s[8:11], s69 offen offset:3072 sc1
    s_add_u32 s69, s69, 4096
    buffer_load_dwordx4 v[156:159], v2, s[8:11], s69 offen offset:0 sc1
    s_add_u32 s62, s62, s64
    s_cmp_ge_u32 s62, s63
    s_cselect_b32 s3, s65, 0
    s_sub_u32 s62, s62, s3
    s_mov_b32 s69, s62
    buffer_load_dwordx4 v[160:163], v2, s[8:11], s69 offen offset:0 sc1
    buffer_load_dwordx4 v[164:167], v2, s[8:11], s69 offen offset:1024 sc1
    buffer_load_dwordx4 v[168:171], v2, s[8:11], s69 offen offset:2048 sc1
    buffer_load_dwordx4 v[172:175], v2, s[8:11], s69 offen offset:3072 sc1
    s_waitcnt vmcnt(52)
    s_add_u32 s69, s69, 4096
    buffer_load_dwordx4 v[176:179], v2, s[8:11], s69 offen offset:0 sc1
    s_add_u32 s62, s62, s64
    s_cmp_ge_u32 s62, s63
    s_cselect_b32 s3, s65, 0
    s_sub_u32 s62, s62, s3
    s_mov_b32 s69, s62
    buffer_load_dwordx4 v[180:183], v2, s[8:11], s69 offen offset:0 sc1
    buffer_load_dwordx4 v[184:187], v2, s[8:11], s69 offen offset:1024 sc1
    buffer_load_dwordx4 v[188:191], v2, s[8:11], s69 offen offset:2048 sc1
    buffer_load_dwordx4 v[192:195], v2, s[8:11], s69 offen offset:3072 sc1
    s_waitcnt vmcnt(52)
    s_add_u32 s69, s69, 4096
    buffer_load_dwordx4 v[196:199], v2, s[8:11], s69 offen offset:0 sc1
    s_add_u32 s62, s62, s64
    s_cmp_ge_u32 s62, s63
    s_cselect_b32 s3, s65, 0
    s_sub_u32 s62, s62, s3
    s_mov_b32 s69, s62
    buffer_load_dwordx4 v[200:203], v2, s[8:11], s69 offen offset:0 sc1
    buffer_load_dwordx4 v[204:207], v2, s[8:11], s69 offen offset:1024 sc1
    buffer_load_dwordx4 v[208:211], v2, s[8:11], s69 offen offset:2048 sc1
    buffer_load_dwordx4 v[212:215], v2, s[8:11], s69 offen offset:3072 sc1
    s_waitcnt vmcnt(52)
    s_add_u32 s69, s69, 4096
    buffer_load_dwordx4 v[216:219], v2, s[8:11], s69 offen offset:0 sc1
    s_add_u32 s62, s62, s64
    s_cmp_ge_u32 s62, s63
    s_cselect_b32 s3, s65, 0
    s_sub_u32 s62, s62, s3
    s_cmp_lg_u32 s22, 4
    s_cbranch_scc1 Lonly33
    s_lshl_b32 s29, s25, 7
    s_add_u32 s29, s29, 0x1c44800
    v_and_b32 v4, 15, v1
    v_lshl_add_u32 v4, v4, 2, s29
    v_mov_b32 v5, 1
    s_mov_b32 s31, 0
Lpoll34:
    buffer_load_dword v6, v4, s[8:11], 0 offen sc1
    s_add_u32 s31, s31, 1
    s_cmp_gt_u32 s31, 400000
    s_cbranch_scc1 Lpollx35
    s_waitcnt vmcnt(0)
    v_cmp_lt_u32 vcc, v6, v5
    s_cbranch_vccnz Lpoll34
Lpollx35:
    s_waitcnt vmcnt(0)
Lonly33:
    s_waitcnt vmcnt(25)
    s_waitcnt lgkmcnt(15)
    s_barrier
    s_waitcnt vmcnt(20)
    ds_write_b128 v11, v[120:123] offset:0
    ds_write_b128 v11, v[124:127] offset:1024
    ds_write_b128 v11, v[128:131] offset:2048
    ds_write_b128 v11, v[132:135] offset:3072
    ds_write_b128 v11, v[136:139] offset:4096
    s_waitcnt vmcnt(15)
    ds_write_b128 v11, v[140:143] offset:20480
    ds_write_b128 v11, v[144:147] offset:21504
    ds_write_b128 v11, v[148:151] offset:22528
    ds_write_b128 v11, v[152:155] offset:23552
    ds_write_b128 v11, v[156:159] offset:24576
    s_waitcnt lgkmcnt(15)
    s_barrier
    s_waitcnt vmcnt(10)
    ds_write_b128 v11, v[160:163] offset:40960
    ds_write_b128 v11, v[164:167] offset:41984
    ds_write_b128 v11, v[168:171] offset:43008
    ds_write_b128 v11, v[172:175] offset:44032
    ds_write_b128 v11, v[176:179] offset:45056
    s_waitcnt vmcnt(5)
    ds_write_b128 v11, v[180:183] offset:61440
    ds_write_b128 v11, v[184:187] offset:62464
    ds_write_b128 v11, v[188:191] offset:63488
    ds_write_b128 v11, v[192:195] offset:64512
    ds_write_b128 v12, v[196:199] offset:0
    s_waitcnt vmcnt(0)
    ds_write_b128 v12, v[200:203] offset:16384
    ds_write_b128 v12, v[204:207] offset:17408
    ds_write_b128 v12, v[208:211] offset:18432
    ds_write_b128 v12, v[212:215] offset:19456
    ds_write_b128 v12, v[216:219] offset:20480
    s_waitcnt lgkmcnt(15)
    s_barrier
    ds_write_b128 v12, v[20:23] offset:36864
    ds_write_b128 v12, v[24:27] offset:37888
    ds_write_b128 v12, v[28:31] offset:38912
    ds_write_b128 v12, v[32:35] offset:39936
    ds_write_b128 v12, v[36:39] offset:40960
    s_waitcnt lgkmcnt(15)
    s_barrier
    ds_write_b128 v12, v[40:43] offset:57344
    ds_write_b128 v12, v[44:47] offset:58368
    ds_write_b128 v12, v[48:51] offset:59392
    ds_write_b128 v12, v[52:55] offset:60416
    ds_write_b128 v12, v[56:59] offset:61440
    s_waitcnt lgkmcnt(15)
    s_barrier
    ds_write_b128 v11, v[60:63] offset:0
    ds_write_b128 v11, v[64:67] offset:1024
    ds_write_b128 v11, v[68:71] offset:2048
    ds_write_b128 v11, v[72:75] offset:3072
    ds_write_b128 v11, v[76:79] offset:4096
    s_waitcnt lgkmcnt(15)
    s_barrier
    ds_write_b128 v11, v[80:83] offset:20480
    ds_write_b128 v11, v[84:87] offset:21504
    ds_write_b128 v11, v[88:91] offset:22528
    ds_write_b128 v11, v[92:95] offset:23552
    ds_write_b128 v11, v[96:99] offset:24576
    s_waitcnt lgkmcnt(15)
    s_barrier
    ds_write_b128 v11, v[100:103] offset:40960
    ds_write_b128 v11, v[104:107] offset:41984
    ds_write_b128 v11, v[108:111] offset:43008
    ds_write_b128 v11, v[112:115] offset:44032
    ds_write_b128 v11, v[116:119] offset:45056
    s_waitcnt lgkmcnt(15)
    s_barrier
    ds_write_b128 v11, v[220:223] offset:61440
    ds_write_b128 v11, v[224:227] offset:62464
    ds_write_b128 v11, v[228:231] offset:63488
    ds_write_b128 v11, v[232:235] offset:64512
    ds_write_b128 v12, v[236:239] offset:0
    s_waitcnt lgkmcnt(15)
    s_barrier
    ds_write_b128 v14, v[240:243]
    ds_write_b128 v14, v[244:247] offset:1024
    ds_write_b128 v15, v[248:251]
    s_waitcnt lgkmcnt(15)
    s_barrier
    s_waitcnt lgkmcnt(0)
    s_barrier
    s_endpgm
.section .rodata,"a"
.p2align 6
.amdhsa_kernel recurrent_scan__sliding_local_dilated__mixer_s_mlp__prompt_kernel
  .amdhsa_next_free_vgpr 256
  .amdhsa_next_free_sgpr 102
  .amdhsa_accum_offset 256
  .amdhsa_group_segment_fixed_size 0
  .amdhsa_kernarg_size 88
  .amdhsa_user_sgpr_count 2
  .amdhsa_user_sgpr_kernarg_segment_ptr 1
  .amdhsa_system_sgpr_workgroup_id_x 1
.end_amdhsa_kernel
```
